```python
import torch

def _softmax(x, axis=-1):
    return torch.softmax(x, dim=axis)
def _gelu(x):
    return torch.nn.functional.gelu(x, approximate="tanh")
def _silu(x):
    return torch.nn.functional.silu(x)
def _sigmoid(x):
    return torch.sigmoid(x)
def _layernorm(x, axis=-1, eps=1e-5):
    m = x.mean(dim=axis, keepdim=True)
    v = x.var(dim=axis, keepdim=True, unbiased=False)
    return (x - m) / torch.sqrt(v + eps)
def _scatter_add(tgt, idx, src, axis=0):
    return tgt.clone().index_add_(axis, idx, src)
def _segment_sum(src, seg, n):
    out = torch.zeros((n,) + src.shape[1:], dtype=src.dtype)
    return out.index_add_(0, seg, src)
def _pad(x, pw):
    flat = tuple(v for pair in reversed(pw) for v in pair)
    return torch.nn.functional.pad(x, flat)

kernel_name = 'recurrent_scan__ssm_conv_s4d__geglu_ffn__prompt'

def setup_inputs():

    _w = (lambda a: (lambda t: t.to(torch.bfloat16) if t.is_floating_point() else t)(torch.as_tensor(a)))
    def _A_setup():
        Bsz, L, D, N = 1, 2048, 640, 128
        return {
            "u": _w((lambda *s: torch.randn(*s, dtype=torch.bfloat16) * 0.05)(Bsz, L, D)),
            "log_A_real": _w((lambda *s: torch.randn(*s, dtype=torch.bfloat16) * 3.2)(D, N) * 0.5),
            "A_imag": _w((lambda *s: torch.randn(*s, dtype=torch.bfloat16) * 0.05)(D, N) * 3.14),
            "C_real": _w((lambda *s: torch.randn(*s, dtype=torch.bfloat16) * 0.1)(D, N) / N ** 0.5),
            "C_imag": _w((lambda *s: torch.randn(*s, dtype=torch.bfloat16) * 0.1)(D, N) / N ** 0.5),
            "log_dt": _w((lambda *s: torch.randn(*s, dtype=torch.bfloat16) * 0.05)(D) * 0.5 - 4.0),
            "D_skip": _w((lambda *s: torch.randn(*s, dtype=torch.bfloat16) * 0.05)(D)),
        }
    _A_in = _A_setup()

    def _B_setup():
        B, S, D, F = 1, 2048, 640, 1728
        return {
            "x": _w((lambda *s: torch.randn(*s, dtype=torch.bfloat16) * 0.05)(B, S, D)),
            "w_gate": _w((lambda *s: torch.randn(*s, dtype=torch.bfloat16) * 0.05)(D, F)),
            "w_up": _w((lambda *s: torch.randn(*s, dtype=torch.bfloat16) * 0.05)(D, F)),
            "w_down": _w((lambda *s: torch.randn(*s, dtype=torch.bfloat16) * 0.05)(F, D)),
        }
    _B_in = _B_setup()

    return {
        "A_u": _A_in["u"],
        "A_log_A_real": _A_in["log_A_real"],
        "A_A_imag": _A_in["A_imag"],
        "A_C_real": _A_in["C_real"],
        "A_C_imag": _A_in["C_imag"],
        "A_log_dt": _A_in["log_dt"],
        "A_D_skip": _A_in["D_skip"],
        "B_x": _B_in["x"],
        "B_w_gate": _B_in["w_gate"],
        "B_w_up": _B_in["w_up"],
        "B_w_down": _B_in["w_down"],
    }

def reference(A_u, A_log_A_real, A_A_imag, A_C_real, A_C_imag, A_log_dt, A_D_skip, B_x, B_w_gate, B_w_up, B_w_down):
    def _A_ref(u, log_A_real, A_imag, C_real, C_imag, log_dt, D_skip):
        L = u.shape[1]
        dt = torch.exp(log_dt)
        A = -torch.exp(log_A_real) + 1j * A_imag
        C = (C_real + 1j * C_imag) * dt[:, None]
        pos = (lambda x, dt: x.to(dt))(torch.arange(L), log_dt.dtype)
        P = torch.exp((A * dt[:, None])[:, :, None] * pos[None, None, :])
        K = 2.0 * torch.einsum("dn,dnl->dl", C, P).real
        L2 = 2 * L
        u_t = (lambda x, *d: x.permute(*d))(u, 0, 2, 1)
        Kf = (lambda x, *a, **k: torch.fft.rfft(x.float(), *a, **k))(K, L2)
        Uf = (lambda x, *a, **k: torch.fft.rfft(x.float(), *a, **k))(u_t, L2)
        y = (lambda x, *a, **k: torch.fft.irfft(x, *a, **k).to(torch.bfloat16))(Uf * Kf[None, :, :], L2)[:, :, :L]
        y = (lambda x, *d: x.permute(*d))(y, 0, 2, 1)
        return y + u * D_skip[None, None, :]

    def _B_ref(x, w_gate, w_up, w_down):
        return (_gelu(x @ w_gate) * (x @ w_up)) @ w_down

    x = A_u
    xn = _layernorm(x, axis=-1)
    s = _A_ref(xn, A_log_A_real, A_A_imag, A_C_real, A_C_imag, A_log_dt, A_D_skip)
    g = _silu(_B_ref(xn, B_w_gate, B_w_up, B_w_down))
    return x + s * g
```

```asm
; @launch kernel=recurrent_scan__ssm_conv_s4d__geglu_ffn__prompt_kernel grid=(256,1,1) block=(256,1,1) lds=163840
.amdgcn_target "amdgcn-amd-amdhsa--gfx950"
.text
.globl recurrent_scan__ssm_conv_s4d__geglu_ffn__prompt_kernel
.p2align 8
.type recurrent_scan__ssm_conv_s4d__geglu_ffn__prompt_kernel,@function
recurrent_scan__ssm_conv_s4d__geglu_ffn__prompt_kernel:
    s_cmp_ge_u32 s2, 256
    s_cbranch_scc1 L_end
    s_getpc_b64 s[88:89]
L_pc:
    s_load_dwordx2 s[4:5], s[0:1], 0
    s_load_dwordx2 s[16:17], s[0:1], 104
    s_load_dwordx2 s[8:9], s[0:1], 64
    s_load_dwordx2 s[12:13], s[0:1], 72
    s_load_dwordx4 s[28:31], s[0:1], 8
    s_load_dwordx4 s[32:35], s[0:1], 24
    s_load_dwordx4 s[36:39], s[0:1], 40
    s_load_dwordx4 s[64:67], s[0:1], 80
    v_lshrrev_b32 v2, 6, v0
    v_and_b32 v3, 15, v0
    s_mov_b32 s90, L_codeend - L_pc
    s_mov_b32 s91, 0x20000
    v_lshl_add_u32 v3, v2, 4, v3
    v_readfirstlane_b32 s40, v2
    v_lshlrev_b32 v3, 7, v3
    buffer_load_dword v125, v3, s[88:91], 0 offen offset:256
    v_and_b32 v0, 63, v0
    s_mov_b32 s6, 2621440
    s_mov_b32 s7, s91
    v_lshrrev_b32 v2, 5, v0
    v_and_b32 v3, 31, v0
    v_mul_u32_u24 v2, 0x500, v2
    s_lshl2_add_u32 s54, s2, s40
    v_lshl_add_u32 v2, v3, 3, v2
    s_mulk_i32 s54, 2560
    s_lshr_b32 s49, s2, 3
    s_bfe_u32 s55, s2, 0x20001
    s_and_b32 s42, s2, 1
    s_and_b32 s56, s49, 3
    s_lshr_b32 s83, s49, 2
    s_lshl2_add_u32 s42, s42, s56
    s_mul_i32 s43, s55, 7
    s_add_u32 s43, s43, s83
    s_mul_i32 s45, s42, 27
    s_add_u32 s45, s45, s43
    s_lshr_b32 s63, s40, 1
    s_lshl1_add_u32 s55, s45, s63
    s_lshl_b32 s55, s55, 8
    v_lshl_add_u32 v12, v0, 2, s55
    s_lshl_b32 s55, s45, 2
    v_mov_b32 v13, s55
    s_cmp_lt_u32 s83, 7
    s_cselect_b32 s57, s43, 27
    s_cmp_lt_u32 s57, 27
    s_cselect_b32 s44, 1, 0
    s_waitcnt lgkmcnt(0)
    buffer_load_dwordx2 v[232:233], v2, s[4:7], s54 offen offset:0
    buffer_load_dwordx2 v[234:235], v2, s[4:7], s54 offen offset:256
    buffer_load_dwordx2 v[236:237], v2, s[4:7], s54 offen offset:512
    buffer_load_dwordx2 v[238:239], v2, s[4:7], s54 offen offset:768
    buffer_load_dwordx2 v[240:241], v2, s[4:7], s54 offen offset:1024
    s_cbranch_scc0 L_spare
    global_load_dword a160, v12, s[28:29] nt
    global_load_dword a161, v12, s[30:31] nt
    global_load_dword a162, v12, s[32:33] nt
    global_load_dword a163, v12, s[34:35] nt
    global_load_dword a164, v13, s[36:37]
    global_load_dword a165, v13, s[38:39]
    s_mul_i32 s55, s83, 37
    s_mul_i32 s57, s40, 10
    s_lshl_b32 s58, s42, 8
    s_add_u32 s55, s55, s57
    s_add_u32 s55, s55, s58
    v_min_u32 v4, 9, v0
    s_mulk_i32 s55, 1280
    v_mul_u32_u24 v4, 0x500, v4
    s_cmp_eq_u32 s63, 0
    s_cselect_b32 s96, s8, s12
    s_cselect_b32 s97, s9, s13
    buffer_load_dword v126, v4, s[4:7], s55 offen offset:0
    buffer_load_dword v126, v4, s[4:7], s55 offen offset:128
    buffer_load_dword v126, v4, s[4:7], s55 offen offset:256
    s_and_b32 s55, s40, 1
    s_lshl1_add_u32 s55, s56, s55
    v_min_u32 v5, 23, v0
    s_mul_i32 s55, s55, 82944
    s_lshl_b32 s57, s43, 7
    v_mul_u32_u24 v5, 3456, v5
    s_add_u32 s55, s55, s57
    s_mov_b32 s98, 2211840
    s_mov_b32 s99, 0x20000
    buffer_load_dword v126, v5, s[96:99], s55 offen
    v_lshrrev_b32 v4, 3, v0
    v_and_b32 v5, 7, v0
    v_lshrrev_b32 v6, 4, v0
    v_mul_u32_u24 v7, 3456, v4
    v_and_b32 v8, 1, v6
    v_lshlrev_b32 v8, 1, v8
    v_xor_b32 v8, v5, v8
    v_lshl_add_u32 v24, v8, 4, v7
    s_lshl_b32 s51, s40, 11
    s_mul_i32 s53, s40, 55296
    s_lshl_b32 s55, s43, 7
    s_add_u32 s53, s53, s55
    v_xor_b32 v8, 4, v8
    v_lshl_add_u32 v8, v8, 4, v7
    v_add_u32 v25, 26624, v8
    s_mov_b32 s10, 2211840
    s_mov_b32 s11, 0x20000
    s_mov_b32 s14, s10
    s_mov_b32 s15, 0x20000
    v_mul_u32_u24 v7, 1280, v4
    v_xor_b32 v8, v5, v6
    v_xor_b32 v9, 4, v8
    v_lshl_add_u32 v16, v8, 4, v7
    v_lshl_add_u32 v17, v9, 4, v7
    v_add_u32 v17, 9216, v17
    s_lshl2_add_u32 s52, s42, s40
    s_mul_i32 s52, s52, 81920
    s_lshl_b32 s50, s40, 13
    s_add_u32 s50, s50, 16384
    v_add_u32 v18, 18432, v16
    v_add_u32 v19, 18432, v17
    v_add_u32 v20, 22528, v18
    v_add_u32 v21, 22528, v19
    v_add_u32 v22, 18432, v20
    v_add_u32 v23, 18432, v21
    s_and_b32 s48, s2, 7
    s_mov_b64 s[24:25], s[64:65]
    s_mov_b64 s[20:21], s[66:67]
    v_lshlrev_b32 v1, 4, v0
    s_mov_b32 s18, 15007744
    s_mov_b32 s19, 0x20000
    v_mov_b32 v121, 2147418112
    v_writelane_b32 v121, 0, 0
    s_mov_b32 s22, 2621440
    s_mov_b32 s23, 0x20000
    s_mov_b32 s26, 2211840
    s_mov_b32 s27, 0x20000
    s_lshl_b32 s58, s48, 2
    s_and_b32 s56, s49, 3
    s_lshr_b32 s82, s48, 1
    s_and_b32 s56, s49, 7
    s_lshl3_add_u32 s82, s82, s56
    s_and_b32 s56, s48, 1
    s_lshr_b32 s83, s49, 3
    s_lshl2_add_u32 s83, s56, s83
    s_add_u32 s58, s58, s49
    s_sub_u32 s58, s58, 28
    s_lshl_b32 s59, s48, 3
    s_add_u32 s59, s59, s49
    s_sub_u32 s59, s59, 48
    s_cmp_lt_u32 s48, 6
    s_cselect_b32 s47, s58, s59
    s_mul_i32 s58, s42, 27
    s_add_u32 s58, s58, s43
    s_add_u32 s59, s47, 216
    s_cmp_lg_u32 s44, 0
    s_cselect_b32 s45, s58, s59
    s_cmp_lt_u32 s47, 24
    s_cselect_b32 s46, 3, 2
    s_and_b32 s62, s40, 1
    s_lshr_b32 s63, s40, 1
    v_lshlrev_b32 v10, 21, v0
    v_mov_b32 v118, v1
    v_mov_b32 v119, v1
    v_mul_u32_u24 v54, 3456, v4
    v_lshl_add_u32 v54, v5, 4, v54
    s_lshl_b32 s64, s42, 1
    s_add_u32 s64, s64, s62
    s_mul_i32 s64, s64, 138240
    s_lshl_b32 s55, s43, 7
    s_add_u32 s64, s64, s55
    s_mov_b32 s98, 2211840
    s_mov_b32 s99, 0x20000
    s_cmp_eq_u32 s63, 0
    s_cselect_b32 s96, s8, s12
    s_cselect_b32 s97, s9, s13
    s_lshl_b32 s55, s49, 2
    s_add_u32 s55, s55, s40
    s_mul_i32 s55, s55, 768
    s_add_u32 s55, s55, 8448
    v_min_u32 v11, 5, v0
    v_lshlrev_b32 v11, 7, v11
    s_mov_b32 s46, 1
    s_mov_b32 s65, s55
    v_mov_b32 v14, v10
    v_mov_b32 v15, v11
    s_mul_i32 s3, s63, 2624
    s_add_u32 s3, s3, 157700
    v_lshrrev_b32 v4, 4, v0
    s_lshl_b32 s1, s62, 2
    v_add_u32 v4, s1, v4
    v_and_b32 v5, 15, v0
    v_cmp_eq_u32 s[54:55], 2, v4
    v_cmp_eq_u32 s[56:57], 3, v4
    v_cmp_eq_u32 s[58:59], 4, v4
    v_cmp_lt_u32 vcc, 4, v4
    v_mov_b32 v6, 8
    v_cndmask_b32 v6, v6, 4, s[54:55]
    v_cndmask_b32 v6, v6, 2, s[56:57]
    v_cndmask_b32 v6, v6, 1, s[58:59]
    v_cndmask_b32 v6, v6, 0, vcc
    v_mul_u32_u24 v7, v6, v5
    v_lshlrev_b32 v8, 4, v6
    v_lshl_add_u32 v9, v4, 2, 0
    v_mov_b32 v10, 256
    v_cndmask_b32 v9, v9, v10, s[54:55]
    v_mov_b32 v10, 384
    v_cndmask_b32 v9, v9, v10, s[56:57]
    v_mov_b32 v10, 512
    v_cndmask_b32 v9, v9, v10, s[58:59]
    v_mov_b32 v10, 645
    v_cndmask_b32 v9, v9, v10, vcc
    v_add_u32 v9, v9, v7
    v_add_u32 v11, v9, v8
    v_lshl_add_u32 v6, v4, 4, v5
    v_mov_b32 v10, 80
    v_cmp_eq_u32 s[60:61], v10, v6
    v_mov_b32 v10, 640
    s_nop 0
    v_cndmask_b32 v9, v9, v10, s[60:61]
    v_lshl_add_u32 v9, v9, 2, s3
    v_accvgpr_write_b32 a224, v9
    v_lshl_add_u32 v11, v11, 2, s3
    v_accvgpr_write_b32 a228, v11
    v_lshl_add_u32 v9, v4, 2, 1
    v_mov_b32 v10, 257
    v_cndmask_b32 v9, v9, v10, s[54:55]
    v_mov_b32 v10, 385
    v_cndmask_b32 v9, v9, v10, s[56:57]
    v_mov_b32 v10, 544
    v_cndmask_b32 v9, v9, v10, s[58:59]
    v_mov_b32 v10, 645
    v_cndmask_b32 v9, v9, v10, vcc
    v_add_u32 v9, v9, v7
    v_add_u32 v11, v9, v8
    v_lshl_add_u32 v9, v9, 2, s3
    v_accvgpr_write_b32 a225, v9
    v_lshl_add_u32 v11, v11, 2, s3
    v_accvgpr_write_b32 a229, v11
    v_lshl_add_u32 v9, v4, 2, 2
    v_mov_b32 v10, 258
    v_cndmask_b32 v9, v9, v10, s[54:55]
    v_mov_b32 v10, 448
    v_cndmask_b32 v9, v9, v10, s[56:57]
    v_mov_b32 v10, 576
    v_cndmask_b32 v9, v9, v10, s[58:59]
    v_mov_b32 v10, 645
    v_cndmask_b32 v9, v9, v10, vcc
    v_add_u32 v9, v9, v7
    v_add_u32 v11, v9, v8
    v_lshl_add_u32 v9, v9, 2, s3
    v_accvgpr_write_b32 a226, v9
    v_lshl_add_u32 v11, v11, 2, s3
    v_accvgpr_write_b32 a230, v11
    v_lshl_add_u32 v9, v4, 2, 3
    v_mov_b32 v10, 259
    v_cndmask_b32 v9, v9, v10, s[54:55]
    v_mov_b32 v10, 449
    v_cndmask_b32 v9, v9, v10, s[56:57]
    v_mov_b32 v10, 608
    v_cndmask_b32 v9, v9, v10, s[58:59]
    v_mov_b32 v10, 645
    v_cndmask_b32 v9, v9, v10, vcc
    v_add_u32 v9, v9, v7
    v_add_u32 v11, v9, v8
    v_lshl_add_u32 v9, v9, 2, s3
    v_accvgpr_write_b32 a227, v9
    v_lshl_add_u32 v11, v11, 2, s3
    v_accvgpr_write_b32 a231, v11
    s_mul_i32 s0, s63, 28832
    s_add_u32 s0, s0, 98304
    v_lshl_add_u32 v2, v0, 3, s0
    v_accvgpr_write_b32 a192, v2
    v_and_b32 v12, 15, v0
    v_lshrrev_b32 v13, 4, v0
    v_mul_u32_u24 v2, 544, v12
    v_lshl_add_u32 v2, v13, 4, v2
    v_add_u32 v3, s0, v2
    v_accvgpr_write_b32 a194, v3
    s_mul_i32 s1, s62, 8704
    v_add_u32 v3, s1, v3
    v_accvgpr_write_b32 a193, v3
    s_mul_i32 s3, s63, 2624
    s_add_u32 s3, s3, 157696
    v_mov_b32 v2, s3
    v_accvgpr_write_b32 a198, v2
    s_mov_b32 s87, 0
    v_accvgpr_read_b32 v224, a224
    v_accvgpr_read_b32 v225, a225
    v_accvgpr_read_b32 v226, a226
    v_accvgpr_read_b32 v227, a227
    v_accvgpr_read_b32 v228, a228
    v_accvgpr_read_b32 v229, a229
    v_accvgpr_read_b32 v230, a230
    v_accvgpr_read_b32 v231, a231
    v_accvgpr_read_b32 v46, a193
    v_accvgpr_read_b32 v47, a194
    v_accvgpr_read_b32 v51, a198
    s_mov_b32 s55, s65
    v_mov_b32 v10, v14
    v_mov_b32 v11, v15
    buffer_load_dword v120, v121, s[16:19], 0 offen sc1
    buffer_load_dword v124, v11, s[88:91], s55 offen
    s_waitcnt vmcnt(12)
    v_lshlrev_b32 v140, 16, v232
    v_and_b32 v141, 0xffff0000, v232
    v_lshlrev_b32 v142, 16, v233
    v_and_b32 v143, 0xffff0000, v233
    v_lshlrev_b32 v144, 16, v234
    v_and_b32 v145, 0xffff0000, v234
    v_lshlrev_b32 v146, 16, v235
    v_and_b32 v147, 0xffff0000, v235
    v_lshlrev_b32 v148, 16, v236
    v_and_b32 v149, 0xffff0000, v236
    v_lshlrev_b32 v150, 16, v237
    v_and_b32 v151, 0xffff0000, v237
    v_lshlrev_b32 v152, 16, v238
    v_and_b32 v153, 0xffff0000, v238
    v_lshlrev_b32 v154, 16, v239
    v_and_b32 v155, 0xffff0000, v239
    s_add_u32 m0, s51, 0
    v_lshlrev_b32 v156, 16, v240
    buffer_load_dwordx4 v24, s[8:11], s53 offen lds
    v_and_b32 v157, 0xffff0000, v240
    v_lshlrev_b32 v158, 16, v241
    v_and_b32 v159, 0xffff0000, v241
    v_pk_add_f32 v[160:161], v[140:141], v[142:143]
    v_pk_add_f32 v[162:163], v[144:145], v[146:147]
    v_pk_add_f32 v[160:161], v[160:161], v[148:149]
    v_pk_add_f32 v[162:163], v[162:163], v[150:151]
    v_pk_add_f32 v[160:161], v[160:161], v[152:153]
    v_pk_add_f32 v[162:163], v[162:163], v[154:155]
    v_pk_add_f32 v[160:161], v[160:161], v[156:157]
    v_pk_add_f32 v[162:163], v[162:163], v[158:159]
    v_pk_add_f32 v[160:161], v[160:161], v[162:163]
    v_add_f32 v160, v160, v161
    s_nop 1
    v_add_f32 v160, v160, v160 quad_perm:[1,0,3,2]
    s_nop 1
    buffer_load_dwordx4 v25, s[8:11], s53 offen offset:1024 lds
    v_add_f32 v160, v160, v160 quad_perm:[2,3,0,1]
    s_nop 1
    v_add_f32 v160, v160, v160 row_half_mirror
    s_nop 1
    v_add_f32 v160, v160, v160 row_mirror
    v_mov_b32 v161, v160
    s_nop 1
    v_permlane16_swap_b32 v160, v161
    s_nop 0
    v_add_f32 v160, v160, v161
    v_mul_f32 v160, 0x3acccccd, v160
    v_pk_add_f32 v[164:165], v[140:141], v[160:161] op_sel_hi:[1,0] neg_lo:[0,1] neg_hi:[0,1]
    v_pk_add_f32 v[166:167], v[142:143], v[160:161] op_sel_hi:[1,0] neg_lo:[0,1] neg_hi:[0,1]
    v_pk_add_f32 v[168:169], v[144:145], v[160:161] op_sel_hi:[1,0] neg_lo:[0,1] neg_hi:[0,1]
    v_pk_add_f32 v[170:171], v[146:147], v[160:161] op_sel_hi:[1,0] neg_lo:[0,1] neg_hi:[0,1]
    v_pk_add_f32 v[172:173], v[148:149], v[160:161] op_sel_hi:[1,0] neg_lo:[0,1] neg_hi:[0,1]
    s_add_u32 m0, s51, 8192
    v_pk_add_f32 v[174:175], v[150:151], v[160:161] op_sel_hi:[1,0] neg_lo:[0,1] neg_hi:[0,1]
    buffer_load_dwordx4 v24, s[12:15], s53 offen lds
    v_pk_add_f32 v[176:177], v[152:153], v[160:161] op_sel_hi:[1,0] neg_lo:[0,1] neg_hi:[0,1]
    v_pk_add_f32 v[178:179], v[154:155], v[160:161] op_sel_hi:[1,0] neg_lo:[0,1] neg_hi:[0,1]
    v_pk_add_f32 v[180:181], v[156:157], v[160:161] op_sel_hi:[1,0] neg_lo:[0,1] neg_hi:[0,1]
    v_pk_add_f32 v[182:183], v[158:159], v[160:161] op_sel_hi:[1,0] neg_lo:[0,1] neg_hi:[0,1]
    v_pk_mul_f32 v[162:163], v[164:165], v[164:165]
    v_pk_mul_f32 v[184:185], v[166:167], v[166:167]
    v_pk_fma_f32 v[162:163], v[168:169], v[168:169], v[162:163]
    v_pk_fma_f32 v[184:185], v[170:171], v[170:171], v[184:185]
    v_pk_fma_f32 v[162:163], v[172:173], v[172:173], v[162:163]
    v_pk_fma_f32 v[184:185], v[174:175], v[174:175], v[184:185]
    v_pk_fma_f32 v[162:163], v[176:177], v[176:177], v[162:163]
    v_pk_fma_f32 v[184:185], v[178:179], v[178:179], v[184:185]
    v_pk_fma_f32 v[162:163], v[180:181], v[180:181], v[162:163]
    v_pk_fma_f32 v[184:185], v[182:183], v[182:183], v[184:185]
    v_pk_add_f32 v[162:163], v[162:163], v[184:185]
    v_add_f32 v162, v162, v163
    buffer_load_dwordx4 v25, s[12:15], s53 offen offset:1024 lds
    s_nop 1
    v_add_f32 v162, v162, v162 quad_perm:[1,0,3,2]
    s_nop 1
    v_add_f32 v162, v162, v162 quad_perm:[2,3,0,1]
    s_nop 1
    v_add_f32 v162, v162, v162 row_half_mirror
    s_nop 1
    v_add_f32 v162, v162, v162 row_mirror
    v_mov_b32 v163, v162
    s_nop 1
    v_permlane16_swap_b32 v162, v163
    s_nop 0
    v_add_f32 v162, v162, v163
    v_mul_f32 v162, 0x3acccccd, v162
    v_cvt_pk_bf16_f32 v162, v162, v162
    v_lshlrev_b32 v162, 16, v162
    s_add_u32 m0, s50, 0
    v_add_f32 v162, 0x3727c5ac, v162
    buffer_load_dwordx4 v16, s[4:7], s52 offen lds
    v_cvt_pk_bf16_f32 v162, v162, v162
    v_lshlrev_b32 v162, 16, v162
    v_sqrt_f32 v162, v162
    v_cvt_pk_bf16_f32 v160, v160, v160
    v_lshlrev_b32 v160, 16, v160
    v_cvt_pk_bf16_f32 v162, v162, v162
    v_lshlrev_b32 v162, 16, v162
    v_rcp_f32 v163, v162
    v_sub_f32 v184, 0, v160
    v_mul_f32 v187, v162, v162
    v_mul_f32 v161, v163, v163
    v_mul_f32 v186, 0xc0135761, v163
    v_mul_f32 v161, v161, v163
    v_mul_f32 v162, v184, v163
    v_mul_f32 v185, 0xbdd2d3e8, v161
    v_pk_fma_f32 v[164:165], v[140:141], v[162:163], v[162:163] op_sel:[0,1,0] op_sel_hi:[1,1,0]
    buffer_load_dwordx4 v17, s[4:7], s52 offen offset:1024 lds
    v_pk_fma_f32 v[166:167], v[142:143], v[162:163], v[162:163] op_sel:[0,1,0] op_sel_hi:[1,1,0]
    v_pk_fma_f32 v[168:169], v[144:145], v[162:163], v[162:163] op_sel:[0,1,0] op_sel_hi:[1,1,0]
    v_pk_fma_f32 v[170:171], v[146:147], v[162:163], v[162:163] op_sel:[0,1,0] op_sel_hi:[1,1,0]
    v_pk_fma_f32 v[172:173], v[148:149], v[162:163], v[162:163] op_sel:[0,1,0] op_sel_hi:[1,1,0]
    v_pk_fma_f32 v[174:175], v[150:151], v[162:163], v[162:163] op_sel:[0,1,0] op_sel_hi:[1,1,0]
    v_pk_fma_f32 v[176:177], v[152:153], v[162:163], v[162:163] op_sel:[0,1,0] op_sel_hi:[1,1,0]
    v_pk_fma_f32 v[178:179], v[154:155], v[162:163], v[162:163] op_sel:[0,1,0] op_sel_hi:[1,1,0]
    v_pk_fma_f32 v[180:181], v[156:157], v[162:163], v[162:163] op_sel:[0,1,0] op_sel_hi:[1,1,0]
    v_pk_fma_f32 v[182:183], v[158:159], v[162:163], v[162:163] op_sel:[0,1,0] op_sel_hi:[1,1,0]
    v_cvt_pk_f16_f32 v188, v164, v165
    v_cvt_pk_f16_f32 v189, v166, v167
    v_cvt_pk_f16_f32 v190, v168, v169
    v_cvt_pk_f16_f32 v191, v170, v171
    v_cvt_pk_f16_f32 v192, v172, v173
    v_cvt_pk_f16_f32 v193, v174, v175
    v_cvt_pk_f16_f32 v194, v176, v177
    buffer_load_dwordx4 v18, s[4:7], s52 offen offset:2048 lds
    v_cvt_pk_f16_f32 v195, v178, v179
    v_cvt_pk_f16_f32 v196, v180, v181
    v_cvt_pk_f16_f32 v197, v182, v183
    v_lshrrev_b32 v2, 5, v0
    v_mul_u32_u24 v2, 1344, v2
    v_and_b32 v3, 31, v0
    v_lshl_add_u32 v2, v3, 3, v2
    s_mul_i32 s55, s40, 2688
    s_add_u32 s55, s55, 98304
    v_add_u32 v2, s55, v2
    ds_write_b64 v2, v[188:189] offset:0
    ds_write_b64 v2, v[190:191] offset:256
    ds_write_b64 v2, v[192:193] offset:512
    ds_write_b64 v2, v[194:195] offset:768
    ds_write_b64 v2, v[196:197] offset:1024
    v_lshrrev_b32 v4, 1, v0
    buffer_load_dwordx4 v19, s[4:7], s52 offen offset:3072 lds
    v_mov_b32 v5, 2147418112
    v_cmp_ne_u32 vcc, 0, v3
    s_lshl_b32 s55, s2, 2
    s_add_u32 s55, s55, s40
    v_cndmask_b32 v4, v4, v5, vcc
    s_lshl_b32 s55, s55, 5
    s_add_u32 s55, s55, 32768
    v_bfe_u32 v6, v0, 2, 2
    v_mul_u32_u24 v2, 1344, v6
    v_lshrrev_b32 v3, 4, v0
    v_lshl_add_u32 v2, v3, 5, v2
    v_and_b32 v7, 3, v0
    v_lshl_add_u32 v2, v7, 3, v2
    s_lshl_b32 s56, s40, 7
    s_add_u32 s56, s56, 98304
    v_add_u32 v2, s56, v2
    buffer_store_dwordx4 v[184:187], v4, s[16:19], s55 offen sc1
    s_waitcnt lgkmcnt(0)
    s_barrier
    ds_read_b64_tr_b16 v[200:201], v2 offset:0
    ds_read_b64_tr_b16 v[202:203], v2 offset:5376
    ds_read_b64_tr_b16 v[204:205], v2 offset:512
    ds_read_b64_tr_b16 v[206:207], v2 offset:5888
    ds_read_b64_tr_b16 v[208:209], v2 offset:1024
    ds_read_b64_tr_b16 v[210:211], v2 offset:6400
    s_mul_i32 s55, s2, 10240
    s_lshl_b32 s56, s40, 10
    s_add_u32 s55, s55, s56
    s_add_u32 s55, s55, 65536
    s_add_u32 s56, s55, 4096
    s_add_u32 s57, s55, 8192
    s_cmp_lt_u32 s40, 2
    s_cselect_b32 s57, s57, 2147418112
    s_waitcnt lgkmcnt(4)
    buffer_store_dwordx4 v[200:203], v1, s[16:19], s55 offen sc1
    s_waitcnt lgkmcnt(2)
    buffer_store_dwordx4 v[204:207], v1, s[16:19], s56 offen sc1
    s_waitcnt lgkmcnt(0)
    buffer_store_dwordx4 v[208:211], v1, s[16:19], s57 offen sc1
    s_waitcnt vmcnt(13)
    v_readfirstlane_b32 s41, v120
    s_nop 3
    s_mul_i32 s41, s41, 1664525
    s_add_u32 s41, s41, 1013904223
    v_mov_b32 v120, s41
    s_lshl_b32 s57, s2, 2
    s_add_u32 s57, s57, 4096
    s_cmp_eq_u32 s40, 0
    s_cselect_b32 s57, s57, 2147418112
    s_barrier
    v_accvgpr_read_b32 v116, a164
    v_accvgpr_read_b32 v117, a165
    v_accvgpr_read_b32 v112, a160
    v_accvgpr_read_b32 v113, a161
    v_accvgpr_read_b32 v114, a162
    v_accvgpr_read_b32 v115, a163
    v_accvgpr_read_b32 v134, a192
    s_lshl_b32 s55, s63, 4
    v_lshrrev_b32 v128, s55, v116
    v_lshlrev_b32 v128, 16, v128
    v_mul_f32 v128, 0x3fb8aa3b, v128
    v_exp_f32 v128, v128
    v_lshrrev_b32 v135, s55, v117
    v_lshlrev_b32 v135, 16, v135
    v_cvt_pk_bf16_f32 v128, v128, v128
    v_lshlrev_b32 v128, 16, v128
    v_lshlrev_b32 v130, 16, v112
    v_and_b32 v131, 0xffff0000, v112
    v_mul_f32 v130, 0x3fb8aa3b, v130
    v_mul_f32 v131, 0x3fb8aa3b, v131
    v_exp_f32 v130, v130
    v_exp_f32 v131, v131
    v_lshlrev_b32 v132, 16, v113
    v_and_b32 v133, 0xffff0000, v113
    v_cvt_pk_bf16_f32 v129, v130, v131
    v_lshlrev_b32 v152, 16, v114
    v_lshlrev_b32 v153, 16, v115
    v_and_b32 v154, 0xffff0000, v114
    v_and_b32 v155, 0xffff0000, v115
    v_lshlrev_b32 v130, 16, v129
    v_and_b32 v131, 0xffff0000, v129
    v_mul_f32 v130, v130, v128
    v_mul_f32 v132, v132, v128
    v_mul_f32 v131, v131, v128
    v_mul_f32 v133, v133, v128
    v_mul_f32 v130, 0xbfb8aa3b, v130
    v_mul_f32 v132, 0x3e22f983, v132
    v_mul_f32 v131, 0xbfb8aa3b, v131
    v_mul_f32 v133, 0x3e22f983, v133
    s_cmp_lg_u32 s62, 0
    s_cbranch_scc1 L_role1g
    v_add_u32 v134, 11424, v134
    v_mul_f32 v136, 0x41000000, v130
    v_mul_f32 v138, 0x41000000, v132
    v_mul_f32 v137, 0x41000000, v131
    v_mul_f32 v139, 0x41000000, v133
    v_fract_f32 v138, v138
    v_fract_f32 v139, v139
    v_exp_f32 v136, v136
    v_cos_f32 v152, v138
    v_sin_f32 v153, v138
    v_exp_f32 v137, v137
    s_add_u32 m0, s50, 4096
    v_cos_f32 v154, v139
    buffer_load_dwordx4 v20, s[4:7], s52 offen lds
    v_sin_f32 v155, v139
    s_nop 0
    .p2align 3
    v_pk_mul_f32 v[152:153], v[152:153], v[136:137] op_sel:[0,0] op_sel_hi:[1,0]
    v_pk_mul_f32 v[154:155], v[154:155], v[136:137] op_sel:[0,1] op_sel_hi:[1,1]
    v_mov_b32 v144, 0x3c00
    v_mov_b32 v145, 0x3c00
    v_pk_mul_f32 v[136:137], v[152:153], v[152:153] op_sel_hi:[0,1]
    v_pk_mul_f32 v[138:139], v[154:155], v[154:155] op_sel_hi:[0,1]
    v_pk_fma_f32 v[156:157], v[152:153], v[152:153], v[136:137] op_sel:[1,1,0] op_sel_hi:[1,0,1] neg_lo:[0,1,0]
    v_pk_fma_f32 v[158:159], v[154:155], v[154:155], v[138:139] op_sel:[1,1,0] op_sel_hi:[1,0,1] neg_lo:[0,1,0]
    v_cvt_pk_f16_f32 v146, v152, v153
    buffer_load_dwordx4 v21, s[4:7], s52 offen offset:1024 lds
    v_cvt_pk_f16_f32 v147, v154, v155
    ds_write2_b64 v134, v[144:145], v[146:147] offset0:0 offset1:68
    v_pk_mul_f32 v[140:141], v[152:153], v[156:157] op_sel_hi:[0,1]
    v_pk_mul_f32 v[142:143], v[154:155], v[158:159] op_sel_hi:[0,1]
    v_pk_fma_f32 v[172:173], v[152:153], v[156:157], v[140:141] op_sel:[1,1,0] op_sel_hi:[1,0,1] neg_lo:[0,1,0]
    v_pk_fma_f32 v[174:175], v[154:155], v[158:159], v[142:143] op_sel:[1,1,0] op_sel_hi:[1,0,1] neg_lo:[0,1,0]
    v_cvt_pk_f16_f32 v148, v156, v157
    v_cvt_pk_f16_f32 v149, v158, v159
    v_cvt_pk_f16_f32 v150, v172, v173
    v_cvt_pk_f16_f32 v151, v174, v175
    ds_write2_b64 v134, v[148:149], v[150:151] offset0:136 offset1:204
    buffer_load_dwordx4 v22, s[4:7], s52 offen offset:2048 lds
    v_add_u32 v134, 2176, v134
    v_pk_mul_f32 v[136:137], v[156:157], v[156:157] op_sel_hi:[0,1]
    v_pk_mul_f32 v[140:141], v[172:173], v[156:157] op_sel_hi:[0,1]
    v_pk_mul_f32 v[138:139], v[158:159], v[158:159] op_sel_hi:[0,1]
    v_pk_mul_f32 v[142:143], v[174:175], v[158:159] op_sel_hi:[0,1]
    v_pk_fma_f32 v[160:161], v[156:157], v[156:157], v[136:137] op_sel:[1,1,0] op_sel_hi:[1,0,1] neg_lo:[0,1,0]
    v_pk_fma_f32 v[168:169], v[172:173], v[156:157], v[140:141] op_sel:[1,1,0] op_sel_hi:[1,0,1] neg_lo:[0,1,0]
    v_pk_fma_f32 v[162:163], v[158:159], v[158:159], v[138:139] op_sel:[1,1,0] op_sel_hi:[1,0,1] neg_lo:[0,1,0]
    v_pk_fma_f32 v[170:171], v[174:175], v[158:159], v[142:143] op_sel:[1,1,0] op_sel_hi:[1,0,1] neg_lo:[0,1,0]
    v_cvt_pk_f16_f32 v144, v160, v161
    v_cvt_pk_f16_f32 v145, v162, v163
    buffer_load_dwordx4 v23, s[4:7], s52 offen offset:3072 lds
    v_cvt_pk_f16_f32 v146, v168, v169
    v_cvt_pk_f16_f32 v147, v170, v171
    ds_write2_b64 v134, v[144:145], v[146:147] offset0:0 offset1:68
    v_pk_mul_f32 v[136:137], v[160:161], v[156:157] op_sel_hi:[0,1]
    v_pk_mul_f32 v[140:141], v[168:169], v[156:157] op_sel_hi:[0,1]
    v_pk_mul_f32 v[138:139], v[162:163], v[158:159] op_sel_hi:[0,1]
    v_pk_mul_f32 v[142:143], v[170:171], v[158:159] op_sel_hi:[0,1]
    v_pk_fma_f32 v[164:165], v[160:161], v[156:157], v[136:137] op_sel:[1,1,0] op_sel_hi:[1,0,1] neg_lo:[0,1,0]
    v_pk_fma_f32 v[172:173], v[168:169], v[156:157], v[140:141] op_sel:[1,1,0] op_sel_hi:[1,0,1] neg_lo:[0,1,0]
    v_pk_fma_f32 v[166:167], v[162:163], v[158:159], v[138:139] op_sel:[1,1,0] op_sel_hi:[1,0,1] neg_lo:[0,1,0]
    v_pk_fma_f32 v[174:175], v[170:171], v[158:159], v[142:143] op_sel:[1,1,0] op_sel_hi:[1,0,1] neg_lo:[0,1,0]
    s_add_u32 s52, s52, 128
    v_cvt_pk_f16_f32 v148, v164, v165
    s_add_u32 s53, s53, 221184
    v_cvt_pk_f16_f32 v149, v166, v167
    s_add_u32 m0, s51, 49152
    v_cvt_pk_f16_f32 v150, v172, v173
    buffer_load_dwordx4 v24, s[8:11], s53 offen lds
    v_cvt_pk_f16_f32 v151, v174, v175
    ds_write2_b64 v134, v[148:149], v[150:151] offset0:136 offset1:204
    v_add_u32 v134, 2176, v134
    v_pk_mul_f32 v[136:137], v[164:165], v[156:157] op_sel_hi:[0,1]
    v_pk_mul_f32 v[140:141], v[172:173], v[156:157] op_sel_hi:[0,1]
    v_pk_mul_f32 v[138:139], v[166:167], v[158:159] op_sel_hi:[0,1]
    v_pk_mul_f32 v[142:143], v[174:175], v[158:159] op_sel_hi:[0,1]
    v_pk_fma_f32 v[160:161], v[164:165], v[156:157], v[136:137] op_sel:[1,1,0] op_sel_hi:[1,0,1] neg_lo:[0,1,0]
    v_pk_fma_f32 v[168:169], v[172:173], v[156:157], v[140:141] op_sel:[1,1,0] op_sel_hi:[1,0,1] neg_lo:[0,1,0]
    v_pk_fma_f32 v[162:163], v[166:167], v[158:159], v[138:139] op_sel:[1,1,0] op_sel_hi:[1,0,1] neg_lo:[0,1,0]
    v_pk_fma_f32 v[170:171], v[174:175], v[158:159], v[142:143] op_sel:[1,1,0] op_sel_hi:[1,0,1] neg_lo:[0,1,0]
    buffer_load_dwordx4 v25, s[8:11], s53 offen offset:1024 lds
    v_cvt_pk_f16_f32 v144, v160, v161
    v_cvt_pk_f16_f32 v145, v162, v163
    v_cvt_pk_f16_f32 v146, v168, v169
    v_cvt_pk_f16_f32 v147, v170, v171
    ds_write2_b64 v134, v[144:145], v[146:147] offset0:0 offset1:68
    v_pk_mul_f32 v[136:137], v[160:161], v[156:157] op_sel_hi:[0,1]
    v_pk_mul_f32 v[140:141], v[168:169], v[156:157] op_sel_hi:[0,1]
    v_pk_mul_f32 v[138:139], v[162:163], v[158:159] op_sel_hi:[0,1]
    v_pk_mul_f32 v[142:143], v[170:171], v[158:159] op_sel_hi:[0,1]
    v_pk_fma_f32 v[164:165], v[160:161], v[156:157], v[136:137] op_sel:[1,1,0] op_sel_hi:[1,0,1] neg_lo:[0,1,0]
    v_pk_fma_f32 v[172:173], v[168:169], v[156:157], v[140:141] op_sel:[1,1,0] op_sel_hi:[1,0,1] neg_lo:[0,1,0]
    s_add_u32 m0, s51, 57344
    v_pk_fma_f32 v[166:167], v[162:163], v[158:159], v[138:139] op_sel:[1,1,0] op_sel_hi:[1,0,1] neg_lo:[0,1,0]
    buffer_load_dwordx4 v24, s[12:15], s53 offen lds
    v_pk_fma_f32 v[174:175], v[170:171], v[158:159], v[142:143] op_sel:[1,1,0] op_sel_hi:[1,0,1] neg_lo:[0,1,0]
    v_cvt_pk_f16_f32 v148, v164, v165
    v_cvt_pk_f16_f32 v149, v166, v167
    v_cvt_pk_f16_f32 v150, v172, v173
    v_cvt_pk_f16_f32 v151, v174, v175
    ds_write2_b64 v134, v[148:149], v[150:151] offset0:136 offset1:204
    v_add_u32 v134, 2176, v134
    v_pk_mul_f32 v[136:137], v[164:165], v[156:157] op_sel_hi:[0,1]
    v_pk_mul_f32 v[140:141], v[172:173], v[156:157] op_sel_hi:[0,1]
    v_pk_mul_f32 v[138:139], v[166:167], v[158:159] op_sel_hi:[0,1]
    v_pk_mul_f32 v[142:143], v[174:175], v[158:159] op_sel_hi:[0,1]
    buffer_load_dwordx4 v25, s[12:15], s53 offen offset:1024 lds
    v_pk_fma_f32 v[160:161], v[164:165], v[156:157], v[136:137] op_sel:[1,1,0] op_sel_hi:[1,0,1] neg_lo:[0,1,0]
    v_pk_fma_f32 v[168:169], v[172:173], v[156:157], v[140:141] op_sel:[1,1,0] op_sel_hi:[1,0,1] neg_lo:[0,1,0]
    v_pk_fma_f32 v[162:163], v[166:167], v[158:159], v[138:139] op_sel:[1,1,0] op_sel_hi:[1,0,1] neg_lo:[0,1,0]
    v_pk_fma_f32 v[170:171], v[174:175], v[158:159], v[142:143] op_sel:[1,1,0] op_sel_hi:[1,0,1] neg_lo:[0,1,0]
    v_cvt_pk_f16_f32 v144, v160, v161
    v_cvt_pk_f16_f32 v145, v162, v163
    v_cvt_pk_f16_f32 v146, v168, v169
    v_cvt_pk_f16_f32 v147, v170, v171
    ds_write2_b64 v134, v[144:145], v[146:147] offset0:0 offset1:68
    v_pk_mul_f32 v[136:137], v[160:161], v[156:157] op_sel_hi:[0,1]
    v_pk_mul_f32 v[140:141], v[168:169], v[156:157] op_sel_hi:[0,1]
    s_add_u32 m0, s50, 49152
    v_pk_mul_f32 v[138:139], v[162:163], v[158:159] op_sel_hi:[0,1]
    buffer_load_dwordx4 v16, s[4:7], s52 offen lds
    v_pk_mul_f32 v[142:143], v[170:171], v[158:159] op_sel_hi:[0,1]
    v_pk_fma_f32 v[164:165], v[160:161], v[156:157], v[136:137] op_sel:[1,1,0] op_sel_hi:[1,0,1] neg_lo:[0,1,0]
    v_pk_fma_f32 v[172:173], v[168:169], v[156:157], v[140:141] op_sel:[1,1,0] op_sel_hi:[1,0,1] neg_lo:[0,1,0]
    v_pk_fma_f32 v[166:167], v[162:163], v[158:159], v[138:139] op_sel:[1,1,0] op_sel_hi:[1,0,1] neg_lo:[0,1,0]
    v_pk_fma_f32 v[174:175], v[170:171], v[158:159], v[142:143] op_sel:[1,1,0] op_sel_hi:[1,0,1] neg_lo:[0,1,0]
    v_cvt_pk_f16_f32 v148, v164, v165
    v_cvt_pk_f16_f32 v149, v166, v167
    v_cvt_pk_f16_f32 v150, v172, v173
    v_cvt_pk_f16_f32 v151, v174, v175
    ds_write2_b64 v134, v[148:149], v[150:151] offset0:136 offset1:204
    v_add_u32 v134, 2176, v134
    buffer_load_dwordx4 v17, s[4:7], s52 offen offset:1024 lds
    v_pk_mul_f32 v[136:137], v[164:165], v[156:157] op_sel_hi:[0,1]
    v_pk_mul_f32 v[140:141], v[172:173], v[156:157] op_sel_hi:[0,1]
    v_pk_mul_f32 v[138:139], v[166:167], v[158:159] op_sel_hi:[0,1]
    v_pk_mul_f32 v[142:143], v[174:175], v[158:159] op_sel_hi:[0,1]
    v_pk_fma_f32 v[160:161], v[164:165], v[156:157], v[136:137] op_sel:[1,1,0] op_sel_hi:[1,0,1] neg_lo:[0,1,0]
    v_pk_fma_f32 v[168:169], v[172:173], v[156:157], v[140:141] op_sel:[1,1,0] op_sel_hi:[1,0,1] neg_lo:[0,1,0]
    v_pk_fma_f32 v[162:163], v[166:167], v[158:159], v[138:139] op_sel:[1,1,0] op_sel_hi:[1,0,1] neg_lo:[0,1,0]
    v_pk_fma_f32 v[170:171], v[174:175], v[158:159], v[142:143] op_sel:[1,1,0] op_sel_hi:[1,0,1] neg_lo:[0,1,0]
    v_cvt_pk_f16_f32 v144, v160, v161
    v_cvt_pk_f16_f32 v145, v162, v163
    v_cvt_pk_f16_f32 v146, v168, v169
    buffer_load_dwordx4 v18, s[4:7], s52 offen offset:2048 lds
    v_cvt_pk_f16_f32 v147, v170, v171
    ds_write2_b64 v134, v[144:145], v[146:147] offset0:0 offset1:68
    v_pk_mul_f32 v[136:137], v[160:161], v[156:157] op_sel_hi:[0,1]
    v_pk_mul_f32 v[140:141], v[168:169], v[156:157] op_sel_hi:[0,1]
    v_pk_mul_f32 v[138:139], v[162:163], v[158:159] op_sel_hi:[0,1]
    v_pk_mul_f32 v[142:143], v[170:171], v[158:159] op_sel_hi:[0,1]
    v_pk_fma_f32 v[164:165], v[160:161], v[156:157], v[136:137] op_sel:[1,1,0] op_sel_hi:[1,0,1] neg_lo:[0,1,0]
    v_pk_fma_f32 v[172:173], v[168:169], v[156:157], v[140:141] op_sel:[1,1,0] op_sel_hi:[1,0,1] neg_lo:[0,1,0]
    v_pk_fma_f32 v[166:167], v[162:163], v[158:159], v[138:139] op_sel:[1,1,0] op_sel_hi:[1,0,1] neg_lo:[0,1,0]
    v_pk_fma_f32 v[174:175], v[170:171], v[158:159], v[142:143] op_sel:[1,1,0] op_sel_hi:[1,0,1] neg_lo:[0,1,0]
    v_cvt_pk_f16_f32 v148, v164, v165
    buffer_load_dwordx4 v19, s[4:7], s52 offen offset:3072 lds
    v_cvt_pk_f16_f32 v149, v166, v167
    v_cvt_pk_f16_f32 v150, v172, v173
    v_cvt_pk_f16_f32 v151, v174, v175
    ds_write2_b64 v134, v[148:149], v[150:151] offset0:136 offset1:204
    v_add_u32 v134, 2176, v134
    v_pk_mul_f32 v[136:137], v[164:165], v[156:157] op_sel_hi:[0,1]
    v_pk_mul_f32 v[140:141], v[172:173], v[156:157] op_sel_hi:[0,1]
    v_pk_mul_f32 v[138:139], v[166:167], v[158:159] op_sel_hi:[0,1]
    v_pk_mul_f32 v[142:143], v[174:175], v[158:159] op_sel_hi:[0,1]
    v_pk_fma_f32 v[160:161], v[164:165], v[156:157], v[136:137] op_sel:[1,1,0] op_sel_hi:[1,0,1] neg_lo:[0,1,0]
    v_pk_fma_f32 v[168:169], v[172:173], v[156:157], v[140:141] op_sel:[1,1,0] op_sel_hi:[1,0,1] neg_lo:[0,1,0]
    s_add_u32 m0, s50, 53248
    v_pk_fma_f32 v[162:163], v[166:167], v[158:159], v[138:139] op_sel:[1,1,0] op_sel_hi:[1,0,1] neg_lo:[0,1,0]
    buffer_load_dwordx4 v20, s[4:7], s52 offen lds
    v_pk_fma_f32 v[170:171], v[174:175], v[158:159], v[142:143] op_sel:[1,1,0] op_sel_hi:[1,0,1] neg_lo:[0,1,0]
    v_cvt_pk_f16_f32 v144, v160, v161
    v_cvt_pk_f16_f32 v145, v162, v163
    v_cvt_pk_f16_f32 v146, v168, v169
    v_cvt_pk_f16_f32 v147, v170, v171
    ds_write2_b64 v134, v[144:145], v[146:147] offset0:0 offset1:68
    v_pk_mul_f32 v[136:137], v[160:161], v[156:157] op_sel_hi:[0,1]
    v_pk_mul_f32 v[140:141], v[168:169], v[156:157] op_sel_hi:[0,1]
    v_pk_mul_f32 v[138:139], v[162:163], v[158:159] op_sel_hi:[0,1]
    v_pk_mul_f32 v[142:143], v[170:171], v[158:159] op_sel_hi:[0,1]
    v_pk_fma_f32 v[164:165], v[160:161], v[156:157], v[136:137] op_sel:[1,1,0] op_sel_hi:[1,0,1] neg_lo:[0,1,0]
    buffer_load_dwordx4 v21, s[4:7], s52 offen offset:1024 lds
    v_pk_fma_f32 v[172:173], v[168:169], v[156:157], v[140:141] op_sel:[1,1,0] op_sel_hi:[1,0,1] neg_lo:[0,1,0]
    v_pk_fma_f32 v[166:167], v[162:163], v[158:159], v[138:139] op_sel:[1,1,0] op_sel_hi:[1,0,1] neg_lo:[0,1,0]
    v_pk_fma_f32 v[174:175], v[170:171], v[158:159], v[142:143] op_sel:[1,1,0] op_sel_hi:[1,0,1] neg_lo:[0,1,0]
    v_cvt_pk_f16_f32 v148, v164, v165
    v_cvt_pk_f16_f32 v149, v166, v167
    v_cvt_pk_f16_f32 v150, v172, v173
    v_cvt_pk_f16_f32 v151, v174, v175
    ds_write2_b64 v134, v[148:149], v[150:151] offset0:136 offset1:204
    v_add_u32 v134, 2176, v134
    v_pk_mul_f32 v[136:137], v[164:165], v[156:157] op_sel_hi:[0,1]
    v_pk_mul_f32 v[140:141], v[172:173], v[156:157] op_sel_hi:[0,1]
    buffer_load_dwordx4 v22, s[4:7], s52 offen offset:2048 lds
    v_pk_mul_f32 v[138:139], v[166:167], v[158:159] op_sel_hi:[0,1]
    v_pk_mul_f32 v[142:143], v[174:175], v[158:159] op_sel_hi:[0,1]
    v_pk_fma_f32 v[160:161], v[164:165], v[156:157], v[136:137] op_sel:[1,1,0] op_sel_hi:[1,0,1] neg_lo:[0,1,0]
    v_pk_fma_f32 v[168:169], v[172:173], v[156:157], v[140:141] op_sel:[1,1,0] op_sel_hi:[1,0,1] neg_lo:[0,1,0]
    v_pk_fma_f32 v[162:163], v[166:167], v[158:159], v[138:139] op_sel:[1,1,0] op_sel_hi:[1,0,1] neg_lo:[0,1,0]
    v_pk_fma_f32 v[170:171], v[174:175], v[158:159], v[142:143] op_sel:[1,1,0] op_sel_hi:[1,0,1] neg_lo:[0,1,0]
    v_cvt_pk_f16_f32 v144, v160, v161
    v_cvt_pk_f16_f32 v145, v162, v163
    v_cvt_pk_f16_f32 v146, v168, v169
    v_cvt_pk_f16_f32 v147, v170, v171
    ds_write2_b64 v134, v[144:145], v[146:147] offset0:0 offset1:68
    buffer_load_dwordx4 v23, s[4:7], s52 offen offset:3072 lds
    v_pk_mul_f32 v[136:137], v[160:161], v[156:157] op_sel_hi:[0,1]
    v_pk_mul_f32 v[140:141], v[168:169], v[156:157] op_sel_hi:[0,1]
    v_pk_mul_f32 v[138:139], v[162:163], v[158:159] op_sel_hi:[0,1]
    v_pk_mul_f32 v[142:143], v[170:171], v[158:159] op_sel_hi:[0,1]
    v_pk_fma_f32 v[164:165], v[160:161], v[156:157], v[136:137] op_sel:[1,1,0] op_sel_hi:[1,0,1] neg_lo:[0,1,0]
    v_pk_fma_f32 v[172:173], v[168:169], v[156:157], v[140:141] op_sel:[1,1,0] op_sel_hi:[1,0,1] neg_lo:[0,1,0]
    v_pk_fma_f32 v[166:167], v[162:163], v[158:159], v[138:139] op_sel:[1,1,0] op_sel_hi:[1,0,1] neg_lo:[0,1,0]
    v_pk_fma_f32 v[174:175], v[170:171], v[158:159], v[142:143] op_sel:[1,1,0] op_sel_hi:[1,0,1] neg_lo:[0,1,0]
    v_cvt_pk_f16_f32 v148, v164, v165
    v_cvt_pk_f16_f32 v149, v166, v167
    v_cvt_pk_f16_f32 v150, v172, v173
    s_add_u32 s52, s52, 128
    v_cvt_pk_f16_f32 v151, v174, v175
    s_add_u32 s53, s53, 221184
    ds_write2_b64 v134, v[148:149], v[150:151] offset0:136 offset1:204
    buffer_load_dwordx4 v[56:59], v54, s[96:99], s64 offen
    v_add_u32 v134, 2176, v134
    v_pk_mul_f32 v[136:137], v[164:165], v[156:157] op_sel_hi:[0,1]
    v_pk_mul_f32 v[140:141], v[172:173], v[156:157] op_sel_hi:[0,1]
    v_pk_mul_f32 v[138:139], v[166:167], v[158:159] op_sel_hi:[0,1]
    v_pk_mul_f32 v[142:143], v[174:175], v[158:159] op_sel_hi:[0,1]
    v_pk_fma_f32 v[160:161], v[164:165], v[156:157], v[136:137] op_sel:[1,1,0] op_sel_hi:[1,0,1] neg_lo:[0,1,0]
    v_pk_fma_f32 v[168:169], v[172:173], v[156:157], v[140:141] op_sel:[1,1,0] op_sel_hi:[1,0,1] neg_lo:[0,1,0]
    v_pk_fma_f32 v[162:163], v[166:167], v[158:159], v[138:139] op_sel:[1,1,0] op_sel_hi:[1,0,1] neg_lo:[0,1,0]
    v_pk_fma_f32 v[170:171], v[174:175], v[158:159], v[142:143] op_sel:[1,1,0] op_sel_hi:[1,0,1] neg_lo:[0,1,0]
    v_cvt_pk_f16_f32 v144, v160, v161
    v_cvt_pk_f16_f32 v145, v162, v163
    s_add_u32 s64, s64, 27648
    v_cvt_pk_f16_f32 v146, v168, v169
    buffer_load_dwordx4 v[60:63], v54, s[96:99], s64 offen
    v_cvt_pk_f16_f32 v147, v170, v171
    ds_write2_b64 v134, v[144:145], v[146:147] offset0:0 offset1:68
    v_pk_mul_f32 v[136:137], v[160:161], v[156:157] op_sel_hi:[0,1]
    v_pk_mul_f32 v[140:141], v[168:169], v[156:157] op_sel_hi:[0,1]
    v_pk_mul_f32 v[138:139], v[162:163], v[158:159] op_sel_hi:[0,1]
    v_pk_mul_f32 v[142:143], v[170:171], v[158:159] op_sel_hi:[0,1]
    v_pk_fma_f32 v[164:165], v[160:161], v[156:157], v[136:137] op_sel:[1,1,0] op_sel_hi:[1,0,1] neg_lo:[0,1,0]
    v_pk_fma_f32 v[172:173], v[168:169], v[156:157], v[140:141] op_sel:[1,1,0] op_sel_hi:[1,0,1] neg_lo:[0,1,0]
    v_pk_fma_f32 v[166:167], v[162:163], v[158:159], v[138:139] op_sel:[1,1,0] op_sel_hi:[1,0,1] neg_lo:[0,1,0]
    v_pk_fma_f32 v[174:175], v[170:171], v[158:159], v[142:143] op_sel:[1,1,0] op_sel_hi:[1,0,1] neg_lo:[0,1,0]
    v_cvt_pk_f16_f32 v148, v164, v165
    s_add_u32 s64, s64, 27648
    v_cvt_pk_f16_f32 v149, v166, v167
    buffer_load_dwordx4 v[112:115], v54, s[96:99], s64 offen
    v_cvt_pk_f16_f32 v150, v172, v173
    v_cvt_pk_f16_f32 v151, v174, v175
    ds_write2_b64 v134, v[148:149], v[150:151] offset0:136 offset1:204
    v_add_u32 v134, 2176, v134
    s_add_u32 s64, s64, 27648
    buffer_load_dwordx4 v[116:119], v54, s[96:99], s64 offen
    s_add_u32 s64, s64, 27648
    buffer_load_dwordx4 v[52:55], v54, s[96:99], s64 offen
    s_branch L_kbarg
    .p2align 3
L_role1g:
    v_max_f32 v136, |v152|, |v153|
    v_max3_f32 v136, |v154|, |v155|, v136
    s_nop 1
    v_max_f32 v136, v136, v136 quad_perm:[1,0,3,2]
    s_nop 1
    v_max_f32 v136, v136, v136 quad_perm:[2,3,0,1]
    s_nop 1
    v_max_f32 v136, v136, v136 row_half_mirror
    s_nop 1
    v_max_f32 v136, v136, v136 row_mirror
    v_mov_b32 v137, v136
    s_add_u32 m0, s50, 4096
    s_nop 1
    buffer_load_dwordx4 v20, s[4:7], s52 offen lds
    v_permlane16_swap_b32 v136, v137
    s_nop 0
    v_max_f32 v136, v136, v137
    v_mov_b32 v137, v136
    s_nop 1
    v_permlane32_swap_b32 v136, v137
    s_nop 0
    v_max_f32 v136, v136, v137
    v_frexp_exp_i32_f32 v136, v136
    v_add_f32 v128, v128, v128
    v_ldexp_f32 v138, v128, v136
    buffer_load_dwordx4 v21, s[4:7], s52 offen offset:1024 lds
    v_mov_b32 v139, v135
    v_sub_u32 v136, 0, v136
    v_ldexp_f32 v152, v152, v136
    v_ldexp_f32 v153, v153, v136
    v_ldexp_f32 v154, v154, v136
    v_ldexp_f32 v155, v155, v136
    v_add_u32 v137, s87, v51
    v_mov_b32 v136, 0
    ds_write_b64 v137, v[138:139] offset:2600
    ds_write_b32 v137, v136
    v_mul_f32 v136, 0x3f800000, v130
    buffer_load_dwordx4 v22, s[4:7], s52 offen offset:2048 lds
    v_mul_f32 v138, 0x3f800000, v132
    v_mul_f32 v137, 0x3f800000, v131
    v_mul_f32 v139, 0x3f800000, v133
    v_fract_f32 v138, v138
    v_fract_f32 v139, v139
    v_exp_f32 v136, v136
    v_cos_f32 v156, v138
    v_sin_f32 v157, v138
    v_exp_f32 v137, v137
    v_cos_f32 v158, v139
    v_sin_f32 v159, v139
    buffer_load_dwordx4 v23, s[4:7], s52 offen offset:3072 lds
    s_nop 0
    .p2align 3
    v_pk_mul_f32 v[156:157], v[156:157], v[136:137] op_sel:[0,0] op_sel_hi:[1,0]
    v_pk_mul_f32 v[158:159], v[158:159], v[136:137] op_sel:[0,1] op_sel_hi:[1,1]
    v_mul_f32 v136, 0x43800000, v130
    v_mul_f32 v138, 0x43800000, v132
    v_mul_f32 v137, 0x43800000, v131
    v_mul_f32 v139, 0x43800000, v133
    v_fract_f32 v138, v138
    v_fract_f32 v139, v139
    v_exp_f32 v136, v136
    v_cos_f32 v160, v138
    s_add_u32 s52, s52, 128
    v_sin_f32 v161, v138
    s_add_u32 s53, s53, 221184
    v_exp_f32 v137, v137
    s_add_u32 m0, s51, 49152
    v_cos_f32 v162, v139
    buffer_load_dwordx4 v24, s[8:11], s53 offen lds
    v_sin_f32 v163, v139
    s_nop 0
    .p2align 3
    v_pk_mul_f32 v[160:161], v[160:161], v[136:137] op_sel:[0,0] op_sel_hi:[1,0]
    v_pk_mul_f32 v[162:163], v[162:163], v[136:137] op_sel:[0,1] op_sel_hi:[1,1]
    v_mul_f32 v136, 0x44800000, v130
    v_mul_f32 v138, 0x44800000, v132
    v_mul_f32 v137, 0x44800000, v131
    v_mul_f32 v139, 0x44800000, v133
    v_fract_f32 v138, v138
    v_fract_f32 v139, v139
    v_exp_f32 v136, v136
    buffer_load_dwordx4 v25, s[8:11], s53 offen offset:1024 lds
    v_cos_f32 v164, v138
    v_sin_f32 v165, v138
    v_exp_f32 v137, v137
    v_cos_f32 v166, v139
    v_sin_f32 v167, v139
    s_nop 0
    .p2align 3
    v_pk_mul_f32 v[164:165], v[164:165], v[136:137] op_sel:[0,0] op_sel_hi:[1,0]
    v_pk_mul_f32 v[166:167], v[166:167], v[136:137] op_sel:[0,1] op_sel_hi:[1,1]
    v_cvt_pk_f16_f32 v144, v152, -v153
    v_cvt_pk_f16_f32 v145, v154, -v155
    v_pk_mul_f32 v[136:137], v[152:153], v[156:157] op_sel_hi:[0,1]
    s_add_u32 m0, s51, 57344
    v_pk_mul_f32 v[138:139], v[154:155], v[158:159] op_sel_hi:[0,1]
    buffer_load_dwordx4 v24, s[12:15], s53 offen lds
    v_pk_fma_f32 v[172:173], v[152:153], v[156:157], v[136:137] op_sel:[1,1,0] op_sel_hi:[1,0,1] neg_lo:[0,1,0]
    v_pk_fma_f32 v[174:175], v[154:155], v[158:159], v[138:139] op_sel:[1,1,0] op_sel_hi:[1,0,1] neg_lo:[0,1,0]
    v_cvt_pk_f16_f32 v146, v172, -v173
    v_cvt_pk_f16_f32 v147, v174, -v175
    ds_write2_b64 v134, v[144:145], v[146:147] offset0:0 offset1:68
    v_pk_mul_f32 v[136:137], v[172:173], v[156:157] op_sel_hi:[0,1]
    v_pk_mul_f32 v[138:139], v[174:175], v[158:159] op_sel_hi:[0,1]
    v_pk_fma_f32 v[176:177], v[172:173], v[156:157], v[136:137] op_sel:[1,1,0] op_sel_hi:[1,0,1] neg_lo:[0,1,0]
    v_pk_fma_f32 v[178:179], v[174:175], v[158:159], v[138:139] op_sel:[1,1,0] op_sel_hi:[1,0,1] neg_lo:[0,1,0]
    v_cvt_pk_f16_f32 v148, v176, -v177
    v_cvt_pk_f16_f32 v149, v178, -v179
    buffer_load_dwordx4 v25, s[12:15], s53 offen offset:1024 lds
    v_pk_mul_f32 v[136:137], v[176:177], v[156:157] op_sel_hi:[0,1]
    v_pk_mul_f32 v[138:139], v[178:179], v[158:159] op_sel_hi:[0,1]
    v_pk_fma_f32 v[180:181], v[176:177], v[156:157], v[136:137] op_sel:[1,1,0] op_sel_hi:[1,0,1] neg_lo:[0,1,0]
    v_pk_fma_f32 v[182:183], v[178:179], v[158:159], v[138:139] op_sel:[1,1,0] op_sel_hi:[1,0,1] neg_lo:[0,1,0]
    v_cvt_pk_f16_f32 v150, v180, -v181
    v_cvt_pk_f16_f32 v151, v182, -v183
    ds_write2_b64 v134, v[148:149], v[150:151] offset0:136 offset1:204
    v_add_u32 v134, 2176, v134
    v_pk_mul_f32 v[136:137], v[180:181], v[156:157] op_sel_hi:[0,1]
    v_pk_mul_f32 v[138:139], v[182:183], v[158:159] op_sel_hi:[0,1]
    v_pk_fma_f32 v[184:185], v[180:181], v[156:157], v[136:137] op_sel:[1,1,0] op_sel_hi:[1,0,1] neg_lo:[0,1,0]
    s_add_u32 m0, s50, 49152
    v_pk_fma_f32 v[186:187], v[182:183], v[158:159], v[138:139] op_sel:[1,1,0] op_sel_hi:[1,0,1] neg_lo:[0,1,0]
    buffer_load_dwordx4 v16, s[4:7], s52 offen lds
    v_cvt_pk_f16_f32 v144, v184, -v185
    v_cvt_pk_f16_f32 v145, v186, -v187
    v_pk_mul_f32 v[136:137], v[184:185], v[156:157] op_sel_hi:[0,1]
    v_pk_mul_f32 v[138:139], v[186:187], v[158:159] op_sel_hi:[0,1]
    v_pk_fma_f32 v[188:189], v[184:185], v[156:157], v[136:137] op_sel:[1,1,0] op_sel_hi:[1,0,1] neg_lo:[0,1,0]
    v_pk_fma_f32 v[190:191], v[186:187], v[158:159], v[138:139] op_sel:[1,1,0] op_sel_hi:[1,0,1] neg_lo:[0,1,0]
    v_cvt_pk_f16_f32 v146, v188, -v189
    v_cvt_pk_f16_f32 v147, v190, -v191
    ds_write2_b64 v134, v[144:145], v[146:147] offset0:0 offset1:68
    v_pk_mul_f32 v[136:137], v[188:189], v[156:157] op_sel_hi:[0,1]
    v_pk_mul_f32 v[138:139], v[190:191], v[158:159] op_sel_hi:[0,1]
    buffer_load_dwordx4 v17, s[4:7], s52 offen offset:1024 lds
    v_pk_fma_f32 v[192:193], v[188:189], v[156:157], v[136:137] op_sel:[1,1,0] op_sel_hi:[1,0,1] neg_lo:[0,1,0]
    v_pk_fma_f32 v[194:195], v[190:191], v[158:159], v[138:139] op_sel:[1,1,0] op_sel_hi:[1,0,1] neg_lo:[0,1,0]
    v_cvt_pk_f16_f32 v148, v192, -v193
    v_cvt_pk_f16_f32 v149, v194, -v195
    v_pk_mul_f32 v[136:137], v[192:193], v[156:157] op_sel_hi:[0,1]
    v_pk_mul_f32 v[138:139], v[194:195], v[158:159] op_sel_hi:[0,1]
    v_pk_fma_f32 v[196:197], v[192:193], v[156:157], v[136:137] op_sel:[1,1,0] op_sel_hi:[1,0,1] neg_lo:[0,1,0]
    v_pk_fma_f32 v[198:199], v[194:195], v[158:159], v[138:139] op_sel:[1,1,0] op_sel_hi:[1,0,1] neg_lo:[0,1,0]
    v_cvt_pk_f16_f32 v150, v196, -v197
    v_cvt_pk_f16_f32 v151, v198, -v199
    ds_write2_b64 v134, v[148:149], v[150:151] offset0:136 offset1:204
    buffer_load_dwordx4 v18, s[4:7], s52 offen offset:2048 lds
    v_add_u32 v134, 2176, v134
    v_pk_mul_f32 v[136:137], v[152:153], v[160:161] op_sel_hi:[0,1]
    v_pk_mul_f32 v[138:139], v[154:155], v[162:163] op_sel_hi:[0,1]
    v_pk_fma_f32 v[200:201], v[152:153], v[160:161], v[136:137] op_sel:[1,1,0] op_sel_hi:[1,0,1] neg_lo:[0,1,0]
    v_pk_fma_f32 v[202:203], v[154:155], v[162:163], v[138:139] op_sel:[1,1,0] op_sel_hi:[1,0,1] neg_lo:[0,1,0]
    v_cvt_pk_f16_f32 v144, v200, -v201
    v_cvt_pk_f16_f32 v145, v202, -v203
    v_pk_mul_f32 v[136:137], v[176:177], v[160:161] op_sel_hi:[0,1]
    v_pk_mul_f32 v[138:139], v[178:179], v[162:163] op_sel_hi:[0,1]
    v_pk_fma_f32 v[204:205], v[176:177], v[160:161], v[136:137] op_sel:[1,1,0] op_sel_hi:[1,0,1] neg_lo:[0,1,0]
    v_pk_fma_f32 v[206:207], v[178:179], v[162:163], v[138:139] op_sel:[1,1,0] op_sel_hi:[1,0,1] neg_lo:[0,1,0]
    buffer_load_dwordx4 v19, s[4:7], s52 offen offset:3072 lds
    v_cvt_pk_f16_f32 v146, v204, -v205
    v_cvt_pk_f16_f32 v147, v206, -v207
    ds_write2_b64 v134, v[144:145], v[146:147] offset0:0 offset1:68
    v_pk_mul_f32 v[136:137], v[184:185], v[160:161] op_sel_hi:[0,1]
    v_pk_mul_f32 v[138:139], v[186:187], v[162:163] op_sel_hi:[0,1]
    v_pk_fma_f32 v[208:209], v[184:185], v[160:161], v[136:137] op_sel:[1,1,0] op_sel_hi:[1,0,1] neg_lo:[0,1,0]
    v_pk_fma_f32 v[210:211], v[186:187], v[162:163], v[138:139] op_sel:[1,1,0] op_sel_hi:[1,0,1] neg_lo:[0,1,0]
    v_cvt_pk_f16_f32 v148, v208, -v209
    v_cvt_pk_f16_f32 v149, v210, -v211
    v_pk_mul_f32 v[136:137], v[192:193], v[160:161] op_sel_hi:[0,1]
    v_pk_mul_f32 v[138:139], v[194:195], v[162:163] op_sel_hi:[0,1]
    s_add_u32 m0, s50, 53248
    v_pk_fma_f32 v[212:213], v[192:193], v[160:161], v[136:137] op_sel:[1,1,0] op_sel_hi:[1,0,1] neg_lo:[0,1,0]
    buffer_load_dwordx4 v20, s[4:7], s52 offen lds
    v_pk_fma_f32 v[214:215], v[194:195], v[162:163], v[138:139] op_sel:[1,1,0] op_sel_hi:[1,0,1] neg_lo:[0,1,0]
    v_cvt_pk_f16_f32 v150, v212, -v213
    v_cvt_pk_f16_f32 v151, v214, -v215
    ds_write2_b64 v134, v[148:149], v[150:151] offset0:136 offset1:204
    v_add_u32 v134, 2176, v134
    v_pk_mul_f32 v[136:137], v[200:201], v[160:161] op_sel_hi:[0,1]
    v_pk_mul_f32 v[138:139], v[202:203], v[162:163] op_sel_hi:[0,1]
    v_pk_fma_f32 v[216:217], v[200:201], v[160:161], v[136:137] op_sel:[1,1,0] op_sel_hi:[1,0,1] neg_lo:[0,1,0]
    v_pk_fma_f32 v[218:219], v[202:203], v[162:163], v[138:139] op_sel:[1,1,0] op_sel_hi:[1,0,1] neg_lo:[0,1,0]
    v_cvt_pk_f16_f32 v144, v216, -v217
    v_cvt_pk_f16_f32 v145, v218, -v219
    buffer_load_dwordx4 v21, s[4:7], s52 offen offset:1024 lds
    v_pk_mul_f32 v[136:137], v[208:209], v[160:161] op_sel_hi:[0,1]
    v_pk_mul_f32 v[138:139], v[210:211], v[162:163] op_sel_hi:[0,1]
    v_pk_fma_f32 v[220:221], v[208:209], v[160:161], v[136:137] op_sel:[1,1,0] op_sel_hi:[1,0,1] neg_lo:[0,1,0]
    v_pk_fma_f32 v[222:223], v[210:211], v[162:163], v[138:139] op_sel:[1,1,0] op_sel_hi:[1,0,1] neg_lo:[0,1,0]
    v_cvt_pk_f16_f32 v146, v220, -v221
    v_cvt_pk_f16_f32 v147, v222, -v223
    ds_write2_b64 v134, v[144:145], v[146:147] offset0:0 offset1:68
    v_pk_mul_f32 v[136:137], v[216:217], v[160:161] op_sel_hi:[0,1]
    v_pk_mul_f32 v[138:139], v[218:219], v[162:163] op_sel_hi:[0,1]
    v_pk_fma_f32 v[172:173], v[216:217], v[160:161], v[136:137] op_sel:[1,1,0] op_sel_hi:[1,0,1] neg_lo:[0,1,0]
    v_pk_fma_f32 v[174:175], v[218:219], v[162:163], v[138:139] op_sel:[1,1,0] op_sel_hi:[1,0,1] neg_lo:[0,1,0]
    buffer_load_dwordx4 v22, s[4:7], s52 offen offset:2048 lds
    v_cvt_pk_f16_f32 v148, v172, -v173
    v_cvt_pk_f16_f32 v149, v174, -v175
    v_pk_mul_f32 v[136:137], v[220:221], v[160:161] op_sel_hi:[0,1]
    v_pk_mul_f32 v[138:139], v[222:223], v[162:163] op_sel_hi:[0,1]
    v_pk_fma_f32 v[180:181], v[220:221], v[160:161], v[136:137] op_sel:[1,1,0] op_sel_hi:[1,0,1] neg_lo:[0,1,0]
    v_pk_fma_f32 v[182:183], v[222:223], v[162:163], v[138:139] op_sel:[1,1,0] op_sel_hi:[1,0,1] neg_lo:[0,1,0]
    v_cvt_pk_f16_f32 v150, v180, -v181
    v_cvt_pk_f16_f32 v151, v182, -v183
    ds_write2_b64 v134, v[148:149], v[150:151] offset0:136 offset1:204
    v_add_u32 v134, 2176, v134
    v_pk_mul_f32 v[136:137], v[152:153], v[164:165] op_sel_hi:[0,1]
    buffer_load_dwordx4 v23, s[4:7], s52 offen offset:3072 lds
    v_pk_mul_f32 v[138:139], v[154:155], v[166:167] op_sel_hi:[0,1]
    v_pk_fma_f32 v[200:201], v[152:153], v[164:165], v[136:137] op_sel:[1,1,0] op_sel_hi:[1,0,1] neg_lo:[0,1,0]
    v_pk_fma_f32 v[202:203], v[154:155], v[166:167], v[138:139] op_sel:[1,1,0] op_sel_hi:[1,0,1] neg_lo:[0,1,0]
    v_cvt_pk_f16_f32 v144, v200, -v201
    v_cvt_pk_f16_f32 v145, v202, -v203
    v_pk_mul_f32 v[136:137], v[200:201], v[160:161] op_sel_hi:[0,1]
    v_pk_mul_f32 v[138:139], v[202:203], v[162:163] op_sel_hi:[0,1]
    v_pk_fma_f32 v[204:205], v[200:201], v[160:161], v[136:137] op_sel:[1,1,0] op_sel_hi:[1,0,1] neg_lo:[0,1,0]
    v_pk_fma_f32 v[206:207], v[202:203], v[162:163], v[138:139] op_sel:[1,1,0] op_sel_hi:[1,0,1] neg_lo:[0,1,0]
    v_cvt_pk_f16_f32 v146, v204, -v205
    v_cvt_pk_f16_f32 v147, v206, -v207
    s_add_u32 s52, s52, 128
    ds_write2_b64 v134, v[144:145], v[146:147] offset0:0 offset1:68
    s_add_u32 s53, s53, 221184
    v_pk_mul_f32 v[136:137], v[204:205], v[160:161] op_sel_hi:[0,1]
    buffer_load_dwordx4 v[56:59], v54, s[96:99], s64 offen
    v_pk_mul_f32 v[138:139], v[206:207], v[162:163] op_sel_hi:[0,1]
    v_pk_fma_f32 v[212:213], v[204:205], v[160:161], v[136:137] op_sel:[1,1,0] op_sel_hi:[1,0,1] neg_lo:[0,1,0]
    v_pk_fma_f32 v[214:215], v[206:207], v[162:163], v[138:139] op_sel:[1,1,0] op_sel_hi:[1,0,1] neg_lo:[0,1,0]
    v_cvt_pk_f16_f32 v148, v212, -v213
    v_cvt_pk_f16_f32 v149, v214, -v215
    v_pk_mul_f32 v[136:137], v[212:213], v[160:161] op_sel_hi:[0,1]
    v_pk_mul_f32 v[138:139], v[214:215], v[162:163] op_sel_hi:[0,1]
    v_pk_fma_f32 v[204:205], v[212:213], v[160:161], v[136:137] op_sel:[1,1,0] op_sel_hi:[1,0,1] neg_lo:[0,1,0]
    v_pk_fma_f32 v[206:207], v[214:215], v[162:163], v[138:139] op_sel:[1,1,0] op_sel_hi:[1,0,1] neg_lo:[0,1,0]
    v_cvt_pk_f16_f32 v150, v204, -v205
    v_cvt_pk_f16_f32 v151, v206, -v207
    s_add_u32 s64, s64, 27648
    ds_write2_b64 v134, v[148:149], v[150:151] offset0:136 offset1:204
    buffer_load_dwordx4 v[60:63], v54, s[96:99], s64 offen
    v_add_u32 v134, 2176, v134
    v_pk_mul_f32 v[136:137], v[200:201], v[164:165] op_sel_hi:[0,1]
    v_pk_mul_f32 v[138:139], v[202:203], v[166:167] op_sel_hi:[0,1]
    v_pk_fma_f32 v[208:209], v[200:201], v[164:165], v[136:137] op_sel:[1,1,0] op_sel_hi:[1,0,1] neg_lo:[0,1,0]
    v_pk_fma_f32 v[210:211], v[202:203], v[166:167], v[138:139] op_sel:[1,1,0] op_sel_hi:[1,0,1] neg_lo:[0,1,0]
    v_cvt_pk_f16_f32 v144, v208, -v209
    v_cvt_pk_f16_f32 v145, v210, -v211
    ds_write_b64 v134, v[144:145] offset:0
    s_add_u32 s64, s64, 27648
    buffer_load_dwordx4 v[112:115], v54, s[96:99], s64 offen
    s_add_u32 s64, s64, 27648
    buffer_load_dwordx4 v[116:119], v54, s[96:99], s64 offen
    s_add_u32 s64, s64, 27648
    buffer_load_dwordx4 v[52:55], v54, s[96:99], s64 offen
L_kbarg:
    s_waitcnt vmcnt(21)
    s_waitcnt lgkmcnt(0)
    s_barrier
    buffer_store_dword v120, v121, s[16:19], s57 offen sc1
    ds_read_b128 v[64:67], v46 offset:0
    ds_read_b128 v[128:131], v47 offset:11424
    ds_read_b128 v[160:163], v47 offset:20128
    ds_read_b128 v[68:71], v46 offset:64
    ds_read_b128 v[132:135], v47 offset:11488
    ds_read_b128 v[164:167], v47 offset:20192
    ds_read_b128 v[72:75], v46 offset:128
    ds_read_b128 v[136:139], v47 offset:11552
    ds_read_b128 v[168:171], v47 offset:20256
    ds_read_b128 v[76:79], v46 offset:192
    ds_read_b128 v[140:143], v47 offset:11616
    ds_read_b128 v[172:175], v47 offset:20320
    ds_read_b128 v[80:83], v46 offset:256
    ds_read_b128 v[144:147], v47 offset:11680
    ds_read_b128 v[176:179], v47 offset:20384
    ds_read_b128 v[84:87], v46 offset:320
    ds_read_b128 v[148:151], v47 offset:11744
    ds_read_b128 v[180:183], v47 offset:20448
    ds_read_b128 v[88:91], v46 offset:384
    ds_read_b128 v[152:155], v47 offset:11808
    ds_read_b128 v[184:187], v47 offset:20512
    ds_read_b128 v[92:95], v46 offset:448
    ds_read_b128 v[156:159], v47 offset:11872
    ds_read_b128 v[188:191], v47 offset:20576
    s_waitcnt lgkmcnt(15)
    v_mfma_f32_16x16x32_f16 v[96:99], v[64:67], v[128:131], 0
    v_mfma_f32_16x16x32_f16 v[100:103], v[64:67], v[160:163], 0
    s_waitcnt lgkmcnt(15)
    v_mfma_f32_16x16x32_f16 v[96:99], v[68:71], v[132:135], v[96:99]
    v_mfma_f32_16x16x32_f16 v[100:103], v[68:71], v[164:167], v[100:103]
    s_waitcnt lgkmcnt(15)
    v_mfma_f32_16x16x32_f16 v[96:99], v[72:75], v[136:139], v[96:99]
    v_mfma_f32_16x16x32_f16 v[100:103], v[72:75], v[168:171], v[100:103]
    s_waitcnt lgkmcnt(12)
    v_mfma_f32_16x16x32_f16 v[96:99], v[76:79], v[140:143], v[96:99]
    v_mfma_f32_16x16x32_f16 v[100:103], v[76:79], v[172:175], v[100:103]
    s_waitcnt lgkmcnt(9)
    v_mfma_f32_16x16x32_f16 v[96:99], v[80:83], v[144:147], v[96:99]
    v_mfma_f32_16x16x32_f16 v[100:103], v[80:83], v[176:179], v[100:103]
    s_waitcnt lgkmcnt(6)
    v_mfma_f32_16x16x32_f16 v[96:99], v[84:87], v[148:151], v[96:99]
    v_mfma_f32_16x16x32_f16 v[100:103], v[84:87], v[180:183], v[100:103]
    s_waitcnt lgkmcnt(3)
    v_mfma_f32_16x16x32_f16 v[96:99], v[88:91], v[152:155], v[96:99]
    v_mfma_f32_16x16x32_f16 v[100:103], v[88:91], v[184:187], v[100:103]
    s_waitcnt lgkmcnt(0)
    v_mfma_f32_16x16x32_f16 v[96:99], v[92:95], v[156:159], v[96:99]
    v_mfma_f32_16x16x32_f16 v[100:103], v[92:95], v[188:191], v[100:103]
    s_nop 6
    ds_write_b32 v224, v96
    ds_write_b32 v225, v97
    ds_write_b32 v226, v98
    ds_write_b32 v227, v99
    ds_write_b32 v228, v100
    ds_write_b32 v229, v101
    ds_write_b32 v230, v102
    ds_write_b32 v231, v103
    v_and_b32 v2, 15, v0
    v_lshrrev_b32 v3, 4, v0
    v_bfe_u32 v4, v0, 1, 3
    v_xor_b32 v4, v4, v3
    v_lshl_add_u32 v2, v2, 7, s50
    v_lshl_add_u32 v26, v4, 4, v2
    v_xor_b32 v27, 64, v26
    v_add_u32 v28, 98304, v26
    v_add_u32 v29, 98304, v27
    v_bfe_u32 v6, v0, 2, 2
    v_and_b32 v7, 3, v0
    v_lshl_add_u32 v2, v3, 3, v6
    v_lshlrev_b32 v2, 7, v2
    v_lshl_add_u32 v2, v7, 3, v2
    v_lshrrev_b32 v6, 1, v6
    v_and_b32 v3, 1, v3
    v_lshl_add_u32 v6, v3, 1, v6
    v_lshl_add_u32 v30, v6, 5, v2
    v_xor_b32 v31, 32, v30
    v_xor_b32 v32, 64, v30
    v_xor_b32 v33, 96, v30
    v_add_u32 v34, 98304, v30
    v_add_u32 v35, 98304, v31
    v_add_u32 v36, 98304, v32
    v_add_u32 v37, 98304, v33
    s_mov_b32 s60, 0xffff0000
    s_waitcnt vmcnt(17)
    s_waitcnt lgkmcnt(0)
    s_barrier
    ds_read_b128 v[96:99], v26 offset:0
    ds_read_b64_tr_b16 v[64:65], v30 offset:0
    ds_read_b64_tr_b16 v[66:67], v30 offset:512
    ds_read_b128 v[100:103], v26 offset:2048
    ds_read_b128 v[104:107], v26 offset:4096
    ds_read_b128 v[108:111], v26 offset:6144
    ds_read_b64_tr_b16 v[68:69], v31 offset:0
    ds_read_b64_tr_b16 v[70:71], v31 offset:512
    ds_read_b64_tr_b16 v[72:73], v32 offset:0
    ds_read_b64_tr_b16 v[74:75], v32 offset:512
    ds_read_b64_tr_b16 v[76:77], v33 offset:0
    ds_read_b64_tr_b16 v[78:79], v33 offset:512
    s_waitcnt lgkmcnt(9)
    v_mfma_f32_16x16x32_bf16 v[128:131], v[64:67], v[96:99], 0
    ds_read_b64_tr_b16 v[80:81], v30 offset:8192
    ds_read_b64_tr_b16 v[82:83], v30 offset:8704
    s_mov_b32 s0, 214748365
    s_waitcnt lgkmcnt(8)
    v_mfma_f32_16x16x32_bf16 v[132:135], v[64:67], v[100:103], 0
    s_lshl_b32 s1, s40, 6
    v_add_u32 v2, s1, v0
    v_mfma_f32_16x16x32_bf16 v[136:139], v[64:67], v[104:107], 0
    ds_read_b64_tr_b16 v[84:85], v31 offset:8192
    v_mul_hi_u32 v3, v2, s0
    v_mul_u32_u24 v12, 20, v3
    v_mfma_f32_16x16x32_bf16 v[140:143], v[64:67], v[108:111], 0
    v_sub_u32 v12, v2, v12
    v_mul_u32_u24 v3, 1280, v3
    s_waitcnt lgkmcnt(7)
    v_mfma_f32_16x16x32_bf16 v[144:147], v[68:71], v[96:99], 0
    ds_read_b64_tr_b16 v[86:87], v31 offset:8704
    v_lshl_add_u32 v48, v12, 4, v3
    v_add_u32 v2, s1, v0
    v_mfma_f32_16x16x32_bf16 v[148:151], v[68:71], v[100:103], 0
    v_add_u32 v2, 256, v2
    v_mul_hi_u32 v3, v2, s0
    v_mfma_f32_16x16x32_bf16 v[152:155], v[68:71], v[104:107], 0
    ds_read_b64_tr_b16 v[88:89], v32 offset:8192
    ds_read_b64_tr_b16 v[90:91], v32 offset:8704
    v_mfma_f32_16x16x32_bf16 v[156:159], v[68:71], v[108:111], 0
    v_mul_u32_u24 v12, 20, v3
    s_add_u32 m0, s51, 98304
    s_waitcnt lgkmcnt(8)
    v_mfma_f32_16x16x32_bf16 v[160:163], v[72:75], v[96:99], 0
    buffer_load_dwordx4 v24, s[8:11], s53 offen lds
    ds_read_b64_tr_b16 v[92:93], v33 offset:8192
    v_sub_u32 v12, v2, v12
    v_mfma_f32_16x16x32_bf16 v[164:167], v[72:75], v[100:103], 0
    v_mul_u32_u24 v3, 1280, v3
    v_lshl_add_u32 v49, v12, 4, v3
    v_mfma_f32_16x16x32_bf16 v[168:171], v[72:75], v[104:107], 0
    ds_read_b64_tr_b16 v[94:95], v33 offset:8704
    v_add_u32 v2, s1, v0
    v_add_u32 v2, 512, v2
    v_mfma_f32_16x16x32_bf16 v[172:175], v[72:75], v[108:111], 0
    v_mul_hi_u32 v3, v2, s0
    v_mul_u32_u24 v12, 20, v3
    s_waitcnt lgkmcnt(8)
    v_mfma_f32_16x16x32_bf16 v[176:179], v[76:79], v[96:99], 0
    buffer_load_dwordx4 v25, s[8:11], s53 offen offset:1024 lds
    v_sub_u32 v12, v2, v12
    v_mul_u32_u24 v3, 1280, v3
    v_mfma_f32_16x16x32_bf16 v[180:183], v[76:79], v[100:103], 0
    v_lshl_add_u32 v50, v12, 4, v3
    s_lshr_b32 s64, s45, 2
    v_mfma_f32_16x16x32_bf16 v[184:187], v[76:79], v[104:107], 0
    s_and_b32 s65, s45, 3
    s_mul_i32 s56, s64, 40960
    v_mfma_f32_16x16x32_bf16 v[188:191], v[76:79], v[108:111], 0
    s_mul_i32 s0, s65, 320
    s_add_u32 m0, s51, 106496
    s_waitcnt lgkmcnt(4)
    v_mfma_f32_16x16x32_bf16 v[192:195], v[80:83], v[96:99], 0
    buffer_load_dwordx4 v24, s[12:15], s53 offen lds
    ds_read_b128 a[144:147], v27 offset:0
    ds_read_b64_tr_b16 v[64:65], v30 offset:4096
    v_mfma_f32_16x16x32_bf16 v[196:199], v[80:83], v[100:103], 0
    s_add_u32 s56, s56, s0
    s_lshl_b32 s57, s40, 10
    v_mfma_f32_16x16x32_bf16 v[200:203], v[80:83], v[104:107], 0
    ds_read_b64_tr_b16 v[66:67], v30 offset:4608
    ds_read_b128 a[148:151], v27 offset:2048
    v_lshrrev_b32 v2, 2, v0
    v_mfma_f32_16x16x32_bf16 v[204:207], v[80:83], v[108:111], 0
    v_mul_u32_u24 v2, 320, v2
    v_and_b32 v3, 3, v0
    v_mfma_f32_16x16x32_bf16 v[208:211], v[84:87], v[96:99], 0
    buffer_load_dwordx4 v25, s[12:15], s53 offen offset:1024 lds
    ds_read_b128 a[152:155], v27 offset:4096
    ds_read_b128 a[156:159], v27 offset:6144
    v_mfma_f32_16x16x32_bf16 v[212:215], v[84:87], v[100:103], 0
    v_lshl_add_u32 v2, v3, 3, v2
    s_lshl_b32 s0, s40, 5
    v_mfma_f32_16x16x32_bf16 v[216:219], v[84:87], v[104:107], 0
    ds_read_b64_tr_b16 v[68:69], v31 offset:4096
    ds_read_b64_tr_b16 v[70:71], v31 offset:4608
    v_mfma_f32_16x16x32_bf16 v[220:223], v[84:87], v[108:111], 0
    s_add_u32 s0, s0, 147456
    s_add_u32 m0, s50, 98304
    s_waitcnt lgkmcnt(8)
    v_mfma_f32_16x16x32_bf16 v[224:227], v[88:91], v[96:99], 0
    buffer_load_dwordx4 v16, s[4:7], s52 offen lds
    ds_read_b64_tr_b16 v[72:73], v32 offset:4096
    ds_read_b64_tr_b16 v[74:75], v32 offset:4608
    v_mfma_f32_16x16x32_bf16 v[228:231], v[88:91], v[100:103], 0
    v_add_u32 v51, s0, v2
    s_mul_i32 s1, s65, 10
    v_mfma_f32_16x16x32_bf16 v[232:235], v[88:91], v[104:107], 0
    ds_read_b64_tr_b16 v[76:77], v33 offset:4096
    ds_read_b64_tr_b16 v[78:79], v33 offset:4608
    s_add_u32 s1, s1, s40
    v_mfma_f32_16x16x32_bf16 v[236:239], v[88:91], v[108:111], 0
    s_mul_i32 s3, s64, 5
    s_add_u32 s97, s1, 0
    v_mfma_f32_16x16x32_bf16 v[240:243], v[92:95], v[96:99], 0
    buffer_load_dwordx4 v17, s[4:7], s52 offen offset:1024 lds
    s_mul_i32 s0, s97, 13108
    s_lshr_b32 s0, s0, 16
    v_mfma_f32_16x16x32_bf16 v[244:247], v[92:95], v[100:103], 0
    s_mul_i32 s0, s0, 265
    s_add_u32 s97, s97, s0
    v_mfma_f32_16x16x32_bf16 v[248:251], v[92:95], v[104:107], 0
    s_add_u32 s97, s97, s3
    s_lshl_b32 s97, s97, 10
    v_mfma_f32_16x16x32_bf16 v[252:255], v[92:95], v[108:111], 0
    s_add_u32 s97, s97, 5308416
    s_add_u32 s98, s1, 4
    s_waitcnt lgkmcnt(4)
    v_mfma_f32_16x16x32_bf16 v[128:131], v[64:67], a[144:147], v[128:131]
    buffer_load_dwordx4 v18, s[4:7], s52 offen offset:2048 lds
    ds_read_b64_tr_b16 v[80:81], v30 offset:12288
    ds_read_b64_tr_b16 v[82:83], v30 offset:12800
    v_mfma_f32_16x16x32_bf16 v[132:135], v[64:67], a[148:151], v[132:135]
    s_mul_i32 s0, s98, 13108
    s_lshr_b32 s0, s0, 16
    v_mfma_f32_16x16x32_bf16 v[136:139], v[64:67], a[152:155], v[136:139]
    ds_read_b64_tr_b16 v[84:85], v31 offset:12288
    s_mul_i32 s0, s0, 265
    s_add_u32 s98, s98, s0
    v_mfma_f32_16x16x32_bf16 v[140:143], v[64:67], a[156:159], v[140:143]
    s_add_u32 s98, s98, s3
    s_lshl_b32 s98, s98, 10
    v_mfma_f32_16x16x32_bf16 v[144:147], v[68:71], a[144:147], v[144:147]
    buffer_load_dwordx4 v19, s[4:7], s52 offen offset:3072 lds
    ds_read_b64_tr_b16 v[86:87], v31 offset:12800
    s_add_u32 s98, s98, 5308416
    v_mfma_f32_16x16x32_bf16 v[148:151], v[68:71], a[148:151], v[148:151]
    s_add_u32 s99, s1, 8
    s_mul_i32 s0, s99, 13108
    v_mfma_f32_16x16x32_bf16 v[152:155], v[68:71], a[152:155], v[152:155]
    ds_read_b64_tr_b16 v[88:89], v32 offset:12288
    ds_read_b64_tr_b16 v[90:91], v32 offset:12800
    v_mfma_f32_16x16x32_bf16 v[156:159], v[68:71], a[156:159], v[156:159]
    s_lshr_b32 s0, s0, 16
    s_add_u32 m0, s50, 102400
    s_waitcnt lgkmcnt(6)
    v_mfma_f32_16x16x32_bf16 v[160:163], v[72:75], a[144:147], v[160:163]
    buffer_load_dwordx4 v20, s[4:7], s52 offen lds
    ds_read_b64_tr_b16 v[92:93], v33 offset:12288
    s_mul_i32 s0, s0, 265
    v_mfma_f32_16x16x32_bf16 v[164:167], v[72:75], a[148:151], v[164:167]
    s_add_u32 s99, s99, s0
    s_add_u32 s99, s99, s3
    v_mfma_f32_16x16x32_bf16 v[168:171], v[72:75], a[152:155], v[168:171]
    ds_read_b64_tr_b16 v[94:95], v33 offset:12800
    s_lshl_b32 s99, s99, 10
    s_add_u32 s99, s99, 5308416
    v_mfma_f32_16x16x32_bf16 v[172:175], v[72:75], a[156:159], v[172:175]
    s_cmp_lt_u32 s40, 2
    s_cselect_b32 s99, s99, 2147418112
    v_mfma_f32_16x16x32_bf16 v[176:179], v[76:79], a[144:147], v[176:179]
    buffer_load_dwordx4 v21, s[4:7], s52 offen offset:1024 lds
    s_waitcnt vmcnt(14)
    v_lshlrev_b32 v4, 16, v56
    v_mfma_f32_16x16x32_bf16 v[180:183], v[76:79], a[148:151], v[180:183]
    v_and_b32 v5, s60, v56
    v_lshlrev_b32 v6, 16, v57
    v_mfma_f32_16x16x32_bf16 v[184:187], v[76:79], a[152:155], v[184:187]
    v_and_b32 v7, s60, v57
    v_lshlrev_b32 v42, 16, v58
    v_mfma_f32_16x16x32_bf16 v[188:191], v[76:79], a[156:159], v[188:191]
    v_and_b32 v43, s60, v58
    v_lshlrev_b32 v44, 16, v59
    s_waitcnt lgkmcnt(0)
    s_barrier
    v_mfma_f32_16x16x32_bf16 v[192:195], v[80:83], a[144:147], v[192:195]
    buffer_load_dwordx4 v22, s[4:7], s52 offen offset:2048 lds
    ds_read_b128 v[96:99], v26 offset:49152
    ds_read_b64_tr_b16 v[64:65], v30 offset:49152
    v_mfma_f32_16x16x32_bf16 v[196:199], v[80:83], a[148:151], v[196:199]
    v_and_b32 v45, s60, v59
    s_waitcnt vmcnt(14)
    v_mfma_f32_16x16x32_bf16 v[200:203], v[80:83], a[152:155], v[200:203]
    ds_read_b64_tr_b16 v[66:67], v30 offset:49664
    ds_read_b128 v[100:103], v26 offset:51200
    v_lshlrev_b32 v8, 16, v60
    v_mfma_f32_16x16x32_bf16 v[204:207], v[80:83], a[156:159], v[204:207]
    v_and_b32 v9, s60, v60
    v_add_f32 v4, v4, v8
    v_mfma_f32_16x16x32_bf16 v[208:211], v[84:87], a[144:147], v[208:211]
    buffer_load_dwordx4 v23, s[4:7], s52 offen offset:3072 lds
    ds_read_b128 v[104:107], v26 offset:53248
    ds_read_b128 v[108:111], v26 offset:55296
    v_mfma_f32_16x16x32_bf16 v[212:215], v[84:87], a[148:151], v[212:215]
    s_add_u32 s52, s52, 128
    s_add_u32 s53, s53, 221184
    v_mfma_f32_16x16x32_bf16 v[216:219], v[84:87], a[152:155], v[216:219]
    ds_read_b64_tr_b16 v[68:69], v31 offset:49152
    ds_read_b64_tr_b16 v[70:71], v31 offset:49664
    v_mfma_f32_16x16x32_bf16 v[220:223], v[84:87], a[156:159], v[220:223]
    v_add_f32 v5, v5, v9
    s_add_u32 m0, s57, 147456
    v_mfma_f32_16x16x32_bf16 v[224:227], v[88:91], a[144:147], v[224:227]
    buffer_load_dwordx4 v48, s[24:27], s56 offen nt lds
    ds_read_b64_tr_b16 v[72:73], v32 offset:49152
    ds_read_b64_tr_b16 v[74:75], v32 offset:49664
    v_mfma_f32_16x16x32_bf16 v[228:231], v[88:91], a[148:151], v[228:231]
    v_lshlrev_b32 v8, 16, v61
    v_and_b32 v9, s60, v61
    v_mfma_f32_16x16x32_bf16 v[232:235], v[88:91], a[152:155], v[232:235]
    ds_read_b64_tr_b16 v[76:77], v33 offset:49152
    ds_read_b64_tr_b16 v[78:79], v33 offset:49664
    v_add_f32 v6, v6, v8
    v_mfma_f32_16x16x32_bf16 v[236:239], v[88:91], a[156:159], v[236:239]
    v_add_f32 v7, v7, v9
    s_add_u32 m0, s57, 151552
    v_mfma_f32_16x16x32_bf16 v[240:243], v[92:95], a[144:147], v[240:243]
    buffer_load_dwordx4 v49, s[24:27], s56 offen nt lds
    v_lshlrev_b32 v8, 16, v62
    v_and_b32 v9, s60, v62
    v_mfma_f32_16x16x32_bf16 v[244:247], v[92:95], a[148:151], v[244:247]
    v_add_f32 v42, v42, v8
    v_add_f32 v43, v43, v9
    v_mfma_f32_16x16x32_bf16 v[248:251], v[92:95], a[152:155], v[248:251]
    v_lshlrev_b32 v8, 16, v63
    v_and_b32 v9, s60, v63
    v_mfma_f32_16x16x32_bf16 v[252:255], v[92:95], a[156:159], v[252:255]
    v_add_f32 v44, v44, v8
    s_add_u32 m0, s57, 155648
    s_waitcnt lgkmcnt(4)
    v_mfma_f32_16x16x32_bf16 v[128:131], v[64:67], v[96:99], v[128:131]
    s_cmp_lt_u32 s40, 2
    s_cbranch_scc0 L_nopk3
    buffer_load_dwordx4 v50, s[24:27], s56 offen nt lds
    L_nopk3:
    ds_read_b64_tr_b16 v[80:81], v30 offset:57344
    ds_read_b64_tr_b16 v[82:83], v30 offset:57856
    v_mfma_f32_16x16x32_bf16 v[132:135], v[64:67], v[100:103], v[132:135]
    v_add_f32 v45, v45, v9
    s_waitcnt vmcnt(16)
    v_mfma_f32_16x16x32_bf16 v[136:139], v[64:67], v[104:107], v[136:139]
    ds_read_b64_tr_b16 v[84:85], v31 offset:57344
    v_lshlrev_b32 v8, 16, v112
    v_and_b32 v9, s60, v112
    v_mfma_f32_16x16x32_bf16 v[140:143], v[64:67], v[108:111], v[140:143]
    v_add_f32 v4, v4, v8
    s_add_u32 m0, s51, 0
    v_mfma_f32_16x16x32_bf16 v[144:147], v[68:71], v[96:99], v[144:147]
    buffer_load_dwordx4 v24, s[8:11], s53 offen lds
    ds_read_b64_tr_b16 v[86:87], v31 offset:57856
    v_add_f32 v5, v5, v9
    v_mfma_f32_16x16x32_bf16 v[148:151], v[68:71], v[100:103], v[148:151]
    v_lshlrev_b32 v8, 16, v113
    v_and_b32 v9, s60, v113
    v_mfma_f32_16x16x32_bf16 v[152:155], v[68:71], v[104:107], v[152:155]
    ds_read_b64_tr_b16 v[88:89], v32 offset:57344
    ds_read_b64_tr_b16 v[90:91], v32 offset:57856
    v_mfma_f32_16x16x32_bf16 v[156:159], v[68:71], v[108:111], v[156:159]
    v_add_f32 v6, v6, v8
    v_add_f32 v7, v7, v9
    s_waitcnt lgkmcnt(6)
    v_mfma_f32_16x16x32_bf16 v[160:163], v[72:75], v[96:99], v[160:163]
    buffer_load_dwordx4 v25, s[8:11], s53 offen offset:1024 lds
    ds_read_b64_tr_b16 v[92:93], v33 offset:57344
    v_lshlrev_b32 v8, 16, v114
    v_mfma_f32_16x16x32_bf16 v[164:167], v[72:75], v[100:103], v[164:167]
    v_and_b32 v9, s60, v114
    v_add_f32 v42, v42, v8
    v_mfma_f32_16x16x32_bf16 v[168:171], v[72:75], v[104:107], v[168:171]
    ds_read_b64_tr_b16 v[94:95], v33 offset:57856
    v_add_f32 v43, v43, v9
    v_lshlrev_b32 v8, 16, v115
    v_mfma_f32_16x16x32_bf16 v[172:175], v[72:75], v[108:111], v[172:175]
    v_and_b32 v9, s60, v115
    s_add_u32 m0, s51, 8192
    v_mfma_f32_16x16x32_bf16 v[176:179], v[76:79], v[96:99], v[176:179]
    buffer_load_dwordx4 v24, s[12:15], s53 offen lds
    v_add_f32 v44, v44, v8
    v_add_f32 v45, v45, v9
    v_mfma_f32_16x16x32_bf16 v[180:183], v[76:79], v[100:103], v[180:183]
    s_waitcnt vmcnt(18)
    v_lshlrev_b32 v8, 16, v116
    v_mfma_f32_16x16x32_bf16 v[184:187], v[76:79], v[104:107], v[184:187]
    v_and_b32 v9, s60, v116
    v_add_f32 v4, v4, v8
    v_mfma_f32_16x16x32_bf16 v[188:191], v[76:79], v[108:111], v[188:191]
    v_add_f32 v5, v5, v9
    v_lshlrev_b32 v8, 16, v117
    s_waitcnt lgkmcnt(4)
    v_mfma_f32_16x16x32_bf16 v[192:195], v[80:83], v[96:99], v[192:195]
    buffer_load_dwordx4 v25, s[12:15], s53 offen offset:1024 lds
    ds_read_b128 a[144:147], v27 offset:49152
    ds_read_b64_tr_b16 v[64:65], v30 offset:53248
    v_mfma_f32_16x16x32_bf16 v[196:199], v[80:83], v[100:103], v[196:199]
    v_and_b32 v9, s60, v117
    v_add_f32 v6, v6, v8
    v_mfma_f32_16x16x32_bf16 v[200:203], v[80:83], v[104:107], v[200:203]
    ds_read_b64_tr_b16 v[66:67], v30 offset:53760
    ds_read_b128 a[148:151], v27 offset:51200
    v_add_f32 v7, v7, v9
    v_mfma_f32_16x16x32_bf16 v[204:207], v[80:83], v[108:111], v[204:207]
    v_lshlrev_b32 v8, 16, v118
    s_add_u32 m0, s50, 0
    v_mfma_f32_16x16x32_bf16 v[208:211], v[84:87], v[96:99], v[208:211]
    buffer_load_dwordx4 v16, s[4:7], s52 offen lds
    ds_read_b128 a[152:155], v27 offset:53248
    ds_read_b128 a[156:159], v27 offset:55296
    v_mfma_f32_16x16x32_bf16 v[212:215], v[84:87], v[100:103], v[212:215]
    v_and_b32 v9, s60, v118
    v_add_f32 v42, v42, v8
    v_mfma_f32_16x16x32_bf16 v[216:219], v[84:87], v[104:107], v[216:219]
    ds_read_b64_tr_b16 v[68:69], v31 offset:53248
    ds_read_b64_tr_b16 v[70:71], v31 offset:53760
    v_mfma_f32_16x16x32_bf16 v[220:223], v[84:87], v[108:111], v[220:223]
    v_add_f32 v43, v43, v9
    v_lshlrev_b32 v8, 16, v119
    s_waitcnt lgkmcnt(8)
    v_mfma_f32_16x16x32_bf16 v[224:227], v[88:91], v[96:99], v[224:227]
    buffer_load_dwordx4 v17, s[4:7], s52 offen offset:1024 lds
    ds_read_b64_tr_b16 v[72:73], v32 offset:53248
    ds_read_b64_tr_b16 v[74:75], v32 offset:53760
    v_mfma_f32_16x16x32_bf16 v[228:231], v[88:91], v[100:103], v[228:231]
    v_and_b32 v9, s60, v119
    v_add_f32 v44, v44, v8
    v_mfma_f32_16x16x32_bf16 v[232:235], v[88:91], v[104:107], v[232:235]
    ds_read_b64_tr_b16 v[76:77], v33 offset:53248
    ds_read_b64_tr_b16 v[78:79], v33 offset:53760
    v_add_f32 v45, v45, v9
    v_mfma_f32_16x16x32_bf16 v[236:239], v[88:91], v[108:111], v[236:239]
    s_waitcnt vmcnt(20)
    v_lshlrev_b32 v8, 16, v52
    v_mfma_f32_16x16x32_bf16 v[240:243], v[92:95], v[96:99], v[240:243]
    buffer_load_dwordx4 v18, s[4:7], s52 offen offset:2048 lds
    v_and_b32 v9, s60, v52
    v_add_f32 v4, v4, v8
    v_mfma_f32_16x16x32_bf16 v[244:247], v[92:95], v[100:103], v[244:247]
    v_add_f32 v5, v5, v9
    v_lshlrev_b32 v8, 16, v53
    v_mfma_f32_16x16x32_bf16 v[248:251], v[92:95], v[104:107], v[248:251]
    v_and_b32 v9, s60, v53
    v_add_f32 v6, v6, v8
    v_mfma_f32_16x16x32_bf16 v[252:255], v[92:95], v[108:111], v[252:255]
    v_add_f32 v7, v7, v9
    v_lshlrev_b32 v8, 16, v54
    s_waitcnt lgkmcnt(4)
    v_mfma_f32_16x16x32_bf16 v[128:131], v[64:67], a[144:147], v[128:131]
    buffer_load_dwordx4 v19, s[4:7], s52 offen offset:3072 lds
    ds_read_b64_tr_b16 v[80:81], v30 offset:61440
    ds_read_b64_tr_b16 v[82:83], v30 offset:61952
    v_mfma_f32_16x16x32_bf16 v[132:135], v[64:67], a[148:151], v[132:135]
    v_and_b32 v9, s60, v54
    v_add_f32 v42, v42, v8
    v_mfma_f32_16x16x32_bf16 v[136:139], v[64:67], a[152:155], v[136:139]
    ds_read_b64_tr_b16 v[84:85], v31 offset:61440
    v_add_f32 v43, v43, v9
    v_lshlrev_b32 v8, 16, v55
    v_mfma_f32_16x16x32_bf16 v[140:143], v[64:67], a[156:159], v[140:143]
    v_and_b32 v9, s60, v55
    s_add_u32 m0, s50, 4096
    v_mfma_f32_16x16x32_bf16 v[144:147], v[68:71], a[144:147], v[144:147]
    buffer_load_dwordx4 v20, s[4:7], s52 offen lds
    ds_read_b64_tr_b16 v[86:87], v31 offset:61952
    v_add_f32 v44, v44, v8
    v_mfma_f32_16x16x32_bf16 v[148:151], v[68:71], a[148:151], v[148:151]
    v_add_f32 v45, v45, v9
    s_nop 1
    v_mfma_f32_16x16x32_bf16 v[152:155], v[68:71], a[152:155], v[152:155]
    ds_read_b64_tr_b16 v[88:89], v32 offset:61440
    ds_read_b64_tr_b16 v[90:91], v32 offset:61952
    v_mfma_f32_16x16x32_bf16 v[156:159], v[68:71], a[156:159], v[156:159]
    v_permlane32_swap_b32 v4, v42
    v_permlane32_swap_b32 v5, v43
    s_waitcnt lgkmcnt(6)
    v_mfma_f32_16x16x32_bf16 v[160:163], v[72:75], a[144:147], v[160:163]
    buffer_load_dwordx4 v21, s[4:7], s52 offen offset:1024 lds
    ds_read_b64_tr_b16 v[92:93], v33 offset:61440
    v_permlane32_swap_b32 v6, v44
    v_mfma_f32_16x16x32_bf16 v[164:167], v[72:75], a[148:151], v[164:167]
    v_permlane32_swap_b32 v7, v45
    v_add_f32 v4, v4, v42
    v_mfma_f32_16x16x32_bf16 v[168:171], v[72:75], a[152:155], v[168:171]
    ds_read_b64_tr_b16 v[94:95], v33 offset:61952
    v_add_f32 v5, v5, v43
    v_add_f32 v6, v6, v44
    v_mfma_f32_16x16x32_bf16 v[172:175], v[72:75], a[156:159], v[172:175]
    v_add_f32 v7, v7, v45
    s_nop 1
    v_mfma_f32_16x16x32_bf16 v[176:179], v[76:79], a[144:147], v[176:179]
    buffer_load_dwordx4 v22, s[4:7], s52 offen offset:2048 lds
    v_permlane16_swap_b32 v4, v6
    v_permlane16_swap_b32 v5, v7
    v_mfma_f32_16x16x32_bf16 v[180:183], v[76:79], a[148:151], v[180:183]
    s_nop 0
    v_add_f32 v4, v4, v6
    v_mfma_f32_16x16x32_bf16 v[184:187], v[76:79], a[152:155], v[184:187]
    v_add_f32 v5, v5, v7
    v_and_b32 v6, 7, v0
    v_mfma_f32_16x16x32_bf16 v[188:191], v[76:79], a[156:159], v[188:191]
    v_lshlrev_b32 v6, 5, v6
    v_add_f32 v4, v4, v4 row_ror:8
    s_waitcnt lgkmcnt(0)
    s_waitcnt vmcnt(11)
    s_barrier
    v_mfma_f32_16x16x32_bf16 v[192:195], v[80:83], a[144:147], v[192:195]
    buffer_load_dwordx4 v23, s[4:7], s52 offen offset:3072 lds
    ds_read_b128 v[96:99], v28 offset:0
    ds_read_b64_tr_b16 v[64:65], v34 offset:0
    v_mfma_f32_16x16x32_bf16 v[196:199], v[80:83], a[148:151], v[196:199]
    s_add_u32 s52, s52, 128
    s_add_u32 s53, s53, 221184
    v_mfma_f32_16x16x32_bf16 v[200:203], v[80:83], a[152:155], v[200:203]
    ds_read_b64_tr_b16 v[66:67], v34 offset:512
    ds_read_b128 v[100:103], v28 offset:2048
    v_add_f32 v5, v5, v5 row_ror:8
    v_mfma_f32_16x16x32_bf16 v[204:207], v[80:83], a[156:159], v[204:207]
    ds_read_b64_tr_b16 a[0:1], v51 offset:0
    ds_read_b64_tr_b16 a[2:3], v51 offset:5120
    v_mfma_f32_16x16x32_bf16 v[208:211], v[84:87], a[144:147], v[208:211]
    ds_read_b128 v[104:107], v28 offset:4096
    ds_read_b128 v[108:111], v28 offset:6144
    v_lshrrev_b32 v7, 4, v0
    v_mfma_f32_16x16x32_bf16 v[212:215], v[84:87], a[148:151], v[212:215]
    ds_read_b64_tr_b16 a[4:5], v51 offset:128
    ds_read_b64_tr_b16 a[6:7], v51 offset:5248
    v_mfma_f32_16x16x32_bf16 v[216:219], v[84:87], a[152:155], v[216:219]
    ds_read_b64_tr_b16 v[68:69], v35 offset:0
    ds_read_b64_tr_b16 v[70:71], v35 offset:512
    v_mfma_f32_16x16x32_bf16 v[220:223], v[84:87], a[156:159], v[220:223]
    ds_read_b64_tr_b16 a[8:9], v51 offset:256
    ds_read_b64_tr_b16 a[10:11], v51 offset:5376
    v_mfma_f32_16x16x32_bf16 v[224:227], v[88:91], a[144:147], v[224:227]
    ds_read_b64_tr_b16 v[72:73], v36 offset:0
    ds_read_b64_tr_b16 v[74:75], v36 offset:512
    v_lshl_add_u32 v6, v7, 3, v6
    v_mfma_f32_16x16x32_bf16 v[228:231], v[88:91], a[148:151], v[228:231]
    v_mov_b32 v7, 2147418112
    v_and_b32 v8, 8, v0
    v_mfma_f32_16x16x32_bf16 v[232:235], v[88:91], a[152:155], v[232:235]
    ds_read_b64_tr_b16 v[76:77], v37 offset:0
    ds_read_b64_tr_b16 v[78:79], v37 offset:512
    v_mfma_f32_16x16x32_bf16 v[236:239], v[88:91], a[156:159], v[236:239]
    v_cmp_ne_u32 vcc, 0, v8
    s_nop 1
    v_cndmask_b32 v6, v6, v7, vcc
    v_mfma_f32_16x16x32_bf16 v[240:243], v[92:95], a[144:147], v[240:243]
    s_waitcnt lgkmcnt(4)
    buffer_store_dwordx4 a[0:3], v1, s[16:19], s97 offen sc1
    v_min_u32 v2, 53, v0
    v_mfma_f32_16x16x32_bf16 v[244:247], v[92:95], a[148:151], v[244:247]
    s_lshr_b32 s0, s83, 1
    s_lshl_b32 s0, s0, 10
    s_add_u32 s0, s0, 17408
    v_mfma_f32_16x16x32_bf16 v[248:251], v[92:95], a[152:155], v[248:251]
    v_lshl_add_u32 v2, v2, 4, s0
    v_and_b32 v3, 7, v0
    v_mfma_f32_16x16x32_bf16 v[252:255], v[92:95], a[156:159], v[252:255]
    v_mul_u32_u24 v3, 27, v3
    v_add_u32 v3, s43, v3
    v_mfma_f32_16x16x32_bf16 v[128:131], v[64:67], v[96:99], v[128:131]
    buffer_store_dwordx4 a[4:7], v1, s[16:19], s98 offen sc1
    ds_read_b64_tr_b16 v[80:81], v34 offset:8192
    v_mfma_f32_16x16x32_bf16 v[132:135], v[64:67], v[100:103], v[132:135]
    ds_read_b64_tr_b16 v[82:83], v34 offset:8704
    v_and_b32 v12, 3, v3
    v_lshrrev_b32 v3, 2, v3
    v_mfma_f32_16x16x32_bf16 v[136:139], v[64:67], v[104:107], v[136:139]
    ds_read_b64_tr_b16 v[84:85], v35 offset:8192
    v_lshl_add_u32 v3, v12, 6, v3
    v_lshlrev_b32 v3, 4, v3
    v_add_u32 v3, 17408, v3
    v_mfma_f32_16x16x32_bf16 v[140:143], v[64:67], v[108:111], v[140:143]
    v_cmp_lt_u32 vcc, 55, v0
    s_nop 1
    v_cndmask_b32 v119, v2, v3, vcc
    v_mfma_f32_16x16x32_bf16 v[144:147], v[68:71], v[96:99], v[144:147]
    buffer_store_dwordx4 a[8:11], v1, s[16:19], s99 offen sc1
    ds_read_b64_tr_b16 v[86:87], v35 offset:8704
    s_lshl_b32 s55, s43, 1
    s_add_u32 s55, s55, s63
    s_lshl_b32 s55, s55, 3
    s_add_u32 s55, s55, s42
    v_mfma_f32_16x16x32_bf16 v[148:151], v[68:71], v[100:103], v[148:151]
    s_lshl_b32 s55, s55, 1
    s_add_u32 s55, s55, s62
    s_lshl_b32 s55, s55, 8
    s_add_u32 s55, s55, 14614528
    v_mfma_f32_16x16x32_bf16 v[152:155], v[68:71], v[104:107], v[152:155]
    buffer_store_dwordx2 v[4:5], v6, s[16:19], s55 offen sc1
    ds_read_b64_tr_b16 v[88:89], v36 offset:8192
    v_mfma_f32_16x16x32_bf16 v[156:159], v[68:71], v[108:111], v[156:159]
    ds_read_b64_tr_b16 v[90:91], v36 offset:8704
    v_add_u32 v118, 4096, v1
    s_waitcnt lgkmcnt(6)
    v_mfma_f32_16x16x32_bf16 v[160:163], v[72:75], v[96:99], v[160:163]
    ds_read_b64_tr_b16 v[92:93], v37 offset:8192
    s_mul_i32 s0, s40, 14
    v_mfma_f32_16x16x32_bf16 v[164:167], v[72:75], v[100:103], v[164:167]
    s_cmp_eq_u32 s40, 3
    s_cselect_b32 s1, 1, 0
    s_sub_u32 s0, s0, s1
    v_mfma_f32_16x16x32_bf16 v[168:171], v[72:75], v[104:107], v[168:171]
    ds_read_b64_tr_b16 v[94:95], v37 offset:8704
    s_mul_i32 s1, s83, 54
    s_add_u32 s1, s0, s1
    v_mfma_f32_16x16x32_bf16 v[172:175], v[72:75], v[108:111], v[172:175]
    s_mul_i32 s1, s1, 5120
    s_add_u32 s84, s1, 5308416
    v_mfma_f32_16x16x32_bf16 v[176:179], v[76:79], v[96:99], v[176:179]
    s_add_u32 s1, s40, 1
    s_and_b32 s1, s1, 3
    s_lshl_b32 s3, s82, 2
    v_mfma_f32_16x16x32_bf16 v[180:183], v[76:79], v[100:103], v[180:183]
    s_add_u32 s1, s1, s3
    s_mul_i32 s1, s1, 54
    v_mfma_f32_16x16x32_bf16 v[184:187], v[76:79], v[104:107], v[184:187]
    s_add_u32 s1, s1, s0
    s_lshl_b32 s1, s1, 10
    v_mfma_f32_16x16x32_bf16 v[188:191], v[76:79], v[108:111], v[188:191]
    s_add_u32 s66, s1, 7536640
    s_add_u32 s67, s66, 4096
    s_waitcnt lgkmcnt(4)
    v_mfma_f32_16x16x32_bf16 v[192:195], v[80:83], v[96:99], v[192:195]
    ds_read_b128 a[144:147], v29 offset:0
    ds_read_b64_tr_b16 v[64:65], v34 offset:4096
    v_mfma_f32_16x16x32_bf16 v[196:199], v[80:83], v[100:103], v[196:199]
    s_add_u32 s68, s66, 8192
    v_mfma_f32_16x16x32_bf16 v[200:203], v[80:83], v[104:107], v[200:203]
    ds_read_b64_tr_b16 v[66:67], v34 offset:4608
    ds_read_b128 a[148:151], v29 offset:2048
    v_mfma_f32_16x16x32_bf16 v[204:207], v[80:83], v[108:111], v[204:207]
    s_add_u32 s69, s66, 12288
    v_mfma_f32_16x16x32_bf16 v[208:211], v[84:87], v[96:99], v[208:211]
    ds_read_b128 a[152:155], v29 offset:4096
    ds_read_b128 a[156:159], v29 offset:6144
    v_mfma_f32_16x16x32_bf16 v[212:215], v[84:87], v[100:103], v[212:215]
    s_add_u32 s1, s40, 2
    v_mfma_f32_16x16x32_bf16 v[216:219], v[84:87], v[104:107], v[216:219]
    ds_read_b64_tr_b16 v[68:69], v35 offset:4096
    ds_read_b64_tr_b16 v[70:71], v35 offset:4608
    v_mfma_f32_16x16x32_bf16 v[220:223], v[84:87], v[108:111], v[220:223]
    s_add_u32 m0, s51, 49152
    s_waitcnt lgkmcnt(8)
    v_mfma_f32_16x16x32_bf16 v[224:227], v[88:91], v[96:99], v[224:227]
    buffer_load_dwordx4 v24, s[8:11], s53 offen lds
    ds_read_b64_tr_b16 v[72:73], v36 offset:4096
    v_mfma_f32_16x16x32_bf16 v[228:231], v[88:91], v[100:103], v[228:231]
    ds_read_b64_tr_b16 v[74:75], v36 offset:4608
    v_mfma_f32_16x16x32_bf16 v[232:235], v[88:91], v[104:107], v[232:235]
    ds_read_b64_tr_b16 v[76:77], v37 offset:4096
    ds_read_b64_tr_b16 v[78:79], v37 offset:4608
    v_mfma_f32_16x16x32_bf16 v[236:239], v[88:91], v[108:111], v[236:239]
    s_and_b32 s1, s1, 3
    v_mfma_f32_16x16x32_bf16 v[240:243], v[92:95], v[96:99], v[240:243]
    buffer_load_dwordx4 v25, s[8:11], s53 offen offset:1024 lds
    s_lshl_b32 s3, s82, 2
    v_mfma_f32_16x16x32_bf16 v[244:247], v[92:95], v[100:103], v[244:247]
    s_add_u32 s1, s1, s3
    v_mfma_f32_16x16x32_bf16 v[248:251], v[92:95], v[104:107], v[248:251]
    s_mul_i32 s1, s1, 54
    v_mfma_f32_16x16x32_bf16 v[252:255], v[92:95], v[108:111], v[252:255]
    s_add_u32 m0, s51, 57344
    s_waitcnt lgkmcnt(4)
    v_mfma_f32_16x16x32_bf16 v[128:131], v[64:67], a[144:147], v[128:131]
    buffer_load_dwordx4 v24, s[12:15], s53 offen lds
    ds_read_b64_tr_b16 v[80:81], v34 offset:12288
    v_mfma_f32_16x16x32_bf16 v[132:135], v[64:67], a[148:151], v[132:135]
    ds_read_b64_tr_b16 v[82:83], v34 offset:12800
    v_mfma_f32_16x16x32_bf16 v[136:139], v[64:67], a[152:155], v[136:139]
    ds_read_b64_tr_b16 v[84:85], v35 offset:12288
    s_add_u32 s1, s1, s0
    v_mfma_f32_16x16x32_bf16 v[140:143], v[64:67], a[156:159], v[140:143]
    s_lshl_b32 s1, s1, 10
    v_mfma_f32_16x16x32_bf16 v[144:147], v[68:71], a[144:147], v[144:147]
    buffer_load_dwordx4 v25, s[12:15], s53 offen offset:1024 lds
    ds_read_b64_tr_b16 v[86:87], v35 offset:12800
    v_mfma_f32_16x16x32_bf16 v[148:151], v[68:71], a[148:151], v[148:151]
    s_add_u32 s70, s1, 7536640
    v_mfma_f32_16x16x32_bf16 v[152:155], v[68:71], a[152:155], v[152:155]
    ds_read_b64_tr_b16 v[88:89], v36 offset:12288
    ds_read_b64_tr_b16 v[90:91], v36 offset:12800
    v_mfma_f32_16x16x32_bf16 v[156:159], v[68:71], a[156:159], v[156:159]
    s_add_u32 m0, s50, 49152
    s_waitcnt lgkmcnt(6)
    v_mfma_f32_16x16x32_bf16 v[160:163], v[72:75], a[144:147], v[160:163]
    buffer_load_dwordx4 v16, s[4:7], s52 offen lds
    ds_read_b64_tr_b16 v[92:93], v37 offset:12288
    v_mfma_f32_16x16x32_bf16 v[164:167], v[72:75], a[148:151], v[164:167]
    s_add_u32 s71, s70, 4096
    v_mfma_f32_16x16x32_bf16 v[168:171], v[72:75], a[152:155], v[168:171]
    ds_read_b64_tr_b16 v[94:95], v37 offset:12800
    s_add_u32 s72, s70, 8192
    v_mfma_f32_16x16x32_bf16 v[172:175], v[72:75], a[156:159], v[172:175]
    s_add_u32 s73, s70, 12288
    v_mfma_f32_16x16x32_bf16 v[176:179], v[76:79], a[144:147], v[176:179]
    buffer_load_dwordx4 v17, s[4:7], s52 offen offset:1024 lds
    s_add_u32 s1, s40, 3
    v_mfma_f32_16x16x32_bf16 v[180:183], v[76:79], a[148:151], v[180:183]
    s_and_b32 s1, s1, 3
    v_mfma_f32_16x16x32_bf16 v[184:187], v[76:79], a[152:155], v[184:187]
    s_lshl_b32 s3, s82, 2
    v_mfma_f32_16x16x32_bf16 v[188:191], v[76:79], a[156:159], v[188:191]
    s_add_u32 s1, s1, s3
    s_waitcnt lgkmcnt(0)
    s_waitcnt vmcnt(10)
    s_barrier
    v_mfma_f32_16x16x32_bf16 v[192:195], v[80:83], a[144:147], v[192:195]
    buffer_load_dwordx4 v18, s[4:7], s52 offen offset:2048 lds
    ds_read_b128 v[96:99], v26 offset:0
    v_mfma_f32_16x16x32_bf16 v[196:199], v[80:83], a[148:151], v[196:199]
    ds_read_b64_tr_b16 v[64:65], v30 offset:0
    v_mfma_f32_16x16x32_bf16 v[200:203], v[80:83], a[152:155], v[200:203]
    ds_read_b64_tr_b16 v[66:67], v30 offset:512
    ds_read_b128 v[100:103], v26 offset:2048
    v_mfma_f32_16x16x32_bf16 v[204:207], v[80:83], a[156:159], v[204:207]
    s_mul_i32 s1, s1, 54
    v_mfma_f32_16x16x32_bf16 v[208:211], v[84:87], a[144:147], v[208:211]
    buffer_load_dwordx4 v19, s[4:7], s52 offen offset:3072 lds
    ds_read_b128 v[104:107], v26 offset:4096
    v_mfma_f32_16x16x32_bf16 v[212:215], v[84:87], a[148:151], v[212:215]
    ds_read_b128 v[108:111], v26 offset:6144
    v_mfma_f32_16x16x32_bf16 v[216:219], v[84:87], a[152:155], v[216:219]
    ds_read_b64_tr_b16 v[68:69], v31 offset:0
    ds_read_b64_tr_b16 v[70:71], v31 offset:512
    v_mfma_f32_16x16x32_bf16 v[220:223], v[84:87], a[156:159], v[220:223]
    s_add_u32 m0, s50, 53248
    v_mfma_f32_16x16x32_bf16 v[224:227], v[88:91], a[144:147], v[224:227]
    buffer_load_dwordx4 v20, s[4:7], s52 offen lds
    ds_read_b64_tr_b16 v[72:73], v32 offset:0
    v_mfma_f32_16x16x32_bf16 v[228:231], v[88:91], a[148:151], v[228:231]
    ds_read_b64_tr_b16 v[74:75], v32 offset:512
    v_mfma_f32_16x16x32_bf16 v[232:235], v[88:91], a[152:155], v[232:235]
    ds_read_b64_tr_b16 v[76:77], v33 offset:0
    ds_read_b64_tr_b16 v[78:79], v33 offset:512
    v_mfma_f32_16x16x32_bf16 v[236:239], v[88:91], a[156:159], v[236:239]
    s_add_u32 s1, s1, s0
    v_mfma_f32_16x16x32_bf16 v[240:243], v[92:95], a[144:147], v[240:243]
    buffer_load_dwordx4 v21, s[4:7], s52 offen offset:1024 lds
    s_lshl_b32 s1, s1, 10
    v_mfma_f32_16x16x32_bf16 v[244:247], v[92:95], a[148:151], v[244:247]
    s_add_u32 s74, s1, 7536640
    v_mfma_f32_16x16x32_bf16 v[248:251], v[92:95], a[152:155], v[248:251]
    s_add_u32 s75, s74, 4096
    v_mfma_f32_16x16x32_bf16 v[252:255], v[92:95], a[156:159], v[252:255]
    s_add_u32 s76, s74, 8192
    s_waitcnt lgkmcnt(4)
    v_mfma_f32_16x16x32_bf16 v[128:131], v[64:67], v[96:99], v[128:131]
    buffer_load_dwordx4 v22, s[4:7], s52 offen offset:2048 lds
    ds_read_b64_tr_b16 v[80:81], v30 offset:8192
    v_mfma_f32_16x16x32_bf16 v[132:135], v[64:67], v[100:103], v[132:135]
    ds_read_b64_tr_b16 v[82:83], v30 offset:8704
    v_mfma_f32_16x16x32_bf16 v[136:139], v[64:67], v[104:107], v[136:139]
    ds_read_b64_tr_b16 v[84:85], v31 offset:8192
    s_add_u32 s77, s74, 12288
    v_mfma_f32_16x16x32_bf16 v[140:143], v[64:67], v[108:111], v[140:143]
    s_add_u32 s1, s40, 4
    v_mfma_f32_16x16x32_bf16 v[144:147], v[68:71], v[96:99], v[144:147]
    buffer_load_dwordx4 v23, s[4:7], s52 offen offset:3072 lds
    ds_read_b64_tr_b16 v[86:87], v31 offset:8704
    s_add_u32 s52, s52, 128
    s_add_u32 s53, s53, 221184
    v_mfma_f32_16x16x32_bf16 v[148:151], v[68:71], v[100:103], v[148:151]
    s_lshl_b32 s55, s65, 6
    s_add_u32 s55, s55, s64
    s_lshl_b32 s55, s55, 2
    s_add_u32 s55, s55, s40
    s_lshl_b32 s55, s55, 2
    s_add_u32 s55, s55, 17408
    v_mfma_f32_16x16x32_bf16 v[152:155], v[68:71], v[104:107], v[152:155]
    s_waitcnt vmcnt(12)
    buffer_store_dword v120, v121, s[16:19], s55 offen sc1
    ds_read_b64_tr_b16 v[88:89], v32 offset:8192
    v_mfma_f32_16x16x32_bf16 v[156:159], v[68:71], v[108:111], v[156:159]
    ds_read_b64_tr_b16 v[90:91], v32 offset:8704
    s_waitcnt lgkmcnt(6)
    v_mfma_f32_16x16x32_bf16 v[160:163], v[72:75], v[96:99], v[160:163]
    ds_read_b64_tr_b16 v[92:93], v33 offset:8192
    s_and_b32 s1, s1, 3
    v_mfma_f32_16x16x32_bf16 v[164:167], v[72:75], v[100:103], v[164:167]
    s_lshl_b32 s3, s82, 2
    v_mfma_f32_16x16x32_bf16 v[168:171], v[72:75], v[104:107], v[168:171]
    ds_read_b64_tr_b16 v[94:95], v33 offset:8704
    s_add_u32 s1, s1, s3
    v_mfma_f32_16x16x32_bf16 v[172:175], v[72:75], v[108:111], v[172:175]
    s_mul_i32 s1, s1, 54
    v_mfma_f32_16x16x32_bf16 v[176:179], v[76:79], v[96:99], v[176:179]
    s_add_u32 s1, s1, s0
    s_lshl_b32 s1, s1, 10
    v_mfma_f32_16x16x32_bf16 v[180:183], v[76:79], v[100:103], v[180:183]
    s_add_u32 s78, s1, 7536640
    v_mfma_f32_16x16x32_bf16 v[184:187], v[76:79], v[104:107], v[184:187]
    s_add_u32 s79, s78, 4096
    v_mfma_f32_16x16x32_bf16 v[188:191], v[76:79], v[108:111], v[188:191]
    s_add_u32 s80, s78, 8192
    s_waitcnt lgkmcnt(4)
    v_mfma_f32_16x16x32_bf16 v[192:195], v[80:83], v[96:99], v[192:195]
    ds_read_b128 a[144:147], v27 offset:0
    ds_read_b64_tr_b16 v[64:65], v30 offset:4096
    v_mfma_f32_16x16x32_bf16 v[196:199], v[80:83], v[100:103], v[196:199]
    s_add_u32 s81, s78, 12288
    v_mfma_f32_16x16x32_bf16 v[200:203], v[80:83], v[104:107], v[200:203]
    ds_read_b64_tr_b16 v[66:67], v30 offset:4608
    ds_read_b128 a[148:151], v27 offset:2048
    v_mfma_f32_16x16x32_bf16 v[204:207], v[80:83], v[108:111], v[204:207]
    s_lshl_b32 s86, s82, 2
    v_mfma_f32_16x16x32_bf16 v[208:211], v[84:87], v[96:99], v[208:211]
    ds_read_b128 a[152:155], v27 offset:4096
    ds_read_b128 a[156:159], v27 offset:6144
    v_mfma_f32_16x16x32_bf16 v[212:215], v[84:87], v[100:103], v[212:215]
    s_add_u32 s86, s86, s40
    v_mfma_f32_16x16x32_bf16 v[216:219], v[84:87], v[104:107], v[216:219]
    ds_read_b64_tr_b16 v[68:69], v31 offset:4096
    ds_read_b64_tr_b16 v[70:71], v31 offset:4608
    v_mfma_f32_16x16x32_bf16 v[220:223], v[84:87], v[108:111], v[220:223]
    s_add_u32 m0, s51, 98304
    s_waitcnt lgkmcnt(8)
    v_mfma_f32_16x16x32_bf16 v[224:227], v[88:91], v[96:99], v[224:227]
    buffer_load_dwordx4 v24, s[8:11], s53 offen lds
    ds_read_b64_tr_b16 v[72:73], v32 offset:4096
    v_mfma_f32_16x16x32_bf16 v[228:231], v[88:91], v[100:103], v[228:231]
    ds_read_b64_tr_b16 v[74:75], v32 offset:4608
    v_mfma_f32_16x16x32_bf16 v[232:235], v[88:91], v[104:107], v[232:235]
    ds_read_b64_tr_b16 v[76:77], v33 offset:4096
    ds_read_b64_tr_b16 v[78:79], v33 offset:4608
    v_mfma_f32_16x16x32_bf16 v[236:239], v[88:91], v[108:111], v[236:239]
    s_mul_i32 s86, s86, 20480
    v_mfma_f32_16x16x32_bf16 v[240:243], v[92:95], v[96:99], v[240:243]
    buffer_load_dwordx4 v25, s[8:11], s53 offen offset:1024 lds
    s_mul_i32 s0, s83, 160
    v_mfma_f32_16x16x32_bf16 v[244:247], v[92:95], v[100:103], v[244:247]
    s_add_u32 s86, s86, s0
    v_mfma_f32_16x16x32_bf16 v[248:251], v[92:95], v[104:107], v[248:251]
    s_mul_i32 s94, s40, 3072
    v_mfma_f32_16x16x32_bf16 v[252:255], v[92:95], v[108:111], v[252:255]
    s_add_u32 m0, s51, 106496
    s_waitcnt lgkmcnt(4)
    v_mfma_f32_16x16x32_bf16 v[128:131], v[64:67], a[144:147], v[128:131]
    buffer_load_dwordx4 v24, s[12:15], s53 offen lds
    ds_read_b64_tr_b16 v[80:81], v30 offset:12288
    v_mfma_f32_16x16x32_bf16 v[132:135], v[64:67], a[148:151], v[132:135]
    ds_read_b64_tr_b16 v[82:83], v30 offset:12800
    v_mfma_f32_16x16x32_bf16 v[136:139], v[64:67], a[152:155], v[136:139]
    ds_read_b64_tr_b16 v[84:85], v31 offset:12288
    s_add_u32 s94, s94, 112128
    v_mfma_f32_16x16x32_bf16 v[140:143], v[64:67], a[156:159], v[140:143]
    s_mul_i32 s95, s83, 80
    v_mfma_f32_16x16x32_bf16 v[144:147], v[68:71], a[144:147], v[144:147]
    buffer_load_dwordx4 v25, s[12:15], s53 offen offset:1024 lds
    ds_read_b64_tr_b16 v[86:87], v31 offset:12800
    v_mfma_f32_16x16x32_bf16 v[148:151], v[68:71], a[148:151], v[148:151]
    s_lshl_b32 s95, s95, 12
    v_mfma_f32_16x16x32_bf16 v[152:155], v[68:71], a[152:155], v[152:155]
    ds_read_b64_tr_b16 v[88:89], v32 offset:12288
    ds_read_b64_tr_b16 v[90:91], v32 offset:12800
    v_mfma_f32_16x16x32_bf16 v[156:159], v[68:71], a[156:159], v[156:159]
    s_add_u32 m0, s50, 98304
    s_waitcnt lgkmcnt(6)
    v_mfma_f32_16x16x32_bf16 v[160:163], v[72:75], a[144:147], v[160:163]
    buffer_load_dwordx4 v16, s[4:7], s52 offen lds
    ds_read_b64_tr_b16 v[92:93], v33 offset:12288
    v_mfma_f32_16x16x32_bf16 v[164:167], v[72:75], a[148:151], v[164:167]
    s_lshl_b32 s0, s82, 2
    v_mfma_f32_16x16x32_bf16 v[168:171], v[72:75], a[152:155], v[168:171]
    ds_read_b64_tr_b16 v[94:95], v33 offset:12800
    s_add_u32 s0, s0, s40
    v_mfma_f32_16x16x32_bf16 v[172:175], v[72:75], a[156:159], v[172:175]
    s_lshl_b32 s0, s0, 5
    v_mfma_f32_16x16x32_bf16 v[176:179], v[76:79], a[144:147], v[176:179]
    buffer_load_dwordx4 v17, s[4:7], s52 offen offset:1024 lds
    s_add_u32 s95, s95, s0
    v_mfma_f32_16x16x32_bf16 v[180:183], v[76:79], a[148:151], v[180:183]
    s_add_u32 s95, s95, 2686976
    v_mfma_f32_16x16x32_bf16 v[184:187], v[76:79], a[152:155], v[184:187]
    v_lshrrev_b32 v3, 4, v0
    v_mfma_f32_16x16x32_bf16 v[188:191], v[76:79], a[156:159], v[188:191]
    v_lshlrev_b32 v13, 4, v3
    s_waitcnt lgkmcnt(0)
    s_waitcnt vmcnt(6)
    s_barrier
    v_mfma_f32_16x16x32_bf16 v[192:195], v[80:83], a[144:147], v[192:195]
    buffer_load_dwordx4 v18, s[4:7], s52 offen offset:2048 lds
    ds_read_b128 v[96:99], v26 offset:49152
    v_mfma_f32_16x16x32_bf16 v[196:199], v[80:83], a[148:151], v[196:199]
    ds_read_b64_tr_b16 v[64:65], v30 offset:49152
    v_mfma_f32_16x16x32_bf16 v[200:203], v[80:83], a[152:155], v[200:203]
    ds_read_b64_tr_b16 v[66:67], v30 offset:49664
    ds_read_b128 v[100:103], v26 offset:51200
    v_mfma_f32_16x16x32_bf16 v[204:207], v[80:83], a[156:159], v[204:207]
    v_add_u32 v13, 163328, v13
    v_mfma_f32_16x16x32_bf16 v[208:211], v[84:87], a[144:147], v[208:211]
    buffer_load_dwordx4 v19, s[4:7], s52 offen offset:3072 lds
    ds_read_b128 v[104:107], v26 offset:53248
    v_mfma_f32_16x16x32_bf16 v[212:215], v[84:87], a[148:151], v[212:215]
    ds_read_b128 v[108:111], v26 offset:55296
    v_mfma_f32_16x16x32_bf16 v[216:219], v[84:87], a[152:155], v[216:219]
    ds_read_b64_tr_b16 v[68:69], v31 offset:49152
    ds_read_b64_tr_b16 v[70:71], v31 offset:49664
    v_mfma_f32_16x16x32_bf16 v[220:223], v[84:87], a[156:159], v[220:223]
    s_add_u32 m0, s50, 102400
    v_mfma_f32_16x16x32_bf16 v[224:227], v[88:91], a[144:147], v[224:227]
    buffer_load_dwordx4 v20, s[4:7], s52 offen lds
    ds_read_b64_tr_b16 v[72:73], v32 offset:49152
    v_mfma_f32_16x16x32_bf16 v[228:231], v[88:91], a[148:151], v[228:231]
    ds_read_b64_tr_b16 v[74:75], v32 offset:49664
    v_mfma_f32_16x16x32_bf16 v[232:235], v[88:91], a[152:155], v[232:235]
    ds_read_b64_tr_b16 v[76:77], v33 offset:49152
    ds_read_b64_tr_b16 v[78:79], v33 offset:49664
    v_mfma_f32_16x16x32_bf16 v[236:239], v[88:91], a[156:159], v[236:239]
    v_lshrrev_b32 v3, 5, v0
    v_mfma_f32_16x16x32_bf16 v[240:243], v[92:95], a[144:147], v[240:243]
    buffer_load_dwordx4 v21, s[4:7], s52 offen offset:1024 lds
    v_and_b32 v2, 7, v0
    v_mfma_f32_16x16x32_bf16 v[244:247], v[92:95], a[148:151], v[244:247]
    v_lshlrev_b32 v12, 4, v2
    v_mfma_f32_16x16x32_bf16 v[248:251], v[92:95], a[152:155], v[248:251]
    v_lshl_add_u32 v12, v3, 3, v12
    v_mfma_f32_16x16x32_bf16 v[252:255], v[92:95], a[156:159], v[252:255]
    v_bfe_u32 v3, v0, 4, 1
    s_waitcnt lgkmcnt(4)
    v_mfma_f32_16x16x32_bf16 v[128:131], v[64:67], v[96:99], v[128:131]
    buffer_load_dwordx4 v22, s[4:7], s52 offen offset:2048 lds
    ds_read_b64_tr_b16 v[80:81], v30 offset:57344
    v_mfma_f32_16x16x32_bf16 v[132:135], v[64:67], v[100:103], v[132:135]
    ds_read_b64_tr_b16 v[82:83], v30 offset:57856
    v_mfma_f32_16x16x32_bf16 v[136:139], v[64:67], v[104:107], v[136:139]
    ds_read_b64_tr_b16 v[84:85], v31 offset:57344
    v_lshl_add_u32 v12, v3, 2, v12
    v_mfma_f32_16x16x32_bf16 v[140:143], v[64:67], v[108:111], v[140:143]
    s_lshl_b32 s0, s40, 7
    v_mfma_f32_16x16x32_bf16 v[144:147], v[68:71], v[96:99], v[144:147]
    buffer_load_dwordx4 v23, s[4:7], s52 offen offset:3072 lds
    ds_read_b64_tr_b16 v[86:87], v31 offset:57856
    v_mfma_f32_16x16x32_bf16 v[148:151], v[68:71], v[100:103], v[148:151]
    s_add_u32 s52, s52, 128
    s_add_u32 s53, s53, 221184
    v_mfma_f32_16x16x32_bf16 v[152:155], v[68:71], v[104:107], v[152:155]
    ds_read_b64_tr_b16 v[88:89], v32 offset:57344
    ds_read_b64_tr_b16 v[90:91], v32 offset:57856
    v_mfma_f32_16x16x32_bf16 v[156:159], v[68:71], v[108:111], v[156:159]
    s_add_u32 m0, s51, 0
    s_waitcnt lgkmcnt(6)
    v_mfma_f32_16x16x32_bf16 v[160:163], v[72:75], v[96:99], v[160:163]
    buffer_load_dwordx4 v24, s[8:11], s53 offen lds
    ds_read_b64_tr_b16 v[92:93], v33 offset:57344
    v_mfma_f32_16x16x32_bf16 v[164:167], v[72:75], v[100:103], v[164:167]
    s_add_u32 s0, s0, 163328
    v_mfma_f32_16x16x32_bf16 v[168:171], v[72:75], v[104:107], v[168:171]
    ds_read_b64_tr_b16 v[94:95], v33 offset:57856
    v_add_u32 v12, s0, v12
    v_mfma_f32_16x16x32_bf16 v[172:175], v[72:75], v[108:111], v[172:175]
    v_lshrrev_b32 v3, 3, v0
    v_mfma_f32_16x16x32_bf16 v[176:179], v[76:79], v[96:99], v[176:179]
    buffer_load_dwordx4 v25, s[8:11], s53 offen offset:1024 lds
    v_lshlrev_b32 v3, 8, v3
    v_mfma_f32_16x16x32_bf16 v[180:183], v[76:79], v[100:103], v[180:183]
    v_lshl_add_u32 v42, v2, 4, v3
    v_mfma_f32_16x16x32_bf16 v[184:187], v[76:79], v[104:107], v[184:187]
    v_and_b32 v15, 15, v0
    v_mfma_f32_16x16x32_bf16 v[188:191], v[76:79], v[108:111], v[188:191]
    s_add_u32 m0, s51, 8192
    s_waitcnt lgkmcnt(4)
    v_mfma_f32_16x16x32_bf16 v[192:195], v[80:83], v[96:99], v[192:195]
    buffer_load_dwordx4 v24, s[12:15], s53 offen lds
    ds_read_b128 a[144:147], v27 offset:49152
    v_mfma_f32_16x16x32_bf16 v[196:199], v[80:83], v[100:103], v[196:199]
    ds_read_b64_tr_b16 v[64:65], v30 offset:53248
    v_mfma_f32_16x16x32_bf16 v[200:203], v[80:83], v[104:107], v[200:203]
    ds_read_b64_tr_b16 v[66:67], v30 offset:53760
    ds_read_b128 a[148:151], v27 offset:51200
    v_mfma_f32_16x16x32_bf16 v[204:207], v[80:83], v[108:111], v[204:207]
    v_lshlrev_b32 v15, 4, v15
    v_mfma_f32_16x16x32_bf16 v[208:211], v[84:87], v[96:99], v[208:211]
    buffer_load_dwordx4 v25, s[12:15], s53 offen offset:1024 lds
    ds_read_b128 a[152:155], v27 offset:53248
    v_mfma_f32_16x16x32_bf16 v[212:215], v[84:87], v[100:103], v[212:215]
    ds_read_b128 a[156:159], v27 offset:55296
    v_mfma_f32_16x16x32_bf16 v[216:219], v[84:87], v[104:107], v[216:219]
    ds_read_b64_tr_b16 v[68:69], v31 offset:53248
    ds_read_b64_tr_b16 v[70:71], v31 offset:53760
    v_mfma_f32_16x16x32_bf16 v[220:223], v[84:87], v[108:111], v[220:223]
    s_add_u32 m0, s50, 0
    s_waitcnt lgkmcnt(8)
    v_mfma_f32_16x16x32_bf16 v[224:227], v[88:91], v[96:99], v[224:227]
    buffer_load_dwordx4 v16, s[4:7], s52 offen lds
    ds_read_b64_tr_b16 v[72:73], v32 offset:53248
    v_mfma_f32_16x16x32_bf16 v[228:231], v[88:91], v[100:103], v[228:231]
    ds_read_b64_tr_b16 v[74:75], v32 offset:53760
    v_mfma_f32_16x16x32_bf16 v[232:235], v[88:91], v[104:107], v[232:235]
    ds_read_b64_tr_b16 v[76:77], v33 offset:53248
    v_mfma_f32_16x16x32_bf16 v[236:239], v[88:91], v[108:111], v[236:239]
    ds_read_b64_tr_b16 v[78:79], v33 offset:53760
    v_mfma_f32_16x16x32_bf16 v[240:243], v[92:95], v[96:99], v[240:243]
    buffer_load_dwordx4 v17, s[4:7], s52 offen offset:1024 lds
    v_mfma_f32_16x16x32_bf16 v[244:247], v[92:95], v[100:103], v[244:247]
    v_mfma_f32_16x16x32_bf16 v[248:251], v[92:95], v[104:107], v[248:251]
    v_mfma_f32_16x16x32_bf16 v[252:255], v[92:95], v[108:111], v[252:255]
    s_waitcnt lgkmcnt(4)
    v_mfma_f32_16x16x32_bf16 v[128:131], v[64:67], a[144:147], v[128:131]
    buffer_load_dwordx4 v18, s[4:7], s52 offen offset:2048 lds
    ds_read_b64_tr_b16 v[80:81], v30 offset:61440
    v_mfma_f32_16x16x32_bf16 v[132:135], v[64:67], a[148:151], v[132:135]
    ds_read_b64_tr_b16 v[82:83], v30 offset:61952
    v_mfma_f32_16x16x32_bf16 v[136:139], v[64:67], a[152:155], v[136:139]
    ds_read_b64_tr_b16 v[84:85], v31 offset:61440
    v_mfma_f32_16x16x32_bf16 v[140:143], v[64:67], a[156:159], v[140:143]
    v_mfma_f32_16x16x32_bf16 v[144:147], v[68:71], a[144:147], v[144:147]
    buffer_load_dwordx4 v19, s[4:7], s52 offen offset:3072 lds
    v_mfma_f32_16x16x32_bf16 v[148:151], v[68:71], a[148:151], v[148:151]
    ds_read_b64_tr_b16 v[86:87], v31 offset:61952
    v_mfma_f32_16x16x32_bf16 v[152:155], v[68:71], a[152:155], v[152:155]
    ds_read_b64_tr_b16 v[88:89], v32 offset:61440
    ds_read_b64_tr_b16 v[90:91], v32 offset:61952
    v_mfma_f32_16x16x32_bf16 v[156:159], v[68:71], a[156:159], v[156:159]
    s_add_u32 m0, s50, 4096
    s_waitcnt lgkmcnt(6)
    v_mfma_f32_16x16x32_bf16 v[160:163], v[72:75], a[144:147], v[160:163]
    buffer_load_dwordx4 v20, s[4:7], s52 offen lds
    v_mfma_f32_16x16x32_bf16 v[164:167], v[72:75], a[148:151], v[164:167]
    ds_read_b64_tr_b16 v[92:93], v33 offset:61440
    v_mfma_f32_16x16x32_bf16 v[168:171], v[72:75], a[152:155], v[168:171]
    ds_read_b64_tr_b16 v[94:95], v33 offset:61952
    v_mfma_f32_16x16x32_bf16 v[172:175], v[72:75], a[156:159], v[172:175]
    v_mfma_f32_16x16x32_bf16 v[176:179], v[76:79], a[144:147], v[176:179]
    buffer_load_dwordx4 v21, s[4:7], s52 offen offset:1024 lds
    v_mfma_f32_16x16x32_bf16 v[180:183], v[76:79], a[148:151], v[180:183]
    v_mfma_f32_16x16x32_bf16 v[184:187], v[76:79], a[152:155], v[184:187]
    v_mfma_f32_16x16x32_bf16 v[188:191], v[76:79], a[156:159], v[188:191]
    s_waitcnt lgkmcnt(0)
    s_waitcnt vmcnt(10)
    s_barrier
    v_mfma_f32_16x16x32_bf16 v[192:195], v[80:83], a[144:147], v[192:195]
    buffer_load_dwordx4 v22, s[4:7], s52 offen offset:2048 lds
    ds_read_b128 v[96:99], v28 offset:0
    v_mfma_f32_16x16x32_bf16 v[196:199], v[80:83], a[148:151], v[196:199]
    ds_read_b64_tr_b16 v[64:65], v34 offset:0
    v_mfma_f32_16x16x32_bf16 v[200:203], v[80:83], a[152:155], v[200:203]
    ds_read_b64_tr_b16 v[66:67], v34 offset:512
    v_mfma_f32_16x16x32_bf16 v[204:207], v[80:83], a[156:159], v[204:207]
    ds_read_b128 v[100:103], v28 offset:2048
    v_mfma_f32_16x16x32_bf16 v[208:211], v[84:87], a[144:147], v[208:211]
    buffer_load_dwordx4 v23, s[4:7], s52 offen offset:3072 lds
    ds_read_b128 v[104:107], v28 offset:4096
    ds_read_b128 v[108:111], v28 offset:6144
    v_mfma_f32_16x16x32_bf16 v[212:215], v[84:87], a[148:151], v[212:215]
    s_add_u32 s52, s52, 128
    s_add_u32 s53, s53, 221184
    v_mfma_f32_16x16x32_bf16 v[216:219], v[84:87], a[152:155], v[216:219]
    ds_read_b64_tr_b16 v[68:69], v35 offset:0
    ds_read_b64_tr_b16 v[70:71], v35 offset:512
    v_mfma_f32_16x16x32_bf16 v[220:223], v[84:87], a[156:159], v[220:223]
    s_mul_i32 s58, s40, 12288
    s_add_u32 s58, s58, L_tab - L_pc + 0
    v_mfma_f32_16x16x32_bf16 v[224:227], v[88:91], a[144:147], v[224:227]
    buffer_load_dwordx4 a[192:195], v1, s[88:91], s58 offen offset:0
    ds_read_b64_tr_b16 v[72:73], v36 offset:0
    v_mfma_f32_16x16x32_bf16 v[228:231], v[88:91], a[148:151], v[228:231]
    ds_read_b64_tr_b16 v[74:75], v36 offset:512
    v_mfma_f32_16x16x32_bf16 v[232:235], v[88:91], a[152:155], v[232:235]
    ds_read_b64_tr_b16 v[76:77], v37 offset:0
    v_mfma_f32_16x16x32_bf16 v[236:239], v[88:91], a[156:159], v[236:239]
    ds_read_b64_tr_b16 v[78:79], v37 offset:512
    v_mfma_f32_16x16x32_bf16 v[240:243], v[92:95], a[144:147], v[240:243]
    buffer_load_dwordx4 a[196:199], v1, s[88:91], s58 offen offset:1024
    v_mfma_f32_16x16x32_bf16 v[244:247], v[92:95], a[148:151], v[244:247]
    v_mfma_f32_16x16x32_bf16 v[248:251], v[92:95], a[152:155], v[248:251]
    v_mfma_f32_16x16x32_bf16 v[252:255], v[92:95], a[156:159], v[252:255]
    s_waitcnt lgkmcnt(4)
    v_mfma_f32_16x16x32_bf16 v[128:131], v[64:67], v[96:99], v[128:131]
    buffer_load_dwordx4 a[200:203], v1, s[88:91], s58 offen offset:2048
    ds_read_b64_tr_b16 v[80:81], v34 offset:8192
    v_mfma_f32_16x16x32_bf16 v[132:135], v[64:67], v[100:103], v[132:135]
    ds_read_b64_tr_b16 v[82:83], v34 offset:8704
    v_mfma_f32_16x16x32_bf16 v[136:139], v[64:67], v[104:107], v[136:139]
    ds_read_b64_tr_b16 v[84:85], v35 offset:8192
    v_mfma_f32_16x16x32_bf16 v[140:143], v[64:67], v[108:111], v[140:143]
    v_mfma_f32_16x16x32_bf16 v[144:147], v[68:71], v[96:99], v[144:147]
    buffer_load_dwordx4 a[204:207], v1, s[88:91], s58 offen offset:3072
    v_mfma_f32_16x16x32_bf16 v[148:151], v[68:71], v[100:103], v[148:151]
    ds_read_b64_tr_b16 v[86:87], v35 offset:8704
    v_mfma_f32_16x16x32_bf16 v[152:155], v[68:71], v[104:107], v[152:155]
    ds_read_b64_tr_b16 v[88:89], v36 offset:8192
    ds_read_b64_tr_b16 v[90:91], v36 offset:8704
    v_mfma_f32_16x16x32_bf16 v[156:159], v[68:71], v[108:111], v[156:159]
    s_add_u32 m0, s51, 49152
    s_waitcnt lgkmcnt(6)
    v_mfma_f32_16x16x32_bf16 v[160:163], v[72:75], v[96:99], v[160:163]
    buffer_load_dwordx4 v24, s[8:11], s53 offen lds
    v_mfma_f32_16x16x32_bf16 v[164:167], v[72:75], v[100:103], v[164:167]
    ds_read_b64_tr_b16 v[92:93], v37 offset:8192
    v_mfma_f32_16x16x32_bf16 v[168:171], v[72:75], v[104:107], v[168:171]
    ds_read_b64_tr_b16 v[94:95], v37 offset:8704
    v_mfma_f32_16x16x32_bf16 v[172:175], v[72:75], v[108:111], v[172:175]
    v_mfma_f32_16x16x32_bf16 v[176:179], v[76:79], v[96:99], v[176:179]
    buffer_load_dwordx4 v25, s[8:11], s53 offen offset:1024 lds
    v_mfma_f32_16x16x32_bf16 v[180:183], v[76:79], v[100:103], v[180:183]
    v_mfma_f32_16x16x32_bf16 v[184:187], v[76:79], v[104:107], v[184:187]
    s_add_u32 m0, s51, 57344
    v_mfma_f32_16x16x32_bf16 v[188:191], v[76:79], v[108:111], v[188:191]
    s_waitcnt lgkmcnt(4)
    v_mfma_f32_16x16x32_bf16 v[192:195], v[80:83], v[96:99], v[192:195]
    buffer_load_dwordx4 v24, s[12:15], s53 offen lds
    ds_read_b128 a[144:147], v29 offset:0
    v_mfma_f32_16x16x32_bf16 v[196:199], v[80:83], v[100:103], v[196:199]
    ds_read_b64_tr_b16 v[64:65], v34 offset:4096
    v_mfma_f32_16x16x32_bf16 v[200:203], v[80:83], v[104:107], v[200:203]
    ds_read_b64_tr_b16 v[66:67], v34 offset:4608
    v_mfma_f32_16x16x32_bf16 v[204:207], v[80:83], v[108:111], v[204:207]
    ds_read_b128 a[148:151], v29 offset:2048
    v_mfma_f32_16x16x32_bf16 v[208:211], v[84:87], v[96:99], v[208:211]
    buffer_load_dwordx4 v25, s[12:15], s53 offen offset:1024 lds
    ds_read_b128 a[152:155], v29 offset:4096
    v_mfma_f32_16x16x32_bf16 v[212:215], v[84:87], v[100:103], v[212:215]
    ds_read_b128 a[156:159], v29 offset:6144
    v_mfma_f32_16x16x32_bf16 v[216:219], v[84:87], v[104:107], v[216:219]
    ds_read_b64_tr_b16 v[68:69], v35 offset:4096
    ds_read_b64_tr_b16 v[70:71], v35 offset:4608
    v_mfma_f32_16x16x32_bf16 v[220:223], v[84:87], v[108:111], v[220:223]
    s_add_u32 m0, s50, 49152
    s_waitcnt lgkmcnt(8)
    v_mfma_f32_16x16x32_bf16 v[224:227], v[88:91], v[96:99], v[224:227]
    buffer_load_dwordx4 v16, s[4:7], s52 offen lds
    ds_read_b64_tr_b16 v[72:73], v36 offset:4096
    v_mfma_f32_16x16x32_bf16 v[228:231], v[88:91], v[100:103], v[228:231]
    ds_read_b64_tr_b16 v[74:75], v36 offset:4608
    v_mfma_f32_16x16x32_bf16 v[232:235], v[88:91], v[104:107], v[232:235]
    ds_read_b64_tr_b16 v[76:77], v37 offset:4096
    v_mfma_f32_16x16x32_bf16 v[236:239], v[88:91], v[108:111], v[236:239]
    ds_read_b64_tr_b16 v[78:79], v37 offset:4608
    v_mfma_f32_16x16x32_bf16 v[240:243], v[92:95], v[96:99], v[240:243]
    buffer_load_dwordx4 v17, s[4:7], s52 offen offset:1024 lds
    v_mfma_f32_16x16x32_bf16 v[244:247], v[92:95], v[100:103], v[244:247]
    v_mfma_f32_16x16x32_bf16 v[248:251], v[92:95], v[104:107], v[248:251]
    v_mfma_f32_16x16x32_bf16 v[252:255], v[92:95], v[108:111], v[252:255]
    s_waitcnt lgkmcnt(4)
    v_mfma_f32_16x16x32_bf16 v[128:131], v[64:67], a[144:147], v[128:131]
    buffer_load_dwordx4 v18, s[4:7], s52 offen offset:2048 lds
    ds_read_b64_tr_b16 v[80:81], v34 offset:12288
    v_mfma_f32_16x16x32_bf16 v[132:135], v[64:67], a[148:151], v[132:135]
    ds_read_b64_tr_b16 v[82:83], v34 offset:12800
    v_mfma_f32_16x16x32_bf16 v[136:139], v[64:67], a[152:155], v[136:139]
    ds_read_b64_tr_b16 v[84:85], v35 offset:12288
    s_lshl_b32 s64, s42, 2
    v_mfma_f32_16x16x32_bf16 v[140:143], v[64:67], a[156:159], v[140:143]
    s_add_u32 s64, s64, s40
    v_mfma_f32_16x16x32_bf16 v[144:147], v[68:71], a[144:147], v[144:147]
    buffer_load_dwordx4 v19, s[4:7], s52 offen offset:3072 lds
    ds_read_b64_tr_b16 v[86:87], v35 offset:12800
    v_mfma_f32_16x16x32_bf16 v[148:151], v[68:71], a[148:151], v[148:151]
    s_lshl_b32 s85, s64, 5
    v_mfma_f32_16x16x32_bf16 v[152:155], v[68:71], a[152:155], v[152:155]
    ds_read_b64_tr_b16 v[88:89], v36 offset:12288
    ds_read_b64_tr_b16 v[90:91], v36 offset:12800
    v_mfma_f32_16x16x32_bf16 v[156:159], v[68:71], a[156:159], v[156:159]
    s_add_u32 m0, s50, 53248
    s_waitcnt lgkmcnt(6)
    v_mfma_f32_16x16x32_bf16 v[160:163], v[72:75], a[144:147], v[160:163]
    buffer_load_dwordx4 v20, s[4:7], s52 offen lds
    ds_read_b64_tr_b16 v[92:93], v37 offset:12288
    v_mfma_f32_16x16x32_bf16 v[164:167], v[72:75], a[148:151], v[164:167]
    s_mul_i32 s64, s64, 216
    v_mfma_f32_16x16x32_bf16 v[168:171], v[72:75], a[152:155], v[168:171]
    ds_read_b64_tr_b16 v[94:95], v37 offset:12800
    s_lshl_b32 s56, s43, 1
    v_mfma_f32_16x16x32_bf16 v[172:175], v[72:75], a[156:159], v[172:175]
    s_add_u32 s64, s64, s56
    v_mfma_f32_16x16x32_bf16 v[176:179], v[76:79], a[144:147], v[176:179]
    buffer_load_dwordx4 v21, s[4:7], s52 offen offset:1024 lds
    s_lshl_b32 s64, s64, 10
    v_mfma_f32_16x16x32_bf16 v[180:183], v[76:79], a[148:151], v[180:183]
    s_add_u32 s64, s64, 7536640
    v_mfma_f32_16x16x32_bf16 v[184:187], v[76:79], a[152:155], v[184:187]
    s_add_u32 s85, s85, s43
    v_mfma_f32_16x16x32_bf16 v[188:191], v[76:79], a[156:159], v[188:191]
    s_lshl_b32 s85, s85, 7
    s_waitcnt lgkmcnt(0)
    s_waitcnt vmcnt(14)
    s_barrier
    v_mfma_f32_16x16x32_bf16 v[192:195], v[80:83], a[144:147], v[192:195]
    buffer_load_dwordx4 v22, s[4:7], s52 offen offset:2048 lds
    ds_read_b128 v[96:99], v26 offset:0
    v_mfma_f32_16x16x32_bf16 v[196:199], v[80:83], a[148:151], v[196:199]
    ds_read_b64_tr_b16 v[64:65], v30 offset:0
    v_mfma_f32_16x16x32_bf16 v[200:203], v[80:83], a[152:155], v[200:203]
    ds_read_b64_tr_b16 v[66:67], v30 offset:512
    ds_read_b128 v[100:103], v26 offset:2048
    v_mfma_f32_16x16x32_bf16 v[204:207], v[80:83], a[156:159], v[204:207]
    s_add_u32 s85, s85, 14835712
    v_mfma_f32_16x16x32_bf16 v[208:211], v[84:87], a[144:147], v[208:211]
    buffer_load_dwordx4 v23, s[4:7], s52 offen offset:3072 lds
    ds_read_b128 v[104:107], v26 offset:4096
    ds_read_b128 v[108:111], v26 offset:6144
    v_mfma_f32_16x16x32_bf16 v[212:215], v[84:87], a[148:151], v[212:215]
    s_add_u32 s52, s52, 128
    s_add_u32 s53, s53, 221184
    v_mfma_f32_16x16x32_bf16 v[216:219], v[84:87], a[152:155], v[216:219]
    ds_read_b64_tr_b16 v[68:69], v31 offset:0
    ds_read_b64_tr_b16 v[70:71], v31 offset:512
    v_mfma_f32_16x16x32_bf16 v[220:223], v[84:87], a[156:159], v[220:223]
    s_mul_i32 s58, s40, 12288
    s_add_u32 s58, s58, L_tab - L_pc + 4096
    v_mfma_f32_16x16x32_bf16 v[224:227], v[88:91], a[144:147], v[224:227]
    buffer_load_dwordx4 a[208:211], v1, s[88:91], s58 offen offset:0
    ds_read_b64_tr_b16 v[72:73], v32 offset:0
    v_mfma_f32_16x16x32_bf16 v[228:231], v[88:91], a[148:151], v[228:231]
    ds_read_b64_tr_b16 v[74:75], v32 offset:512
    v_mfma_f32_16x16x32_bf16 v[232:235], v[88:91], a[152:155], v[232:235]
    ds_read_b64_tr_b16 v[76:77], v33 offset:0
    v_mfma_f32_16x16x32_bf16 v[236:239], v[88:91], a[156:159], v[236:239]
    ds_read_b64_tr_b16 v[78:79], v33 offset:512
    v_mfma_f32_16x16x32_bf16 v[240:243], v[92:95], a[144:147], v[240:243]
    buffer_load_dwordx4 a[212:215], v1, s[88:91], s58 offen offset:1024
    v_mfma_f32_16x16x32_bf16 v[244:247], v[92:95], a[148:151], v[244:247]
    v_mfma_f32_16x16x32_bf16 v[248:251], v[92:95], a[152:155], v[248:251]
    v_mfma_f32_16x16x32_bf16 v[252:255], v[92:95], a[156:159], v[252:255]
    s_waitcnt lgkmcnt(4)
    v_mfma_f32_16x16x32_bf16 v[128:131], v[64:67], v[96:99], v[128:131]
    buffer_load_dwordx4 a[232:235], v1, s[88:91], s58 offen offset:2048
    ds_read_b64_tr_b16 v[80:81], v30 offset:8192
    v_mfma_f32_16x16x32_bf16 v[132:135], v[64:67], v[100:103], v[132:135]
    ds_read_b64_tr_b16 v[82:83], v30 offset:8704
    v_mfma_f32_16x16x32_bf16 v[136:139], v[64:67], v[104:107], v[136:139]
    ds_read_b64_tr_b16 v[84:85], v31 offset:8192
    v_mfma_f32_16x16x32_bf16 v[140:143], v[64:67], v[108:111], v[140:143]
    v_mfma_f32_16x16x32_bf16 v[144:147], v[68:71], v[96:99], v[144:147]
    buffer_load_dwordx4 a[236:239], v1, s[88:91], s58 offen offset:3072
    v_mfma_f32_16x16x32_bf16 v[148:151], v[68:71], v[100:103], v[148:151]
    ds_read_b64_tr_b16 v[86:87], v31 offset:8704
    v_mfma_f32_16x16x32_bf16 v[152:155], v[68:71], v[104:107], v[152:155]
    ds_read_b64_tr_b16 v[88:89], v32 offset:8192
    ds_read_b64_tr_b16 v[90:91], v32 offset:8704
    v_mfma_f32_16x16x32_bf16 v[156:159], v[68:71], v[108:111], v[156:159]
    s_add_u32 m0, s51, 98304
    s_waitcnt lgkmcnt(6)
    v_mfma_f32_16x16x32_bf16 v[160:163], v[72:75], v[96:99], v[160:163]
    buffer_load_dwordx4 v24, s[8:11], s53 offen lds
    v_mfma_f32_16x16x32_bf16 v[164:167], v[72:75], v[100:103], v[164:167]
    ds_read_b64_tr_b16 v[92:93], v33 offset:8192
    v_mfma_f32_16x16x32_bf16 v[168:171], v[72:75], v[104:107], v[168:171]
    ds_read_b64_tr_b16 v[94:95], v33 offset:8704
    v_mfma_f32_16x16x32_bf16 v[172:175], v[72:75], v[108:111], v[172:175]
    v_mfma_f32_16x16x32_bf16 v[176:179], v[76:79], v[96:99], v[176:179]
    buffer_load_dwordx4 v25, s[8:11], s53 offen offset:1024 lds
    v_mfma_f32_16x16x32_bf16 v[180:183], v[76:79], v[100:103], v[180:183]
    v_mfma_f32_16x16x32_bf16 v[184:187], v[76:79], v[104:107], v[184:187]
    s_add_u32 m0, s51, 106496
    v_mfma_f32_16x16x32_bf16 v[188:191], v[76:79], v[108:111], v[188:191]
    s_waitcnt lgkmcnt(4)
    v_mfma_f32_16x16x32_bf16 v[192:195], v[80:83], v[96:99], v[192:195]
    buffer_load_dwordx4 v24, s[12:15], s53 offen lds
    ds_read_b128 a[144:147], v27 offset:0
    v_mfma_f32_16x16x32_bf16 v[196:199], v[80:83], v[100:103], v[196:199]
    ds_read_b64_tr_b16 v[64:65], v30 offset:4096
    v_mfma_f32_16x16x32_bf16 v[200:203], v[80:83], v[104:107], v[200:203]
    ds_read_b64_tr_b16 v[66:67], v30 offset:4608
    v_mfma_f32_16x16x32_bf16 v[204:207], v[80:83], v[108:111], v[204:207]
    ds_read_b128 a[148:151], v27 offset:2048
    v_mfma_f32_16x16x32_bf16 v[208:211], v[84:87], v[96:99], v[208:211]
    buffer_load_dwordx4 v25, s[12:15], s53 offen offset:1024 lds
    ds_read_b128 a[152:155], v27 offset:4096
    v_mfma_f32_16x16x32_bf16 v[212:215], v[84:87], v[100:103], v[212:215]
    ds_read_b128 a[156:159], v27 offset:6144
    v_mfma_f32_16x16x32_bf16 v[216:219], v[84:87], v[104:107], v[216:219]
    ds_read_b64_tr_b16 v[68:69], v31 offset:4096
    ds_read_b64_tr_b16 v[70:71], v31 offset:4608
    v_mfma_f32_16x16x32_bf16 v[220:223], v[84:87], v[108:111], v[220:223]
    s_add_u32 m0, s50, 98304
    s_waitcnt lgkmcnt(8)
    v_mfma_f32_16x16x32_bf16 v[224:227], v[88:91], v[96:99], v[224:227]
    buffer_load_dwordx4 v16, s[4:7], s52 offen lds
    ds_read_b64_tr_b16 v[72:73], v32 offset:4096
    v_mfma_f32_16x16x32_bf16 v[228:231], v[88:91], v[100:103], v[228:231]
    ds_read_b64_tr_b16 v[74:75], v32 offset:4608
    v_mfma_f32_16x16x32_bf16 v[232:235], v[88:91], v[104:107], v[232:235]
    ds_read_b64_tr_b16 v[76:77], v33 offset:4096
    v_mfma_f32_16x16x32_bf16 v[236:239], v[88:91], v[108:111], v[236:239]
    ds_read_b64_tr_b16 v[78:79], v33 offset:4608
    v_mfma_f32_16x16x32_bf16 v[240:243], v[92:95], v[96:99], v[240:243]
    buffer_load_dwordx4 v17, s[4:7], s52 offen offset:1024 lds
    v_mfma_f32_16x16x32_bf16 v[244:247], v[92:95], v[100:103], v[244:247]
    v_mfma_f32_16x16x32_bf16 v[248:251], v[92:95], v[104:107], v[248:251]
    v_mfma_f32_16x16x32_bf16 v[252:255], v[92:95], v[108:111], v[252:255]
    s_waitcnt lgkmcnt(4)
    v_mfma_f32_16x16x32_bf16 v[128:131], v[64:67], a[144:147], v[128:131]
    buffer_load_dwordx4 v18, s[4:7], s52 offen offset:2048 lds
    ds_read_b64_tr_b16 v[80:81], v30 offset:12288
    v_mfma_f32_16x16x32_bf16 v[132:135], v[64:67], a[148:151], v[132:135]
    ds_read_b64_tr_b16 v[82:83], v30 offset:12800
    v_mfma_f32_16x16x32_bf16 v[136:139], v[64:67], a[152:155], v[136:139]
    ds_read_b64_tr_b16 v[84:85], v31 offset:12288
    v_mfma_f32_16x16x32_bf16 v[140:143], v[64:67], a[156:159], v[140:143]
    v_mfma_f32_16x16x32_bf16 v[144:147], v[68:71], a[144:147], v[144:147]
    buffer_load_dwordx4 v19, s[4:7], s52 offen offset:3072 lds
    v_mfma_f32_16x16x32_bf16 v[148:151], v[68:71], a[148:151], v[148:151]
    ds_read_b64_tr_b16 v[86:87], v31 offset:12800
    v_mfma_f32_16x16x32_bf16 v[152:155], v[68:71], a[152:155], v[152:155]
    buffer_load_dwordx4 v[122:125], v118, s[16:19], 0 offen sc1
    ds_read_b64_tr_b16 v[88:89], v32 offset:12288
    v_mfma_f32_16x16x32_bf16 v[156:159], v[68:71], a[156:159], v[156:159]
    ds_read_b64_tr_b16 v[90:91], v32 offset:12800
    s_add_u32 m0, s50, 102400
    s_waitcnt lgkmcnt(6)
    v_mfma_f32_16x16x32_bf16 v[160:163], v[72:75], a[144:147], v[160:163]
    buffer_load_dwordx4 v20, s[4:7], s52 offen lds
    v_mfma_f32_16x16x32_bf16 v[164:167], v[72:75], a[148:151], v[164:167]
    ds_read_b64_tr_b16 v[92:93], v33 offset:12288
    v_mfma_f32_16x16x32_bf16 v[168:171], v[72:75], a[152:155], v[168:171]
    buffer_load_dwordx4 v[48:51], v119, s[16:19], 0 offen sc1
    v_mfma_f32_16x16x32_bf16 v[172:175], v[72:75], a[156:159], v[172:175]
    ds_read_b64_tr_b16 v[94:95], v33 offset:12800
    v_mfma_f32_16x16x32_bf16 v[176:179], v[76:79], a[144:147], v[176:179]
    buffer_load_dwordx4 v21, s[4:7], s52 offen offset:1024 lds
    v_mfma_f32_16x16x32_bf16 v[180:183], v[76:79], a[148:151], v[180:183]
    v_mfma_f32_16x16x32_bf16 v[184:187], v[76:79], a[152:155], v[184:187]
    v_mfma_f32_16x16x32_bf16 v[188:191], v[76:79], a[156:159], v[188:191]
    s_waitcnt lgkmcnt(0)
    s_waitcnt vmcnt(16)
    s_barrier
    v_mfma_f32_16x16x32_bf16 v[192:195], v[80:83], a[144:147], v[192:195]
    buffer_load_dwordx4 v22, s[4:7], s52 offen offset:2048 lds
    ds_read_b128 v[96:99], v26 offset:49152
    v_mfma_f32_16x16x32_bf16 v[196:199], v[80:83], a[148:151], v[196:199]
    ds_read_b64_tr_b16 v[64:65], v30 offset:49152
    v_mfma_f32_16x16x32_bf16 v[200:203], v[80:83], a[152:155], v[200:203]
    ds_read_b64_tr_b16 v[66:67], v30 offset:49664
    v_mfma_f32_16x16x32_bf16 v[204:207], v[80:83], a[156:159], v[204:207]
    ds_read_b128 v[100:103], v26 offset:51200
    v_mfma_f32_16x16x32_bf16 v[208:211], v[84:87], a[144:147], v[208:211]
    buffer_load_dwordx4 v23, s[4:7], s52 offen offset:3072 lds
    ds_read_b128 v[104:107], v26 offset:53248
    ds_read_b128 v[108:111], v26 offset:55296
    v_mfma_f32_16x16x32_bf16 v[212:215], v[84:87], a[148:151], v[212:215]
    s_add_u32 s52, s52, 128
    s_add_u32 s53, s53, 221184
    v_mfma_f32_16x16x32_bf16 v[216:219], v[84:87], a[152:155], v[216:219]
    ds_read_b64_tr_b16 v[68:69], v31 offset:49152
    ds_read_b64_tr_b16 v[70:71], v31 offset:49664
    v_mfma_f32_16x16x32_bf16 v[220:223], v[84:87], a[156:159], v[220:223]
    s_mul_i32 s58, s40, 12288
    s_add_u32 s58, s58, L_tab - L_pc + 8192
    v_mfma_f32_16x16x32_bf16 v[224:227], v[88:91], a[144:147], v[224:227]
    buffer_load_dwordx4 a[240:243], v1, s[88:91], s58 offen offset:0
    ds_read_b64_tr_b16 v[72:73], v32 offset:49152
    v_mfma_f32_16x16x32_bf16 v[228:231], v[88:91], a[148:151], v[228:231]
    ds_read_b64_tr_b16 v[74:75], v32 offset:49664
    v_mfma_f32_16x16x32_bf16 v[232:235], v[88:91], a[152:155], v[232:235]
    ds_read_b64_tr_b16 v[76:77], v33 offset:49152
    v_mfma_f32_16x16x32_bf16 v[236:239], v[88:91], a[156:159], v[236:239]
    ds_read_b64_tr_b16 v[78:79], v33 offset:49664
    v_mfma_f32_16x16x32_bf16 v[240:243], v[92:95], a[144:147], v[240:243]
    buffer_load_dwordx4 a[244:247], v1, s[88:91], s58 offen offset:1024
    v_mfma_f32_16x16x32_bf16 v[244:247], v[92:95], a[148:151], v[244:247]
    v_mfma_f32_16x16x32_bf16 v[248:251], v[92:95], a[152:155], v[248:251]
    v_mfma_f32_16x16x32_bf16 v[252:255], v[92:95], a[156:159], v[252:255]
    s_waitcnt lgkmcnt(4)
    v_mfma_f32_16x16x32_bf16 v[128:131], v[64:67], v[96:99], v[128:131]
    buffer_load_dwordx4 a[248:251], v1, s[88:91], s58 offen offset:2048
    ds_read_b64_tr_b16 v[80:81], v30 offset:57344
    v_mfma_f32_16x16x32_bf16 v[132:135], v[64:67], v[100:103], v[132:135]
    ds_read_b64_tr_b16 v[82:83], v30 offset:57856
    v_mfma_f32_16x16x32_bf16 v[136:139], v[64:67], v[104:107], v[136:139]
    ds_read_b64_tr_b16 v[84:85], v31 offset:57344
    v_mfma_f32_16x16x32_bf16 v[140:143], v[64:67], v[108:111], v[140:143]
    v_mfma_f32_16x16x32_bf16 v[144:147], v[68:71], v[96:99], v[144:147]
    buffer_load_dwordx4 a[252:255], v1, s[88:91], s58 offen offset:3072
    v_mfma_f32_16x16x32_bf16 v[148:151], v[68:71], v[100:103], v[148:151]
    ds_read_b64_tr_b16 v[86:87], v31 offset:57856
    v_mfma_f32_16x16x32_bf16 v[152:155], v[68:71], v[104:107], v[152:155]
    ds_read_b64_tr_b16 v[88:89], v32 offset:57344
    ds_read_b64_tr_b16 v[90:91], v32 offset:57856
    v_mfma_f32_16x16x32_bf16 v[156:159], v[68:71], v[108:111], v[156:159]
    s_add_u32 m0, s51, 0
    s_waitcnt lgkmcnt(6)
    v_mfma_f32_16x16x32_bf16 v[160:163], v[72:75], v[96:99], v[160:163]
    buffer_load_dwordx4 v24, s[8:11], s53 offen lds
    v_mfma_f32_16x16x32_bf16 v[164:167], v[72:75], v[100:103], v[164:167]
    ds_read_b64_tr_b16 v[92:93], v33 offset:57344
    v_mfma_f32_16x16x32_bf16 v[168:171], v[72:75], v[104:107], v[168:171]
    ds_read_b64_tr_b16 v[94:95], v33 offset:57856
    v_mfma_f32_16x16x32_bf16 v[172:175], v[72:75], v[108:111], v[172:175]
    v_mfma_f32_16x16x32_bf16 v[176:179], v[76:79], v[96:99], v[176:179]
    buffer_load_dwordx4 v25, s[8:11], s53 offen offset:1024 lds
    v_mfma_f32_16x16x32_bf16 v[180:183], v[76:79], v[100:103], v[180:183]
    v_mfma_f32_16x16x32_bf16 v[184:187], v[76:79], v[104:107], v[184:187]
    s_add_u32 m0, s51, 8192
    v_mfma_f32_16x16x32_bf16 v[188:191], v[76:79], v[108:111], v[188:191]
    s_waitcnt lgkmcnt(4)
    v_mfma_f32_16x16x32_bf16 v[192:195], v[80:83], v[96:99], v[192:195]
    buffer_load_dwordx4 v24, s[12:15], s53 offen lds
    ds_read_b128 a[144:147], v27 offset:49152
    ds_read_b64_tr_b16 v[64:65], v30 offset:53248
    v_mfma_f32_16x16x32_bf16 v[196:199], v[80:83], v[100:103], v[196:199]
    s_waitcnt vmcnt(10)
    v_xor_b32 v122, v120, v122
    v_xor_b32 v123, v120, v123
    v_mfma_f32_16x16x32_bf16 v[200:203], v[80:83], v[104:107], v[200:203]
    ds_read_b64_tr_b16 v[66:67], v30 offset:53760
    ds_read_b128 a[148:151], v27 offset:51200
    v_xor_b32 v124, v120, v124
    v_mfma_f32_16x16x32_bf16 v[204:207], v[80:83], v[108:111], v[204:207]
    v_xor_b32 v125, v120, v125
    v_or3_b32 v122, v122, v123, v124
    v_mfma_f32_16x16x32_bf16 v[208:211], v[84:87], v[96:99], v[208:211]
    buffer_load_dwordx4 v25, s[12:15], s53 offen offset:1024 lds
    ds_read_b128 a[152:155], v27 offset:53248
    v_mfma_f32_16x16x32_bf16 v[212:215], v[84:87], v[100:103], v[212:215]
    ds_read_b128 a[156:159], v27 offset:55296
    v_xor_b32 v48, v120, v48
    v_xor_b32 v49, v120, v49
    v_xor_b32 v50, v120, v50
    v_xor_b32 v51, v120, v51
    v_or3_b32 v48, v48, v49, v50
    v_or_b32 v48, v48, v51
    v_or3_b32 v122, v122, v125, v48
    v_cmp_ne_u32 vcc, 0, v122
    s_cbranch_vccnz Lslow_1
Lback_2:
    v_mfma_f32_16x16x32_bf16 v[216:219], v[84:87], v[104:107], v[216:219]
    ds_read_b64_tr_b16 v[68:69], v31 offset:53248
    ds_read_b64_tr_b16 v[70:71], v31 offset:53760
    v_mfma_f32_16x16x32_bf16 v[220:223], v[84:87], v[108:111], v[220:223]
    s_add_u32 m0, s50, 0
    s_waitcnt lgkmcnt(8)
    v_mfma_f32_16x16x32_bf16 v[224:227], v[88:91], v[96:99], v[224:227]
    buffer_load_dwordx4 v16, s[4:7], s52 offen lds
    ds_read_b64_tr_b16 v[72:73], v32 offset:53248
    v_mfma_f32_16x16x32_bf16 v[228:231], v[88:91], v[100:103], v[228:231]
    ds_read_b64_tr_b16 v[74:75], v32 offset:53760
    v_mfma_f32_16x16x32_bf16 v[232:235], v[88:91], v[104:107], v[232:235]
    ds_read_b64_tr_b16 v[76:77], v33 offset:53248
    v_mfma_f32_16x16x32_bf16 v[236:239], v[88:91], v[108:111], v[236:239]
    ds_read_b64_tr_b16 v[78:79], v33 offset:53760
    v_mfma_f32_16x16x32_bf16 v[240:243], v[92:95], v[96:99], v[240:243]
    buffer_load_dwordx4 v17, s[4:7], s52 offen offset:1024 lds
    v_mfma_f32_16x16x32_bf16 v[244:247], v[92:95], v[100:103], v[244:247]
    v_mfma_f32_16x16x32_bf16 v[248:251], v[92:95], v[104:107], v[248:251]
    v_mfma_f32_16x16x32_bf16 v[252:255], v[92:95], v[108:111], v[252:255]
    s_waitcnt lgkmcnt(4)
    v_mfma_f32_16x16x32_bf16 v[128:131], v[64:67], a[144:147], v[128:131]
    buffer_load_dwordx4 v18, s[4:7], s52 offen offset:2048 lds
    ds_read_b64_tr_b16 v[80:81], v30 offset:61440
    v_mfma_f32_16x16x32_bf16 v[132:135], v[64:67], a[148:151], v[132:135]
    ds_read_b64_tr_b16 v[82:83], v30 offset:61952
    v_mfma_f32_16x16x32_bf16 v[136:139], v[64:67], a[152:155], v[136:139]
    ds_read_b64_tr_b16 v[84:85], v31 offset:61440
    s_waitcnt vmcnt(7)
    v_mfma_f32_16x16x32_bf16 v[140:143], v[64:67], a[156:159], v[140:143]
    s_lshl_b32 s0, s82, 12
    v_mfma_f32_16x16x32_bf16 v[144:147], v[68:71], a[144:147], v[144:147]
    buffer_load_dwordx4 v19, s[4:7], s52 offen offset:3072 lds
    ds_read_b64_tr_b16 v[86:87], v31 offset:61952
    v_mfma_f32_16x16x32_bf16 v[148:151], v[68:71], a[148:151], v[148:151]
    s_add_u32 s0, s0, 14835712
    v_mfma_f32_16x16x32_bf16 v[152:155], v[68:71], a[152:155], v[152:155]
    ds_read_b64_tr_b16 v[88:89], v32 offset:61440
    ds_read_b64_tr_b16 v[90:91], v32 offset:61952
    v_mfma_f32_16x16x32_bf16 v[156:159], v[68:71], a[156:159], v[156:159]
    s_add_u32 m0, s50, 4096
    s_waitcnt lgkmcnt(6)
    v_mfma_f32_16x16x32_bf16 v[160:163], v[72:75], a[144:147], v[160:163]
    buffer_load_dwordx4 v20, s[4:7], s52 offen lds
    ds_read_b64_tr_b16 v[92:93], v33 offset:61440
    v_mfma_f32_16x16x32_bf16 v[164:167], v[72:75], a[148:151], v[164:167]
    v_min_u32 v2, 26, v0
    v_mfma_f32_16x16x32_bf16 v[168:171], v[72:75], a[152:155], v[168:171]
    ds_read_b64_tr_b16 v[94:95], v33 offset:61952
    v_lshl_add_u32 v2, v2, 7, s0
    v_mfma_f32_16x16x32_bf16 v[172:175], v[72:75], a[156:159], v[172:175]
    v_accvgpr_write_b32 a213, v2
    v_mfma_f32_16x16x32_bf16 v[176:179], v[76:79], a[144:147], v[176:179]
    buffer_load_dwordx4 v21, s[4:7], s52 offen offset:1024 lds
    s_mul_i32 s0, s83, 5120
    v_mfma_f32_16x16x32_bf16 v[180:183], v[76:79], a[148:151], v[180:183]
    s_add_u32 s0, s0, 14966784
    v_mfma_f32_16x16x32_bf16 v[184:187], v[76:79], a[152:155], v[184:187]
    v_min_u32 v2, 39, v0
    v_mfma_f32_16x16x32_bf16 v[188:191], v[76:79], a[156:159], v[188:191]
    v_lshl_add_u32 v2, v2, 7, s0
    s_waitcnt lgkmcnt(0)
    s_barrier
    v_mfma_f32_16x16x32_bf16 v[192:195], v[80:83], a[144:147], v[192:195]
    buffer_load_dwordx4 v22, s[4:7], s52 offen offset:2048 lds
    ds_read_b128 v[96:99], v28 offset:0
    ds_read_b64_tr_b16 v[64:65], v34 offset:0
    v_mfma_f32_16x16x32_bf16 v[196:199], v[80:83], a[148:151], v[196:199]
    s_lshl_b32 s55, s43, 1
    s_add_u32 s55, s55, s63
    s_lshl_b32 s55, s55, 5
    s_add_u32 s55, s55, s62
    s_lshl_b32 s55, s55, 7
    s_add_u32 s55, s55, 14614528
    v_mfma_f32_16x16x32_bf16 v[200:203], v[80:83], a[152:155], v[200:203]
    buffer_load_dwordx4 v[112:115], v42, s[16:19], s55 offen sc1
    ds_read_b64_tr_b16 v[66:67], v34 offset:512
    v_mfma_f32_16x16x32_bf16 v[204:207], v[80:83], a[156:159], v[204:207]
    ds_read_b128 v[100:103], v28 offset:2048
    v_mfma_f32_16x16x32_bf16 v[208:211], v[84:87], a[144:147], v[208:211]
    buffer_load_dwordx4 v23, s[4:7], s52 offen offset:3072 lds
    ds_read_b128 v[104:107], v28 offset:4096
    ds_read_b128 v[108:111], v28 offset:6144
    v_mfma_f32_16x16x32_bf16 v[212:215], v[84:87], a[148:151], v[212:215]
    s_add_u32 s52, s52, 128
    s_add_u32 s53, s53, 221184
    v_mfma_f32_16x16x32_bf16 v[216:219], v[84:87], a[152:155], v[216:219]
    buffer_load_dwordx4 v[20:23], v42, s[16:19], s55 offen offset:2048 sc1
    ds_read_b64_tr_b16 v[68:69], v35 offset:0
    v_mfma_f32_16x16x32_bf16 v[220:223], v[84:87], a[156:159], v[220:223]
    ds_read_b64_tr_b16 v[70:71], v35 offset:512
    s_add_u32 s59, s84, 0
    v_mfma_f32_16x16x32_bf16 v[224:227], v[88:91], a[144:147], v[224:227]
    buffer_load_dwordx4 a[0:3], v1, s[16:19], s59 offen offset:0 sc1
    ds_read_b64_tr_b16 v[72:73], v36 offset:0
    ds_read_b64_tr_b16 v[74:75], v36 offset:512
    v_mfma_f32_16x16x32_bf16 v[228:231], v[88:91], a[148:151], v[228:231]
    s_lshl_b32 s55, s42, 2
    s_add_u32 s55, s55, s40
    s_lshl_b32 s55, s55, 10
    s_add_u32 s55, s55, 32768
    v_mfma_f32_16x16x32_bf16 v[232:235], v[88:91], a[152:155], v[232:235]
    buffer_load_dwordx4 v[38:41], v15, s[16:19], s55 offen offset:0 sc1
    ds_read_b64_tr_b16 v[76:77], v37 offset:0
    v_mfma_f32_16x16x32_bf16 v[236:239], v[88:91], a[156:159], v[236:239]
    ds_read_b64_tr_b16 v[78:79], v37 offset:512
    v_mfma_f32_16x16x32_bf16 v[240:243], v[92:95], a[144:147], v[240:243]
    buffer_load_dwordx4 a[4:7], v1, s[16:19], s59 offen offset:1024 sc1
    v_mfma_f32_16x16x32_bf16 v[244:247], v[92:95], a[148:151], v[244:247]
    v_accvgpr_write_b32 a214, v2
    v_mfma_f32_16x16x32_bf16 v[248:251], v[92:95], a[152:155], v[248:251]
    buffer_load_dwordx4 v[48:51], v15, s[16:19], s55 offen offset:256 sc1
    v_mfma_f32_16x16x32_bf16 v[252:255], v[92:95], a[156:159], v[252:255]
    s_waitcnt lgkmcnt(4)
    v_mfma_f32_16x16x32_bf16 v[128:131], v[64:67], v[96:99], v[128:131]
    buffer_load_dwordx4 a[8:11], v1, s[16:19], s59 offen offset:2048 sc1
    ds_read_b64_tr_b16 v[80:81], v34 offset:8192
    v_mfma_f32_16x16x32_bf16 v[132:135], v[64:67], v[100:103], v[132:135]
    ds_read_b64_tr_b16 v[82:83], v34 offset:8704
    v_mfma_f32_16x16x32_bf16 v[136:139], v[64:67], v[104:107], v[136:139]
    buffer_load_dwordx4 v[52:55], v15, s[16:19], s55 offen offset:512 sc1
    v_mfma_f32_16x16x32_bf16 v[140:143], v[64:67], v[108:111], v[140:143]
    ds_read_b64_tr_b16 v[84:85], v35 offset:8192
    v_mfma_f32_16x16x32_bf16 v[144:147], v[68:71], v[96:99], v[144:147]
    buffer_load_dwordx4 a[12:15], v1, s[16:19], s59 offen offset:3072 sc1
    v_mfma_f32_16x16x32_bf16 v[148:151], v[68:71], v[100:103], v[148:151]
    ds_read_b64_tr_b16 v[86:87], v35 offset:8704
    v_mfma_f32_16x16x32_bf16 v[152:155], v[68:71], v[104:107], v[152:155]
    buffer_load_dwordx4 v[16:19], v15, s[16:19], s55 offen offset:768 sc1
    ds_read_b64_tr_b16 v[88:89], v36 offset:8192
    v_mfma_f32_16x16x32_bf16 v[156:159], v[68:71], v[108:111], v[156:159]
    ds_read_b64_tr_b16 v[90:91], v36 offset:8704
    s_add_u32 s59, s84, 4096
    s_waitcnt lgkmcnt(6)
    v_mfma_f32_16x16x32_bf16 v[160:163], v[72:75], v[96:99], v[160:163]
    buffer_load_dwordx4 a[16:19], v1, s[16:19], s59 offen offset:0 sc1
    v_mfma_f32_16x16x32_bf16 v[164:167], v[72:75], v[100:103], v[164:167]
    ds_read_b64_tr_b16 v[92:93], v37 offset:8192
    v_mfma_f32_16x16x32_bf16 v[168:171], v[72:75], v[104:107], v[168:171]
    ds_read_b64_tr_b16 v[94:95], v37 offset:8704
    v_mfma_f32_16x16x32_bf16 v[172:175], v[72:75], v[108:111], v[172:175]
    v_mfma_f32_16x16x32_bf16 v[176:179], v[76:79], v[96:99], v[176:179]
    buffer_load_dwordx4 a[20:23], v1, s[16:19], s59 offen offset:1024 sc1
    v_mfma_f32_16x16x32_bf16 v[180:183], v[76:79], v[100:103], v[180:183]
    v_mfma_f32_16x16x32_bf16 v[184:187], v[76:79], v[104:107], v[184:187]
    v_mfma_f32_16x16x32_bf16 v[188:191], v[76:79], v[108:111], v[188:191]
    s_waitcnt lgkmcnt(4)
    v_mfma_f32_16x16x32_bf16 v[192:195], v[80:83], v[96:99], v[192:195]
    buffer_load_dwordx4 a[24:27], v1, s[16:19], s59 offen offset:2048 sc1
    ds_read_b128 a[144:147], v29 offset:0
    ds_read_b64_tr_b16 v[64:65], v34 offset:4096
    v_mfma_f32_16x16x32_bf16 v[196:199], v[80:83], v[100:103], v[196:199]
    s_waitcnt vmcnt(11)
    v_add_f32 v112, v112, v20
    v_mfma_f32_16x16x32_bf16 v[200:203], v[80:83], v[104:107], v[200:203]
    ds_read_b64_tr_b16 v[66:67], v34 offset:4608
    ds_read_b128 a[148:151], v29 offset:2048
    v_add_f32 v113, v113, v21
    v_mfma_f32_16x16x32_bf16 v[204:207], v[80:83], v[108:111], v[204:207]
    v_add_f32 v114, v114, v22
    v_add_f32 v115, v115, v23
    v_mfma_f32_16x16x32_bf16 v[208:211], v[84:87], v[96:99], v[208:211]
    buffer_load_dwordx4 a[28:31], v1, s[16:19], s59 offen offset:3072 sc1
    ds_read_b128 a[152:155], v29 offset:4096
    ds_read_b128 a[156:159], v29 offset:6144
    v_mfma_f32_16x16x32_bf16 v[212:215], v[84:87], v[100:103], v[212:215]
    s_nop 0
    v_permlane32_swap_b32 v112, v114
    v_mfma_f32_16x16x32_bf16 v[216:219], v[84:87], v[104:107], v[216:219]
    ds_read_b64_tr_b16 v[68:69], v35 offset:4096
    ds_read_b64_tr_b16 v[70:71], v35 offset:4608
    v_mfma_f32_16x16x32_bf16 v[220:223], v[84:87], v[108:111], v[220:223]
    v_permlane32_swap_b32 v113, v115
    s_add_u32 s59, s84, 8192
    s_waitcnt lgkmcnt(8)
    v_mfma_f32_16x16x32_bf16 v[224:227], v[88:91], v[96:99], v[224:227]
    buffer_load_dwordx4 a[32:35], v1, s[16:19], s59 offen offset:0 sc1
    ds_read_b64_tr_b16 v[72:73], v36 offset:4096
    ds_read_b64_tr_b16 v[74:75], v36 offset:4608
    v_mfma_f32_16x16x32_bf16 v[228:231], v[88:91], v[100:103], v[228:231]
    s_nop 0
    v_add_f32 v112, v112, v114
    v_mfma_f32_16x16x32_bf16 v[232:235], v[88:91], v[104:107], v[232:235]
    ds_read_b64_tr_b16 v[76:77], v37 offset:4096
    ds_read_b64_tr_b16 v[78:79], v37 offset:4608
    v_add_f32 v113, v113, v115
    v_mfma_f32_16x16x32_bf16 v[236:239], v[88:91], v[108:111], v[236:239]
    s_nop 1
    v_permlane16_swap_b32 v112, v113
    v_mfma_f32_16x16x32_bf16 v[240:243], v[92:95], v[96:99], v[240:243]
    buffer_load_dwordx4 a[36:39], v1, s[16:19], s59 offen offset:1024 sc1
    s_nop 0
    v_add_f32 v112, v112, v113
    v_mfma_f32_16x16x32_bf16 v[244:247], v[92:95], v[100:103], v[244:247]
    s_nop 1
    v_add_f32 v112, v112, v112 row_ror:8
    v_mfma_f32_16x16x32_bf16 v[248:251], v[92:95], v[104:107], v[248:251]
    ds_write_b32 v12, v112
    v_mfma_f32_16x16x32_bf16 v[252:255], v[92:95], v[108:111], v[252:255]
    s_waitcnt lgkmcnt(5)
    v_mfma_f32_16x16x32_bf16 v[128:131], v[64:67], a[144:147], v[128:131]
    buffer_load_dwordx4 a[40:43], v1, s[16:19], s59 offen offset:2048 sc1
    ds_read_b64_tr_b16 v[80:81], v34 offset:12288
    v_mfma_f32_16x16x32_bf16 v[132:135], v[64:67], a[148:151], v[132:135]
    ds_read_b64_tr_b16 v[82:83], v34 offset:12800
    v_mfma_f32_16x16x32_bf16 v[136:139], v[64:67], a[152:155], v[136:139]
    ds_read_b64_tr_b16 v[84:85], v35 offset:12288
    v_mfma_f32_16x16x32_bf16 v[140:143], v[64:67], a[156:159], v[140:143]
    v_mfma_f32_16x16x32_bf16 v[144:147], v[68:71], a[144:147], v[144:147]
    buffer_load_dwordx4 a[44:47], v1, s[16:19], s59 offen offset:3072 sc1
    v_mfma_f32_16x16x32_bf16 v[148:151], v[68:71], a[148:151], v[148:151]
    ds_read_b64_tr_b16 v[86:87], v35 offset:12800
    v_mfma_f32_16x16x32_bf16 v[152:155], v[68:71], a[152:155], v[152:155]
    ds_read_b64_tr_b16 v[88:89], v36 offset:12288
    ds_read_b64_tr_b16 v[90:91], v36 offset:12800
    v_mfma_f32_16x16x32_bf16 v[156:159], v[68:71], a[156:159], v[156:159]
    s_add_u32 s59, s84, 12288
    s_waitcnt lgkmcnt(7)
    v_mfma_f32_16x16x32_bf16 v[160:163], v[72:75], a[144:147], v[160:163]
    buffer_load_dwordx4 a[48:51], v1, s[16:19], s59 offen offset:0 sc1
    v_mfma_f32_16x16x32_bf16 v[164:167], v[72:75], a[148:151], v[164:167]
    ds_read_b64_tr_b16 v[92:93], v37 offset:12288
    v_mfma_f32_16x16x32_bf16 v[168:171], v[72:75], a[152:155], v[168:171]
    ds_read_b64_tr_b16 v[94:95], v37 offset:12800
    v_mfma_f32_16x16x32_bf16 v[172:175], v[72:75], a[156:159], v[172:175]
    v_mfma_f32_16x16x32_bf16 v[176:179], v[76:79], a[144:147], v[176:179]
    buffer_load_dwordx4 a[52:55], v1, s[16:19], s59 offen offset:1024 sc1
    v_mfma_f32_16x16x32_bf16 v[180:183], v[76:79], a[148:151], v[180:183]
    v_mfma_f32_16x16x32_bf16 v[184:187], v[76:79], a[152:155], v[184:187]
    v_mfma_f32_16x16x32_bf16 v[188:191], v[76:79], a[156:159], v[188:191]
    s_waitcnt lgkmcnt(0)
    s_barrier
    v_mfma_f32_16x16x32_bf16 v[192:195], v[80:83], a[144:147], v[192:195]
    buffer_load_dwordx4 a[56:59], v1, s[16:19], s59 offen offset:2048 sc1
    ds_read_b128 v[96:99], v26 offset:0
    v_mfma_f32_16x16x32_bf16 v[196:199], v[80:83], a[148:151], v[196:199]
    ds_read_b64_tr_b16 v[64:65], v30 offset:0
    v_mfma_f32_16x16x32_bf16 v[200:203], v[80:83], a[152:155], v[200:203]
    ds_read_b64_tr_b16 v[66:67], v30 offset:512
    v_mfma_f32_16x16x32_bf16 v[204:207], v[80:83], a[156:159], v[204:207]
    ds_read_b128 v[100:103], v26 offset:2048
    v_mfma_f32_16x16x32_bf16 v[208:211], v[84:87], a[144:147], v[208:211]
    buffer_load_dwordx4 a[60:63], v1, s[16:19], s59 offen offset:3072 sc1
    ds_read_b128 v[104:107], v26 offset:4096
    v_mfma_f32_16x16x32_bf16 v[212:215], v[84:87], a[148:151], v[212:215]
    ds_read_b128 v[108:111], v26 offset:6144
    v_mfma_f32_16x16x32_bf16 v[216:219], v[84:87], a[152:155], v[216:219]
    ds_read_b64_tr_b16 v[68:69], v31 offset:0
    ds_read_b64_tr_b16 v[70:71], v31 offset:512
    v_mfma_f32_16x16x32_bf16 v[220:223], v[84:87], a[156:159], v[220:223]
    s_add_u32 s59, s84, 16384
    v_mfma_f32_16x16x32_bf16 v[224:227], v[88:91], a[144:147], v[224:227]
    buffer_load_dwordx4 a[64:67], v1, s[16:19], s59 offen offset:0 sc1
    ds_read_b64_tr_b16 v[72:73], v32 offset:0
    v_mfma_f32_16x16x32_bf16 v[228:231], v[88:91], a[148:151], v[228:231]
    ds_read_b64_tr_b16 v[74:75], v32 offset:512
    v_mfma_f32_16x16x32_bf16 v[232:235], v[88:91], a[152:155], v[232:235]
    ds_read_b64_tr_b16 v[76:77], v33 offset:0
    v_mfma_f32_16x16x32_bf16 v[236:239], v[88:91], a[156:159], v[236:239]
    ds_read_b64_tr_b16 v[78:79], v33 offset:512
    v_mfma_f32_16x16x32_bf16 v[240:243], v[92:95], a[144:147], v[240:243]
    buffer_load_dwordx4 a[68:71], v1, s[16:19], s59 offen offset:1024 sc1
    v_mfma_f32_16x16x32_bf16 v[244:247], v[92:95], a[148:151], v[244:247]
    v_mfma_f32_16x16x32_bf16 v[248:251], v[92:95], a[152:155], v[248:251]
    v_mfma_f32_16x16x32_bf16 v[252:255], v[92:95], a[156:159], v[252:255]
    s_waitcnt lgkmcnt(4)
    v_mfma_f32_16x16x32_bf16 v[128:131], v[64:67], v[96:99], v[128:131]
    buffer_load_dwordx4 a[72:75], v1, s[16:19], s59 offen offset:2048 sc1
    ds_read_b64_tr_b16 v[80:81], v30 offset:8192
    v_mfma_f32_16x16x32_bf16 v[132:135], v[64:67], v[100:103], v[132:135]
    ds_read_b64_tr_b16 v[82:83], v30 offset:8704
    v_mfma_f32_16x16x32_bf16 v[136:139], v[64:67], v[104:107], v[136:139]
    ds_read_b64_tr_b16 v[84:85], v31 offset:8192
    v_mfma_f32_16x16x32_bf16 v[140:143], v[64:67], v[108:111], v[140:143]
    v_mfma_f32_16x16x32_bf16 v[144:147], v[68:71], v[96:99], v[144:147]
    buffer_load_dwordx4 a[76:79], v1, s[16:19], s59 offen offset:3072 sc1
    v_mfma_f32_16x16x32_bf16 v[148:151], v[68:71], v[100:103], v[148:151]
    ds_read_b64_tr_b16 v[86:87], v31 offset:8704
    v_mfma_f32_16x16x32_bf16 v[152:155], v[68:71], v[104:107], v[152:155]
    ds_read_b64_tr_b16 v[88:89], v32 offset:8192
    ds_read_b64_tr_b16 v[90:91], v32 offset:8704
    v_mfma_f32_16x16x32_bf16 v[156:159], v[68:71], v[108:111], v[156:159]
    s_add_u32 s59, s84, 20480
    s_waitcnt lgkmcnt(6)
    v_mfma_f32_16x16x32_bf16 v[160:163], v[72:75], v[96:99], v[160:163]
    buffer_load_dwordx4 a[80:83], v1, s[16:19], s59 offen offset:0 sc1
    v_mfma_f32_16x16x32_bf16 v[164:167], v[72:75], v[100:103], v[164:167]
    ds_read_b64_tr_b16 v[92:93], v33 offset:8192
    v_mfma_f32_16x16x32_bf16 v[168:171], v[72:75], v[104:107], v[168:171]
    ds_read_b64_tr_b16 v[94:95], v33 offset:8704
    v_mfma_f32_16x16x32_bf16 v[172:175], v[72:75], v[108:111], v[172:175]
    v_mfma_f32_16x16x32_bf16 v[176:179], v[76:79], v[96:99], v[176:179]
    buffer_load_dwordx4 a[84:87], v1, s[16:19], s59 offen offset:1024 sc1
    v_mfma_f32_16x16x32_bf16 v[180:183], v[76:79], v[100:103], v[180:183]
    v_mfma_f32_16x16x32_bf16 v[184:187], v[76:79], v[104:107], v[184:187]
    v_mfma_f32_16x16x32_bf16 v[188:191], v[76:79], v[108:111], v[188:191]
    s_waitcnt lgkmcnt(4)
    v_mfma_f32_16x16x32_bf16 v[192:195], v[80:83], v[96:99], v[192:195]
    buffer_load_dwordx4 a[88:91], v1, s[16:19], s59 offen offset:2048 sc1
    ds_read_b128 a[144:147], v27 offset:0
    v_mfma_f32_16x16x32_bf16 v[196:199], v[80:83], v[100:103], v[196:199]
    ds_read_b64_tr_b16 v[64:65], v30 offset:4096
    v_mfma_f32_16x16x32_bf16 v[200:203], v[80:83], v[104:107], v[200:203]
    ds_read_b64_tr_b16 v[66:67], v30 offset:4608
    v_mfma_f32_16x16x32_bf16 v[204:207], v[80:83], v[108:111], v[204:207]
    ds_read_b128 a[148:151], v27 offset:2048
    v_mfma_f32_16x16x32_bf16 v[208:211], v[84:87], v[96:99], v[208:211]
    buffer_load_dwordx4 a[92:95], v1, s[16:19], s59 offen offset:3072 sc1
    ds_read_b128 a[152:155], v27 offset:4096
    v_mfma_f32_16x16x32_bf16 v[212:215], v[84:87], v[100:103], v[212:215]
    ds_read_b128 a[156:159], v27 offset:6144
    v_mfma_f32_16x16x32_bf16 v[216:219], v[84:87], v[104:107], v[216:219]
    ds_read_b64_tr_b16 v[68:69], v31 offset:4096
    ds_read_b64_tr_b16 v[70:71], v31 offset:4608
    v_mfma_f32_16x16x32_bf16 v[220:223], v[84:87], v[108:111], v[220:223]
    s_add_u32 s59, s84, 24576
    s_waitcnt lgkmcnt(8)
    v_mfma_f32_16x16x32_bf16 v[224:227], v[88:91], v[96:99], v[224:227]
    buffer_load_dwordx4 a[96:99], v1, s[16:19], s59 offen offset:0 sc1
    ds_read_b64_tr_b16 v[72:73], v32 offset:4096
    v_mfma_f32_16x16x32_bf16 v[228:231], v[88:91], v[100:103], v[228:231]
    ds_read_b64_tr_b16 v[74:75], v32 offset:4608
    v_mfma_f32_16x16x32_bf16 v[232:235], v[88:91], v[104:107], v[232:235]
    ds_read_b64_tr_b16 v[76:77], v33 offset:4096
    v_mfma_f32_16x16x32_bf16 v[236:239], v[88:91], v[108:111], v[236:239]
    ds_read_b64_tr_b16 v[78:79], v33 offset:4608
    v_mfma_f32_16x16x32_bf16 v[240:243], v[92:95], v[96:99], v[240:243]
    buffer_load_dwordx4 a[100:103], v1, s[16:19], s59 offen offset:1024 sc1
    v_mfma_f32_16x16x32_bf16 v[244:247], v[92:95], v[100:103], v[244:247]
    v_mfma_f32_16x16x32_bf16 v[248:251], v[92:95], v[104:107], v[248:251]
    v_mfma_f32_16x16x32_bf16 v[252:255], v[92:95], v[108:111], v[252:255]
    s_waitcnt lgkmcnt(4)
    v_mfma_f32_16x16x32_bf16 v[128:131], v[64:67], a[144:147], v[128:131]
    buffer_load_dwordx4 a[104:107], v1, s[16:19], s59 offen offset:2048 sc1
    ds_read_b64_tr_b16 v[80:81], v30 offset:12288
    v_mfma_f32_16x16x32_bf16 v[132:135], v[64:67], a[148:151], v[132:135]
    ds_read_b64_tr_b16 v[82:83], v30 offset:12800
    v_mfma_f32_16x16x32_bf16 v[136:139], v[64:67], a[152:155], v[136:139]
    ds_read_b64_tr_b16 v[84:85], v31 offset:12288
    v_mfma_f32_16x16x32_bf16 v[140:143], v[64:67], a[156:159], v[140:143]
    v_mfma_f32_16x16x32_bf16 v[144:147], v[68:71], a[144:147], v[144:147]
    buffer_load_dwordx4 a[108:111], v1, s[16:19], s59 offen offset:3072 sc1
    v_mfma_f32_16x16x32_bf16 v[148:151], v[68:71], a[148:151], v[148:151]
    ds_read_b64_tr_b16 v[86:87], v31 offset:12800
    v_mfma_f32_16x16x32_bf16 v[152:155], v[68:71], a[152:155], v[152:155]
    ds_read_b64_tr_b16 v[88:89], v32 offset:12288
    ds_read_b64_tr_b16 v[90:91], v32 offset:12800
    v_mfma_f32_16x16x32_bf16 v[156:159], v[68:71], a[156:159], v[156:159]
    s_add_u32 s59, s84, 28672
    s_waitcnt lgkmcnt(6)
    v_mfma_f32_16x16x32_bf16 v[160:163], v[72:75], a[144:147], v[160:163]
    buffer_load_dwordx4 a[112:115], v1, s[16:19], s59 offen offset:0 sc1
    v_mfma_f32_16x16x32_bf16 v[164:167], v[72:75], a[148:151], v[164:167]
    ds_read_b64_tr_b16 v[92:93], v33 offset:12288
    v_mfma_f32_16x16x32_bf16 v[168:171], v[72:75], a[152:155], v[168:171]
    ds_read_b64_tr_b16 v[94:95], v33 offset:12800
    v_mfma_f32_16x16x32_bf16 v[172:175], v[72:75], a[156:159], v[172:175]
    v_mfma_f32_16x16x32_bf16 v[176:179], v[76:79], a[144:147], v[176:179]
    buffer_load_dwordx4 a[116:119], v1, s[16:19], s59 offen offset:1024 sc1
    v_mfma_f32_16x16x32_bf16 v[180:183], v[76:79], a[148:151], v[180:183]
    v_mfma_f32_16x16x32_bf16 v[184:187], v[76:79], a[152:155], v[184:187]
    v_mfma_f32_16x16x32_bf16 v[188:191], v[76:79], a[156:159], v[188:191]
    s_waitcnt lgkmcnt(4)
    v_mfma_f32_16x16x32_bf16 v[192:195], v[80:83], a[144:147], v[192:195]
    buffer_load_dwordx4 a[120:123], v1, s[16:19], s59 offen offset:2048 sc1
    v_mfma_f32_16x16x32_bf16 v[196:199], v[80:83], a[148:151], v[196:199]
    v_mfma_f32_16x16x32_bf16 v[200:203], v[80:83], a[152:155], v[200:203]
    ds_read_b128 v[64:67], v13 offset:0
    v_mfma_f32_16x16x32_bf16 v[204:207], v[80:83], a[156:159], v[204:207]
    ds_read_b128 v[68:71], v13 offset:64
    v_mfma_f32_16x16x32_bf16 v[208:211], v[84:87], a[144:147], v[208:211]
    buffer_load_dwordx4 a[124:127], v1, s[16:19], s59 offen offset:3072 sc1
    ds_read_b128 v[72:75], v13 offset:128
    v_mfma_f32_16x16x32_bf16 v[212:215], v[84:87], a[148:151], v[212:215]
    ds_read_b128 v[76:79], v13 offset:192
    v_mfma_f32_16x16x32_bf16 v[216:219], v[84:87], a[152:155], v[216:219]
    ds_read_b128 v[96:99], v13 offset:256
    ds_read_b128 v[100:103], v13 offset:320
    v_accvgpr_read_b32 v116, a215
    s_mul_i32 s56, s40, 655360
    v_mfma_f32_16x16x32_bf16 v[220:223], v[84:87], a[156:159], v[220:223]
    s_lshl_b32 s57, s45, 5
    s_add_u32 s56, s56, s57
    s_add_u32 s56, s56, 65536
    s_add_u32 s57, s56, 327680
    s_waitcnt lgkmcnt(6)
    v_mfma_f32_16x16x32_bf16 v[224:227], v[88:91], a[144:147], v[224:227]
    buffer_load_dwordx4 v[56:59], v116, s[16:19], s56 offen sc1
    ds_read_b128 v[104:107], v13 offset:384
    v_mfma_f32_16x16x32_bf16 v[228:231], v[88:91], a[148:151], v[228:231]
    ds_read_b128 v[108:111], v13 offset:448
    v_mfma_f32_16x16x32_bf16 v[232:235], v[88:91], a[152:155], v[232:235]
    buffer_load_dwordx4 v[60:63], v116, s[16:19], s57 offen sc1
    v_mfma_f32_16x16x32_bf16 v[236:239], v[88:91], a[156:159], v[236:239]
    v_mfma_f32_16x16x32_bf16 v[240:243], v[92:95], a[144:147], v[240:243]
    v_mfma_f32_16x16x32_bf16 v[244:247], v[92:95], a[148:151], v[244:247]
    v_mfma_f32_16x16x32_bf16 v[248:251], v[92:95], a[152:155], v[248:251]
    v_mfma_f32_16x16x32_bf16 v[252:255], v[92:95], a[156:159], v[252:255]
    s_waitcnt vmcnt(30)
    s_waitcnt lgkmcnt(0)
    .p2align 3
    v_pk_fma_f32 v[128:129], v[64:65], v[38:39], v[128:129] op_sel_hi:[1,0,1]
    v_pk_fma_f32 v[130:131], v[66:67], v[38:39], v[130:131] op_sel_hi:[1,0,1]
    v_pk_fma_f32 v[144:145], v[68:69], v[38:39], v[144:145] op_sel_hi:[1,0,1]
    v_pk_fma_f32 v[146:147], v[70:71], v[38:39], v[146:147] op_sel_hi:[1,0,1]
    v_pk_mul_f32 v[28:29], v[128:129], v[128:129]
    v_pk_mul_f32 v[30:31], v[130:131], v[130:131]
    v_pk_mul_f32 v[32:33], v[144:145], v[144:145]
    v_pk_mul_f32 v[34:35], v[146:147], v[146:147]
    v_pk_fma_f32 v[28:29], v[28:29], v[38:39], v[40:41] op_sel:[0,1,0] op_sel_hi:[1,1,0]
    v_pk_fma_f32 v[30:31], v[30:31], v[38:39], v[40:41] op_sel:[0,1,0] op_sel_hi:[1,1,0]
    v_pk_fma_f32 v[32:33], v[32:33], v[38:39], v[40:41] op_sel:[0,1,0] op_sel_hi:[1,1,0]
    v_pk_fma_f32 v[34:35], v[34:35], v[38:39], v[40:41] op_sel:[0,1,0] op_sel_hi:[1,1,0]
    v_pk_mul_f32 v[28:29], v[28:29], v[128:129]
    v_pk_mul_f32 v[30:31], v[30:31], v[130:131]
    v_pk_mul_f32 v[32:33], v[32:33], v[144:145]
    v_pk_mul_f32 v[34:35], v[34:35], v[146:147]
    v_exp_f32 v28, v28
    v_exp_f32 v29, v29
    v_exp_f32 v30, v30
    v_exp_f32 v31, v31
    v_exp_f32 v32, v32
    v_exp_f32 v33, v33
    v_exp_f32 v34, v34
    v_exp_f32 v35, v35
    v_pk_fma_f32 v[192:193], v[96:97], v[38:39], v[192:193] op_sel_hi:[1,0,1]
    v_pk_fma_f32 v[194:195], v[98:99], v[38:39], v[194:195] op_sel_hi:[1,0,1]
    v_pk_fma_f32 v[208:209], v[100:101], v[38:39], v[208:209] op_sel_hi:[1,0,1]
    v_pk_fma_f32 v[210:211], v[102:103], v[38:39], v[210:211] op_sel_hi:[1,0,1]
    v_pk_fma_f32 v[28:29], v[28:29], v[40:41], v[40:41] op_sel:[0,1,1] op_sel_hi:[1,1,1]
    v_pk_fma_f32 v[30:31], v[30:31], v[40:41], v[40:41] op_sel:[0,1,1] op_sel_hi:[1,1,1]
    v_pk_fma_f32 v[32:33], v[32:33], v[40:41], v[40:41] op_sel:[0,1,1] op_sel_hi:[1,1,1]
    v_pk_fma_f32 v[34:35], v[34:35], v[40:41], v[40:41] op_sel:[0,1,1] op_sel_hi:[1,1,1]
    v_rcp_f32 v28, v28
    v_rcp_f32 v29, v29
    v_rcp_f32 v30, v30
    v_rcp_f32 v31, v31
    v_rcp_f32 v32, v32
    v_rcp_f32 v33, v33
    v_rcp_f32 v34, v34
    v_rcp_f32 v35, v35
    v_pk_mul_f32 v[128:129], v[128:129], v[192:193]
    v_pk_mul_f32 v[130:131], v[130:131], v[194:195]
    v_pk_mul_f32 v[144:145], v[144:145], v[208:209]
    v_pk_mul_f32 v[146:147], v[146:147], v[210:211]
    v_pk_mul_f32 v[128:129], v[128:129], v[28:29]
    v_pk_mul_f32 v[130:131], v[130:131], v[30:31]
    v_pk_mul_f32 v[144:145], v[144:145], v[32:33]
    v_pk_mul_f32 v[146:147], v[146:147], v[34:35]
    v_cvt_pk_bf16_f32 v20, v128, v129
    v_cvt_pk_bf16_f32 v21, v130, v131
    v_cvt_pk_bf16_f32 v22, v144, v145
    v_cvt_pk_bf16_f32 v23, v146, v147
    buffer_store_dwordx4 v[20:23], v1, s[16:19], s64 offen offset:0 sc1
    v_pk_fma_f32 v[160:161], v[72:73], v[38:39], v[160:161] op_sel_hi:[1,0,1]
    v_pk_fma_f32 v[162:163], v[74:75], v[38:39], v[162:163] op_sel_hi:[1,0,1]
    v_pk_fma_f32 v[176:177], v[76:77], v[38:39], v[176:177] op_sel_hi:[1,0,1]
    v_pk_fma_f32 v[178:179], v[78:79], v[38:39], v[178:179] op_sel_hi:[1,0,1]
    v_pk_mul_f32 v[28:29], v[160:161], v[160:161]
    v_pk_mul_f32 v[30:31], v[162:163], v[162:163]
    v_pk_mul_f32 v[32:33], v[176:177], v[176:177]
    v_pk_mul_f32 v[34:35], v[178:179], v[178:179]
    v_pk_fma_f32 v[28:29], v[28:29], v[38:39], v[40:41] op_sel:[0,1,0] op_sel_hi:[1,1,0]
    v_pk_fma_f32 v[30:31], v[30:31], v[38:39], v[40:41] op_sel:[0,1,0] op_sel_hi:[1,1,0]
    v_pk_fma_f32 v[32:33], v[32:33], v[38:39], v[40:41] op_sel:[0,1,0] op_sel_hi:[1,1,0]
    v_pk_fma_f32 v[34:35], v[34:35], v[38:39], v[40:41] op_sel:[0,1,0] op_sel_hi:[1,1,0]
    v_pk_mul_f32 v[28:29], v[28:29], v[160:161]
    v_pk_mul_f32 v[30:31], v[30:31], v[162:163]
    v_pk_mul_f32 v[32:33], v[32:33], v[176:177]
    v_pk_mul_f32 v[34:35], v[34:35], v[178:179]
    v_exp_f32 v28, v28
    v_exp_f32 v29, v29
    v_exp_f32 v30, v30
    v_exp_f32 v31, v31
    v_exp_f32 v32, v32
    v_exp_f32 v33, v33
    v_exp_f32 v34, v34
    v_exp_f32 v35, v35
    v_pk_fma_f32 v[224:225], v[104:105], v[38:39], v[224:225] op_sel_hi:[1,0,1]
    v_pk_fma_f32 v[226:227], v[106:107], v[38:39], v[226:227] op_sel_hi:[1,0,1]
    v_pk_fma_f32 v[240:241], v[108:109], v[38:39], v[240:241] op_sel_hi:[1,0,1]
    v_pk_fma_f32 v[242:243], v[110:111], v[38:39], v[242:243] op_sel_hi:[1,0,1]
    v_pk_fma_f32 v[28:29], v[28:29], v[40:41], v[40:41] op_sel:[0,1,1] op_sel_hi:[1,1,1]
    v_pk_fma_f32 v[30:31], v[30:31], v[40:41], v[40:41] op_sel:[0,1,1] op_sel_hi:[1,1,1]
    v_pk_fma_f32 v[32:33], v[32:33], v[40:41], v[40:41] op_sel:[0,1,1] op_sel_hi:[1,1,1]
    v_pk_fma_f32 v[34:35], v[34:35], v[40:41], v[40:41] op_sel:[0,1,1] op_sel_hi:[1,1,1]
    v_rcp_f32 v28, v28
    v_rcp_f32 v29, v29
    v_rcp_f32 v30, v30
    v_rcp_f32 v31, v31
    v_rcp_f32 v32, v32
    v_rcp_f32 v33, v33
    v_rcp_f32 v34, v34
    v_rcp_f32 v35, v35
    v_pk_mul_f32 v[160:161], v[160:161], v[224:225]
    v_pk_mul_f32 v[162:163], v[162:163], v[226:227]
    v_pk_mul_f32 v[176:177], v[176:177], v[240:241]
    v_pk_mul_f32 v[178:179], v[178:179], v[242:243]
    v_pk_mul_f32 v[160:161], v[160:161], v[28:29]
    v_pk_mul_f32 v[162:163], v[162:163], v[30:31]
    v_pk_mul_f32 v[176:177], v[176:177], v[32:33]
    v_pk_mul_f32 v[178:179], v[178:179], v[34:35]
    v_cvt_pk_bf16_f32 v24, v160, v161
    v_cvt_pk_bf16_f32 v25, v162, v163
    v_cvt_pk_bf16_f32 v26, v176, v177
    v_cvt_pk_bf16_f32 v27, v178, v179
    buffer_store_dwordx4 v[24:27], v1, s[16:19], s64 offen offset:1024 sc1
    s_add_u32 s64, s64, 55296
    v_pk_fma_f32 v[132:133], v[64:65], v[48:49], v[132:133] op_sel_hi:[1,0,1]
    v_pk_fma_f32 v[134:135], v[66:67], v[48:49], v[134:135] op_sel_hi:[1,0,1]
    v_pk_fma_f32 v[148:149], v[68:69], v[48:49], v[148:149] op_sel_hi:[1,0,1]
    v_pk_fma_f32 v[150:151], v[70:71], v[48:49], v[150:151] op_sel_hi:[1,0,1]
    v_pk_mul_f32 v[28:29], v[132:133], v[132:133]
    v_pk_mul_f32 v[30:31], v[134:135], v[134:135]
    v_pk_mul_f32 v[32:33], v[148:149], v[148:149]
    v_pk_mul_f32 v[34:35], v[150:151], v[150:151]
    v_pk_fma_f32 v[28:29], v[28:29], v[48:49], v[50:51] op_sel:[0,1,0] op_sel_hi:[1,1,0]
    v_pk_fma_f32 v[30:31], v[30:31], v[48:49], v[50:51] op_sel:[0,1,0] op_sel_hi:[1,1,0]
    v_pk_fma_f32 v[32:33], v[32:33], v[48:49], v[50:51] op_sel:[0,1,0] op_sel_hi:[1,1,0]
    v_pk_fma_f32 v[34:35], v[34:35], v[48:49], v[50:51] op_sel:[0,1,0] op_sel_hi:[1,1,0]
    v_pk_mul_f32 v[28:29], v[28:29], v[132:133]
    v_pk_mul_f32 v[30:31], v[30:31], v[134:135]
    v_pk_mul_f32 v[32:33], v[32:33], v[148:149]
    v_pk_mul_f32 v[34:35], v[34:35], v[150:151]
    v_exp_f32 v28, v28
    v_exp_f32 v29, v29
    v_exp_f32 v30, v30
    v_exp_f32 v31, v31
    v_exp_f32 v32, v32
    v_exp_f32 v33, v33
    v_exp_f32 v34, v34
    v_exp_f32 v35, v35
    v_pk_fma_f32 v[196:197], v[96:97], v[48:49], v[196:197] op_sel_hi:[1,0,1]
    v_pk_fma_f32 v[198:199], v[98:99], v[48:49], v[198:199] op_sel_hi:[1,0,1]
    v_pk_fma_f32 v[212:213], v[100:101], v[48:49], v[212:213] op_sel_hi:[1,0,1]
    v_pk_fma_f32 v[214:215], v[102:103], v[48:49], v[214:215] op_sel_hi:[1,0,1]
    v_pk_fma_f32 v[28:29], v[28:29], v[50:51], v[50:51] op_sel:[0,1,1] op_sel_hi:[1,1,1]
    v_pk_fma_f32 v[30:31], v[30:31], v[50:51], v[50:51] op_sel:[0,1,1] op_sel_hi:[1,1,1]
    v_pk_fma_f32 v[32:33], v[32:33], v[50:51], v[50:51] op_sel:[0,1,1] op_sel_hi:[1,1,1]
    v_pk_fma_f32 v[34:35], v[34:35], v[50:51], v[50:51] op_sel:[0,1,1] op_sel_hi:[1,1,1]
    v_rcp_f32 v28, v28
    v_rcp_f32 v29, v29
    v_rcp_f32 v30, v30
    v_rcp_f32 v31, v31
    v_rcp_f32 v32, v32
    v_rcp_f32 v33, v33
    v_rcp_f32 v34, v34
    v_rcp_f32 v35, v35
    v_pk_mul_f32 v[132:133], v[132:133], v[196:197]
    v_pk_mul_f32 v[134:135], v[134:135], v[198:199]
    v_pk_mul_f32 v[148:149], v[148:149], v[212:213]
    v_pk_mul_f32 v[150:151], v[150:151], v[214:215]
    v_pk_mul_f32 v[132:133], v[132:133], v[28:29]
    v_pk_mul_f32 v[134:135], v[134:135], v[30:31]
    v_pk_mul_f32 v[148:149], v[148:149], v[32:33]
    v_pk_mul_f32 v[150:151], v[150:151], v[34:35]
    v_cvt_pk_bf16_f32 v20, v132, v133
    v_cvt_pk_bf16_f32 v21, v134, v135
    v_cvt_pk_bf16_f32 v22, v148, v149
    v_cvt_pk_bf16_f32 v23, v150, v151
    buffer_store_dwordx4 v[20:23], v1, s[16:19], s64 offen offset:0 sc1
    v_pk_fma_f32 v[164:165], v[72:73], v[48:49], v[164:165] op_sel_hi:[1,0,1]
    v_pk_fma_f32 v[166:167], v[74:75], v[48:49], v[166:167] op_sel_hi:[1,0,1]
    v_pk_fma_f32 v[180:181], v[76:77], v[48:49], v[180:181] op_sel_hi:[1,0,1]
    v_pk_fma_f32 v[182:183], v[78:79], v[48:49], v[182:183] op_sel_hi:[1,0,1]
    v_pk_mul_f32 v[28:29], v[164:165], v[164:165]
    v_pk_mul_f32 v[30:31], v[166:167], v[166:167]
    v_pk_mul_f32 v[32:33], v[180:181], v[180:181]
    v_pk_mul_f32 v[34:35], v[182:183], v[182:183]
    v_pk_fma_f32 v[28:29], v[28:29], v[48:49], v[50:51] op_sel:[0,1,0] op_sel_hi:[1,1,0]
    v_pk_fma_f32 v[30:31], v[30:31], v[48:49], v[50:51] op_sel:[0,1,0] op_sel_hi:[1,1,0]
    v_pk_fma_f32 v[32:33], v[32:33], v[48:49], v[50:51] op_sel:[0,1,0] op_sel_hi:[1,1,0]
    v_pk_fma_f32 v[34:35], v[34:35], v[48:49], v[50:51] op_sel:[0,1,0] op_sel_hi:[1,1,0]
    v_pk_mul_f32 v[28:29], v[28:29], v[164:165]
    v_pk_mul_f32 v[30:31], v[30:31], v[166:167]
    v_pk_mul_f32 v[32:33], v[32:33], v[180:181]
    v_pk_mul_f32 v[34:35], v[34:35], v[182:183]
    v_exp_f32 v28, v28
    v_exp_f32 v29, v29
    v_exp_f32 v30, v30
    v_exp_f32 v31, v31
    v_exp_f32 v32, v32
    v_exp_f32 v33, v33
    v_exp_f32 v34, v34
    v_exp_f32 v35, v35
    v_pk_fma_f32 v[228:229], v[104:105], v[48:49], v[228:229] op_sel_hi:[1,0,1]
    v_pk_fma_f32 v[230:231], v[106:107], v[48:49], v[230:231] op_sel_hi:[1,0,1]
    v_pk_fma_f32 v[244:245], v[108:109], v[48:49], v[244:245] op_sel_hi:[1,0,1]
    v_pk_fma_f32 v[246:247], v[110:111], v[48:49], v[246:247] op_sel_hi:[1,0,1]
    v_pk_fma_f32 v[28:29], v[28:29], v[50:51], v[50:51] op_sel:[0,1,1] op_sel_hi:[1,1,1]
    v_pk_fma_f32 v[30:31], v[30:31], v[50:51], v[50:51] op_sel:[0,1,1] op_sel_hi:[1,1,1]
    v_pk_fma_f32 v[32:33], v[32:33], v[50:51], v[50:51] op_sel:[0,1,1] op_sel_hi:[1,1,1]
    v_pk_fma_f32 v[34:35], v[34:35], v[50:51], v[50:51] op_sel:[0,1,1] op_sel_hi:[1,1,1]
    v_rcp_f32 v28, v28
    v_rcp_f32 v29, v29
    v_rcp_f32 v30, v30
    v_rcp_f32 v31, v31
    v_rcp_f32 v32, v32
    v_rcp_f32 v33, v33
    v_rcp_f32 v34, v34
    v_rcp_f32 v35, v35
    v_pk_mul_f32 v[164:165], v[164:165], v[228:229]
    v_pk_mul_f32 v[166:167], v[166:167], v[230:231]
    v_pk_mul_f32 v[180:181], v[180:181], v[244:245]
    v_pk_mul_f32 v[182:183], v[182:183], v[246:247]
    v_pk_mul_f32 v[164:165], v[164:165], v[28:29]
    v_pk_mul_f32 v[166:167], v[166:167], v[30:31]
    v_pk_mul_f32 v[180:181], v[180:181], v[32:33]
    v_pk_mul_f32 v[182:183], v[182:183], v[34:35]
    v_cvt_pk_bf16_f32 v24, v164, v165
    v_cvt_pk_bf16_f32 v25, v166, v167
    v_cvt_pk_bf16_f32 v26, v180, v181
    v_cvt_pk_bf16_f32 v27, v182, v183
    buffer_store_dwordx4 v[24:27], v1, s[16:19], s64 offen offset:1024 sc1
    s_add_u32 s64, s64, 55296
    v_pk_fma_f32 v[136:137], v[64:65], v[52:53], v[136:137] op_sel_hi:[1,0,1]
    v_pk_fma_f32 v[138:139], v[66:67], v[52:53], v[138:139] op_sel_hi:[1,0,1]
    v_pk_fma_f32 v[152:153], v[68:69], v[52:53], v[152:153] op_sel_hi:[1,0,1]
    v_pk_fma_f32 v[154:155], v[70:71], v[52:53], v[154:155] op_sel_hi:[1,0,1]
    v_pk_mul_f32 v[28:29], v[136:137], v[136:137]
    v_pk_mul_f32 v[30:31], v[138:139], v[138:139]
    v_pk_mul_f32 v[32:33], v[152:153], v[152:153]
    v_pk_mul_f32 v[34:35], v[154:155], v[154:155]
    v_pk_fma_f32 v[28:29], v[28:29], v[52:53], v[54:55] op_sel:[0,1,0] op_sel_hi:[1,1,0]
    v_pk_fma_f32 v[30:31], v[30:31], v[52:53], v[54:55] op_sel:[0,1,0] op_sel_hi:[1,1,0]
    v_pk_fma_f32 v[32:33], v[32:33], v[52:53], v[54:55] op_sel:[0,1,0] op_sel_hi:[1,1,0]
    v_pk_fma_f32 v[34:35], v[34:35], v[52:53], v[54:55] op_sel:[0,1,0] op_sel_hi:[1,1,0]
    v_pk_mul_f32 v[28:29], v[28:29], v[136:137]
    v_pk_mul_f32 v[30:31], v[30:31], v[138:139]
    v_pk_mul_f32 v[32:33], v[32:33], v[152:153]
    v_pk_mul_f32 v[34:35], v[34:35], v[154:155]
    v_exp_f32 v28, v28
    v_exp_f32 v29, v29
    v_exp_f32 v30, v30
    v_exp_f32 v31, v31
    v_exp_f32 v32, v32
    v_exp_f32 v33, v33
    v_exp_f32 v34, v34
    v_exp_f32 v35, v35
    v_pk_fma_f32 v[200:201], v[96:97], v[52:53], v[200:201] op_sel_hi:[1,0,1]
    v_pk_fma_f32 v[202:203], v[98:99], v[52:53], v[202:203] op_sel_hi:[1,0,1]
    v_pk_fma_f32 v[216:217], v[100:101], v[52:53], v[216:217] op_sel_hi:[1,0,1]
    v_pk_fma_f32 v[218:219], v[102:103], v[52:53], v[218:219] op_sel_hi:[1,0,1]
    v_pk_fma_f32 v[28:29], v[28:29], v[54:55], v[54:55] op_sel:[0,1,1] op_sel_hi:[1,1,1]
    v_pk_fma_f32 v[30:31], v[30:31], v[54:55], v[54:55] op_sel:[0,1,1] op_sel_hi:[1,1,1]
    v_pk_fma_f32 v[32:33], v[32:33], v[54:55], v[54:55] op_sel:[0,1,1] op_sel_hi:[1,1,1]
    v_pk_fma_f32 v[34:35], v[34:35], v[54:55], v[54:55] op_sel:[0,1,1] op_sel_hi:[1,1,1]
    v_rcp_f32 v28, v28
    v_rcp_f32 v29, v29
    v_rcp_f32 v30, v30
    v_rcp_f32 v31, v31
    v_rcp_f32 v32, v32
    v_rcp_f32 v33, v33
    v_rcp_f32 v34, v34
    v_rcp_f32 v35, v35
    v_pk_mul_f32 v[136:137], v[136:137], v[200:201]
    v_pk_mul_f32 v[138:139], v[138:139], v[202:203]
    v_pk_mul_f32 v[152:153], v[152:153], v[216:217]
    v_pk_mul_f32 v[154:155], v[154:155], v[218:219]
    v_pk_mul_f32 v[136:137], v[136:137], v[28:29]
    v_pk_mul_f32 v[138:139], v[138:139], v[30:31]
    v_pk_mul_f32 v[152:153], v[152:153], v[32:33]
    v_pk_mul_f32 v[154:155], v[154:155], v[34:35]
    v_cvt_pk_bf16_f32 v20, v136, v137
    v_cvt_pk_bf16_f32 v21, v138, v139
    v_cvt_pk_bf16_f32 v22, v152, v153
    v_cvt_pk_bf16_f32 v23, v154, v155
    buffer_store_dwordx4 v[20:23], v1, s[16:19], s64 offen offset:0 sc1
    v_pk_fma_f32 v[168:169], v[72:73], v[52:53], v[168:169] op_sel_hi:[1,0,1]
    v_pk_fma_f32 v[170:171], v[74:75], v[52:53], v[170:171] op_sel_hi:[1,0,1]
    v_pk_fma_f32 v[184:185], v[76:77], v[52:53], v[184:185] op_sel_hi:[1,0,1]
    v_pk_fma_f32 v[186:187], v[78:79], v[52:53], v[186:187] op_sel_hi:[1,0,1]
    v_pk_mul_f32 v[28:29], v[168:169], v[168:169]
    v_pk_mul_f32 v[30:31], v[170:171], v[170:171]
    v_pk_mul_f32 v[32:33], v[184:185], v[184:185]
    v_pk_mul_f32 v[34:35], v[186:187], v[186:187]
    v_pk_fma_f32 v[28:29], v[28:29], v[52:53], v[54:55] op_sel:[0,1,0] op_sel_hi:[1,1,0]
    v_pk_fma_f32 v[30:31], v[30:31], v[52:53], v[54:55] op_sel:[0,1,0] op_sel_hi:[1,1,0]
    v_pk_fma_f32 v[32:33], v[32:33], v[52:53], v[54:55] op_sel:[0,1,0] op_sel_hi:[1,1,0]
    v_pk_fma_f32 v[34:35], v[34:35], v[52:53], v[54:55] op_sel:[0,1,0] op_sel_hi:[1,1,0]
    v_pk_mul_f32 v[28:29], v[28:29], v[168:169]
    v_pk_mul_f32 v[30:31], v[30:31], v[170:171]
    v_pk_mul_f32 v[32:33], v[32:33], v[184:185]
    v_pk_mul_f32 v[34:35], v[34:35], v[186:187]
    v_exp_f32 v28, v28
    v_exp_f32 v29, v29
    v_exp_f32 v30, v30
    v_exp_f32 v31, v31
    v_exp_f32 v32, v32
    v_exp_f32 v33, v33
    v_exp_f32 v34, v34
    v_exp_f32 v35, v35
    v_pk_fma_f32 v[232:233], v[104:105], v[52:53], v[232:233] op_sel_hi:[1,0,1]
    v_pk_fma_f32 v[234:235], v[106:107], v[52:53], v[234:235] op_sel_hi:[1,0,1]
    v_pk_fma_f32 v[248:249], v[108:109], v[52:53], v[248:249] op_sel_hi:[1,0,1]
    v_pk_fma_f32 v[250:251], v[110:111], v[52:53], v[250:251] op_sel_hi:[1,0,1]
    v_pk_fma_f32 v[28:29], v[28:29], v[54:55], v[54:55] op_sel:[0,1,1] op_sel_hi:[1,1,1]
    v_pk_fma_f32 v[30:31], v[30:31], v[54:55], v[54:55] op_sel:[0,1,1] op_sel_hi:[1,1,1]
    v_pk_fma_f32 v[32:33], v[32:33], v[54:55], v[54:55] op_sel:[0,1,1] op_sel_hi:[1,1,1]
    v_pk_fma_f32 v[34:35], v[34:35], v[54:55], v[54:55] op_sel:[0,1,1] op_sel_hi:[1,1,1]
    v_rcp_f32 v28, v28
    v_rcp_f32 v29, v29
    v_rcp_f32 v30, v30
    v_rcp_f32 v31, v31
    v_rcp_f32 v32, v32
    v_rcp_f32 v33, v33
    v_rcp_f32 v34, v34
    v_rcp_f32 v35, v35
    v_pk_mul_f32 v[168:169], v[168:169], v[232:233]
    v_pk_mul_f32 v[170:171], v[170:171], v[234:235]
    v_pk_mul_f32 v[184:185], v[184:185], v[248:249]
    v_pk_mul_f32 v[186:187], v[186:187], v[250:251]
    v_pk_mul_f32 v[168:169], v[168:169], v[28:29]
    v_pk_mul_f32 v[170:171], v[170:171], v[30:31]
    v_pk_mul_f32 v[184:185], v[184:185], v[32:33]
    v_pk_mul_f32 v[186:187], v[186:187], v[34:35]
    v_cvt_pk_bf16_f32 v24, v168, v169
    v_cvt_pk_bf16_f32 v25, v170, v171
    v_cvt_pk_bf16_f32 v26, v184, v185
    v_cvt_pk_bf16_f32 v27, v186, v187
    buffer_store_dwordx4 v[24:27], v1, s[16:19], s64 offen offset:1024 sc1
    s_add_u32 s64, s64, 55296
    v_pk_fma_f32 v[140:141], v[64:65], v[16:17], v[140:141] op_sel_hi:[1,0,1]
    v_pk_fma_f32 v[142:143], v[66:67], v[16:17], v[142:143] op_sel_hi:[1,0,1]
    v_pk_fma_f32 v[156:157], v[68:69], v[16:17], v[156:157] op_sel_hi:[1,0,1]
    v_pk_fma_f32 v[158:159], v[70:71], v[16:17], v[158:159] op_sel_hi:[1,0,1]
    v_pk_mul_f32 v[28:29], v[140:141], v[140:141]
    v_pk_mul_f32 v[30:31], v[142:143], v[142:143]
    v_pk_mul_f32 v[32:33], v[156:157], v[156:157]
    v_pk_mul_f32 v[34:35], v[158:159], v[158:159]
    v_pk_fma_f32 v[28:29], v[28:29], v[16:17], v[18:19] op_sel:[0,1,0] op_sel_hi:[1,1,0]
    v_pk_fma_f32 v[30:31], v[30:31], v[16:17], v[18:19] op_sel:[0,1,0] op_sel_hi:[1,1,0]
    v_pk_fma_f32 v[32:33], v[32:33], v[16:17], v[18:19] op_sel:[0,1,0] op_sel_hi:[1,1,0]
    v_pk_fma_f32 v[34:35], v[34:35], v[16:17], v[18:19] op_sel:[0,1,0] op_sel_hi:[1,1,0]
    v_pk_mul_f32 v[28:29], v[28:29], v[140:141]
    v_pk_mul_f32 v[30:31], v[30:31], v[142:143]
    v_pk_mul_f32 v[32:33], v[32:33], v[156:157]
    v_pk_mul_f32 v[34:35], v[34:35], v[158:159]
    v_exp_f32 v28, v28
    v_exp_f32 v29, v29
    v_exp_f32 v30, v30
    v_exp_f32 v31, v31
    v_exp_f32 v32, v32
    v_exp_f32 v33, v33
    v_exp_f32 v34, v34
    v_exp_f32 v35, v35
    v_pk_fma_f32 v[204:205], v[96:97], v[16:17], v[204:205] op_sel_hi:[1,0,1]
    v_pk_fma_f32 v[206:207], v[98:99], v[16:17], v[206:207] op_sel_hi:[1,0,1]
    v_pk_fma_f32 v[220:221], v[100:101], v[16:17], v[220:221] op_sel_hi:[1,0,1]
    v_pk_fma_f32 v[222:223], v[102:103], v[16:17], v[222:223] op_sel_hi:[1,0,1]
    v_pk_fma_f32 v[28:29], v[28:29], v[18:19], v[18:19] op_sel:[0,1,1] op_sel_hi:[1,1,1]
    v_pk_fma_f32 v[30:31], v[30:31], v[18:19], v[18:19] op_sel:[0,1,1] op_sel_hi:[1,1,1]
    v_pk_fma_f32 v[32:33], v[32:33], v[18:19], v[18:19] op_sel:[0,1,1] op_sel_hi:[1,1,1]
    v_pk_fma_f32 v[34:35], v[34:35], v[18:19], v[18:19] op_sel:[0,1,1] op_sel_hi:[1,1,1]
    v_rcp_f32 v28, v28
    v_rcp_f32 v29, v29
    v_rcp_f32 v30, v30
    v_rcp_f32 v31, v31
    v_rcp_f32 v32, v32
    v_rcp_f32 v33, v33
    v_rcp_f32 v34, v34
    v_rcp_f32 v35, v35
    v_pk_mul_f32 v[140:141], v[140:141], v[204:205]
    v_pk_mul_f32 v[142:143], v[142:143], v[206:207]
    v_pk_mul_f32 v[156:157], v[156:157], v[220:221]
    v_pk_mul_f32 v[158:159], v[158:159], v[222:223]
    v_pk_mul_f32 v[140:141], v[140:141], v[28:29]
    v_pk_mul_f32 v[142:143], v[142:143], v[30:31]
    v_pk_mul_f32 v[156:157], v[156:157], v[32:33]
    v_pk_mul_f32 v[158:159], v[158:159], v[34:35]
    v_cvt_pk_bf16_f32 v20, v140, v141
    v_cvt_pk_bf16_f32 v21, v142, v143
    v_cvt_pk_bf16_f32 v22, v156, v157
    v_cvt_pk_bf16_f32 v23, v158, v159
    buffer_store_dwordx4 v[20:23], v1, s[16:19], s64 offen offset:0 sc1
    v_pk_fma_f32 v[172:173], v[72:73], v[16:17], v[172:173] op_sel_hi:[1,0,1]
    v_pk_fma_f32 v[174:175], v[74:75], v[16:17], v[174:175] op_sel_hi:[1,0,1]
    v_pk_fma_f32 v[188:189], v[76:77], v[16:17], v[188:189] op_sel_hi:[1,0,1]
    v_pk_fma_f32 v[190:191], v[78:79], v[16:17], v[190:191] op_sel_hi:[1,0,1]
    v_pk_mul_f32 v[28:29], v[172:173], v[172:173]
    v_pk_mul_f32 v[30:31], v[174:175], v[174:175]
    v_pk_mul_f32 v[32:33], v[188:189], v[188:189]
    v_pk_mul_f32 v[34:35], v[190:191], v[190:191]
    v_pk_fma_f32 v[28:29], v[28:29], v[16:17], v[18:19] op_sel:[0,1,0] op_sel_hi:[1,1,0]
    v_pk_fma_f32 v[30:31], v[30:31], v[16:17], v[18:19] op_sel:[0,1,0] op_sel_hi:[1,1,0]
    v_pk_fma_f32 v[32:33], v[32:33], v[16:17], v[18:19] op_sel:[0,1,0] op_sel_hi:[1,1,0]
    v_pk_fma_f32 v[34:35], v[34:35], v[16:17], v[18:19] op_sel:[0,1,0] op_sel_hi:[1,1,0]
    v_pk_mul_f32 v[28:29], v[28:29], v[172:173]
    v_pk_mul_f32 v[30:31], v[30:31], v[174:175]
    v_pk_mul_f32 v[32:33], v[32:33], v[188:189]
    v_pk_mul_f32 v[34:35], v[34:35], v[190:191]
    v_exp_f32 v28, v28
    v_exp_f32 v29, v29
    v_exp_f32 v30, v30
    v_exp_f32 v31, v31
    v_exp_f32 v32, v32
    v_exp_f32 v33, v33
    v_exp_f32 v34, v34
    v_exp_f32 v35, v35
    v_pk_fma_f32 v[236:237], v[104:105], v[16:17], v[236:237] op_sel_hi:[1,0,1]
    v_pk_fma_f32 v[238:239], v[106:107], v[16:17], v[238:239] op_sel_hi:[1,0,1]
    v_pk_fma_f32 v[252:253], v[108:109], v[16:17], v[252:253] op_sel_hi:[1,0,1]
    v_pk_fma_f32 v[254:255], v[110:111], v[16:17], v[254:255] op_sel_hi:[1,0,1]
    v_pk_fma_f32 v[28:29], v[28:29], v[18:19], v[18:19] op_sel:[0,1,1] op_sel_hi:[1,1,1]
    v_pk_fma_f32 v[30:31], v[30:31], v[18:19], v[18:19] op_sel:[0,1,1] op_sel_hi:[1,1,1]
    v_pk_fma_f32 v[32:33], v[32:33], v[18:19], v[18:19] op_sel:[0,1,1] op_sel_hi:[1,1,1]
    v_pk_fma_f32 v[34:35], v[34:35], v[18:19], v[18:19] op_sel:[0,1,1] op_sel_hi:[1,1,1]
    v_rcp_f32 v28, v28
    v_rcp_f32 v29, v29
    v_rcp_f32 v30, v30
    v_rcp_f32 v31, v31
    v_rcp_f32 v32, v32
    v_rcp_f32 v33, v33
    v_rcp_f32 v34, v34
    v_rcp_f32 v35, v35
    v_pk_mul_f32 v[172:173], v[172:173], v[236:237]
    v_pk_mul_f32 v[174:175], v[174:175], v[238:239]
    v_pk_mul_f32 v[188:189], v[188:189], v[252:253]
    v_pk_mul_f32 v[190:191], v[190:191], v[254:255]
    v_pk_mul_f32 v[172:173], v[172:173], v[28:29]
    v_pk_mul_f32 v[174:175], v[174:175], v[30:31]
    v_pk_mul_f32 v[188:189], v[188:189], v[32:33]
    v_pk_mul_f32 v[190:191], v[190:191], v[34:35]
    v_cvt_pk_bf16_f32 v24, v172, v173
    v_cvt_pk_bf16_f32 v25, v174, v175
    v_cvt_pk_bf16_f32 v26, v188, v189
    v_cvt_pk_bf16_f32 v27, v190, v191
    buffer_store_dwordx4 v[24:27], v1, s[16:19], s64 offen offset:1024 sc1
    s_mov_b32 s60, s85
    s_nop 0
    v_accvgpr_read_b32 v24, a232
    v_accvgpr_read_b32 v25, a233
    v_accvgpr_read_b32 v26, a234
    v_accvgpr_read_b32 v27, a235
    v_accvgpr_read_b32 v28, a236
    v_accvgpr_read_b32 v29, a237
    v_accvgpr_read_b32 v30, a238
    v_accvgpr_read_b32 v31, a239
    v_accvgpr_read_b32 v32, a240
    v_accvgpr_read_b32 v33, a241
    v_accvgpr_read_b32 v34, a242
    v_accvgpr_read_b32 v35, a243
    v_accvgpr_read_b32 v36, a244
    v_accvgpr_read_b32 v37, a245
    v_accvgpr_read_b32 v38, a246
    v_accvgpr_read_b32 v39, a247
    v_accvgpr_read_b32 v40, a248
    v_accvgpr_read_b32 v41, a249
    v_accvgpr_read_b32 v42, a250
    v_accvgpr_read_b32 v43, a251
    v_accvgpr_read_b32 v44, a252
    v_accvgpr_read_b32 v45, a253
    v_accvgpr_read_b32 v48, a195
    v_accvgpr_read_b32 v49, a196
    v_accvgpr_read_b32 v50, a197
    v_accvgpr_read_b32 v51, a198
    v_accvgpr_read_b32 v52, a199
    v_accvgpr_read_b32 v53, a200
    v_mov_b32 v4, 0
    v_mov_b32 v5, 0
    v_mov_b32 v6, 0
    v_mov_b32 v7, 0
    ds_write_b128 v48, v[4:7]
L_conv_last:
    v_accvgpr_read_b32 v9, a206
    v_accvgpr_read_b32 v10, a207
    v_accvgpr_read_b32 v11, a208
    v_accvgpr_read_b32 v12, a209
    v_accvgpr_read_b32 v13, a210
    v_accvgpr_read_b32 v14, a211
    v_accvgpr_read_b32 v15, a212
    ds_read_b32 v128, v24
    ds_read_b32 v129, v25
    ds_read_b32 v130, v26
    ds_read_b32 v131, v27
    ds_read_b32 v132, v28
    ds_read_b32 v133, v29
    ds_read_b32 v134, v30
    ds_read_b32 v135, v31
    ds_read_b32 v136, v32
    ds_read_b32 v137, v33
    ds_read_b32 v138, v34
    ds_read_b32 v140, v35
    ds_read_b32 v141, v36
    ds_read_b32 v142, v37
    ds_read_b32 v143, v38
    ds_read_b32 v144, v39
    ds_read_b32 v145, v40
    ds_read_b32 v146, v41
    ds_read_b32 v147, v42
    ds_read_b32 v148, v43
    ds_read_b32 v149, v44
    ds_read_b32 v150, v45
    ds_read_b64 v[100:101], v51 offset:2600
    s_add_u32 m0, s94, 0
    s_nop 0
    buffer_load_dwordx4 v12, s[4:7], s86 offen lds
    s_add_u32 m0, s94, 1024
    s_nop 0
    buffer_load_dwordx4 v13, s[4:7], s86 offen lds
    s_add_u32 m0, s94, 2048
    s_nop 0
    buffer_load_dwordx4 v14, s[4:7], s86 offen lds
    s_waitcnt vmcnt(3)
    ds_write_b128 v50, v[56:59]
    ds_write_b128 v50, v[60:63] offset:512
    s_or_b32 s55, s2, s40
    s_cmp_eq_u32 s55, 0
    s_cselect_b32 s55, 0, 2147418112
    buffer_store_dword v120, v121, s[16:19], s55 offen sc1
    s_waitcnt lgkmcnt(14)
    .p2align 3
    v_cvt_pk_f16_f32 v64, v128, v129
    v_cvt_pk_f16_f32 v65, v130, v131
    v_cvt_pk_f16_f32 v66, v132, v133
    v_cvt_pk_f16_f32 v67, v134, v135
    ds_write_b128 v49, v[64:67] offset:0
    v_cvt_pk_f16_f32 v68, v129, v130
    v_cvt_pk_f16_f32 v69, v131, v132
    v_cvt_pk_f16_f32 v70, v133, v134
    v_cvt_pk_f16_f32 v71, v135, v136
    ds_write_b128 v49, v[68:71] offset:4160
    s_add_u32 s59, s84, 32768
    buffer_load_dwordx4 a[128:131], v1, s[16:19], s59 offen offset:0 sc1
    v_cvt_pk_f16_f32 v72, v130, v131
    v_cvt_pk_f16_f32 v73, v132, v133
    v_cvt_pk_f16_f32 v74, v134, v135
    v_cvt_pk_f16_f32 v75, v136, v137
    ds_write_b128 v49, v[72:75] offset:8320
    v_cvt_pk_f16_f32 v76, v131, v132
    v_cvt_pk_f16_f32 v77, v133, v134
    v_cvt_pk_f16_f32 v78, v135, v136
    v_cvt_pk_f16_f32 v79, v137, v138
    ds_write_b128 v49, v[76:79] offset:12480
    buffer_load_dwordx4 a[132:135], v1, s[16:19], s59 offen offset:1024 sc1
    s_waitcnt lgkmcnt(7)
    .p2align 3
    v_cvt_pk_f16_f32 v80, v140, v141
    v_cvt_pk_f16_f32 v81, v142, v143
    v_cvt_pk_f16_f32 v82, v144, v145
    v_cvt_pk_f16_f32 v83, v146, v147
    ds_write_b128 v49, v[80:83] offset:1024
    v_cvt_pk_f16_f32 v84, v141, v142
    v_cvt_pk_f16_f32 v85, v143, v144
    v_cvt_pk_f16_f32 v86, v145, v146
    v_cvt_pk_f16_f32 v87, v147, v148
    ds_write_b128 v49, v[84:87] offset:5184
    buffer_load_dwordx4 a[136:139], v1, s[16:19], s59 offen offset:2048 sc1
    v_cvt_pk_f16_f32 v88, v142, v143
    v_cvt_pk_f16_f32 v89, v144, v145
    v_cvt_pk_f16_f32 v90, v146, v147
    v_cvt_pk_f16_f32 v91, v148, v149
    ds_write_b128 v49, v[88:91] offset:9344
    v_cvt_pk_f16_f32 v92, v143, v144
    v_cvt_pk_f16_f32 v93, v145, v146
    v_cvt_pk_f16_f32 v94, v147, v148
    v_cvt_pk_f16_f32 v95, v149, v150
    ds_write_b128 v49, v[92:95] offset:13504
    buffer_load_dwordx4 a[140:143], v1, s[16:19], s59 offen offset:3072 sc1
    s_waitcnt vmcnt(7)
    buffer_store_dword v120, v121, s[16:19], s60 offen sc1
    s_add_u32 s59, s84, 36864
    buffer_load_dwordx4 a[144:147], v1, s[16:19], s59 offen offset:0 sc1
    buffer_load_dwordx4 a[148:151], v1, s[16:19], s59 offen offset:1024 sc1
    s_waitcnt lgkmcnt(0)
    s_barrier
    ds_read_b128 v[224:227], v53 offset:192
    ds_read_b64 v[128:129], v52 offset:3776
    ds_read_b64 v[130:131], v52 offset:3784
    ds_read_b128 v[228:231], v53 offset:704
    ds_read_b64 v[132:133], v52 offset:3264
    ds_read_b64 v[134:135], v52 offset:3272
    ds_read_b128 v[232:235], v53 offset:1216
    ds_read_b64 v[136:137], v52 offset:2752
    ds_read_b64 v[138:139], v52 offset:2760
    ds_read_b128 v[236:239], v53 offset:1728
    ds_read_b64 v[140:141], v52 offset:2240
    ds_read_b64 v[142:143], v52 offset:2248
    ds_read_b128 v[240:243], v53 offset:2240
    ds_read_b64 v[144:145], v52 offset:1728
    ds_read_b64 v[146:147], v52 offset:1736
    ds_read_b128 v[244:247], v53 offset:2752
    ds_read_b64 v[148:149], v52 offset:1216
    ds_read_b64 v[150:151], v52 offset:1224
    ds_read_b128 v[248:251], v53 offset:3264
    ds_read_b64 v[152:153], v52 offset:704
    ds_read_b64 v[154:155], v52 offset:712
    ds_read_b128 v[252:255], v53 offset:3776
    ds_read_b64 v[156:157], v52 offset:192
    ds_read_b64 v[158:159], v52 offset:200
    s_waitcnt lgkmcnt(15)
    s_waitcnt lgkmcnt(15)
    v_mfma_f32_16x16x32_f16 v[64:67], v[128:131], v[224:227], 0
    v_accvgpr_read_b32 v4, a201
    s_waitcnt lgkmcnt(15)
    v_mfma_f32_16x16x32_f16 v[68:71], v[128:131], v[228:231], 0
    v_accvgpr_read_b32 v5, a202
    s_waitcnt lgkmcnt(15)
    v_mfma_f32_16x16x32_f16 v[68:71], v[132:135], v[224:227], v[68:71]
    v_accvgpr_read_b32 v6, a203
    buffer_load_dwordx4 a[152:155], v1, s[16:19], s59 offen offset:2048 sc1
    v_mfma_f32_16x16x32_f16 v[72:75], v[132:135], v[228:231], 0
    v_accvgpr_read_b32 v7, a204
    s_waitcnt lgkmcnt(15)
    v_mfma_f32_16x16x32_f16 v[72:75], v[128:131], v[232:235], v[72:75]
    v_accvgpr_read_b32 v8, a205
    s_waitcnt lgkmcnt(15)
    v_mfma_f32_16x16x32_f16 v[72:75], v[136:139], v[224:227], v[72:75]
    s_lshl_b32 s55, s45, 1
    v_mfma_f32_16x16x32_f16 v[76:79], v[132:135], v[232:235], 0
    s_add_u32 s55, s55, s63
    buffer_load_dwordx4 a[156:159], v1, s[16:19], s59 offen offset:3072 sc1
    v_mfma_f32_16x16x32_f16 v[76:79], v[136:139], v[228:231], v[76:79]
    s_lshl_b32 s55, s55, 12
    v_mfma_f32_16x16x32_f16 v[80:83], v[136:139], v[232:235], 0
    ds_read_b128 v[192:195], v53 offset:128
    s_waitcnt lgkmcnt(15)
    v_mfma_f32_16x16x32_f16 v[76:79], v[128:131], v[236:239], v[76:79]
    ds_read_b64 v[160:161], v52 offset:3712
    s_lshl_b32 s57, s62, 11
    s_waitcnt lgkmcnt(14)
    v_mfma_f32_16x16x32_f16 v[76:79], v[140:143], v[224:227], v[76:79]
    ds_read_b64 v[162:163], v52 offset:3720
    s_add_u32 s59, s84, 40960
    buffer_load_dwordx4 a[160:163], v1, s[16:19], s59 offen offset:0 sc1
    v_mfma_f32_16x16x32_f16 v[80:83], v[132:135], v[236:239], v[80:83]
    ds_read_b128 v[196:199], v53 offset:640
    s_add_u32 s55, s55, s57
    v_mfma_f32_16x16x32_f16 v[80:83], v[140:143], v[228:231], v[80:83]
    ds_read_b64 v[164:165], v52 offset:3200
    v_mfma_f32_16x16x32_f16 v[84:87], v[136:139], v[236:239], 0
    ds_read_b64 v[166:167], v52 offset:3208
    s_add_u32 s64, s55, 2686976
    v_mfma_f32_16x16x32_f16 v[84:87], v[140:143], v[232:235], v[84:87]
    ds_read_b128 v[200:203], v53 offset:1152
    buffer_load_dwordx4 a[164:167], v1, s[16:19], s59 offen offset:1024 sc1
    v_mfma_f32_16x16x32_f16 v[88:91], v[140:143], v[236:239], 0
    ds_read_b64 v[168:169], v52 offset:2688
    s_lshl_b32 s56, s45, 5
    s_waitcnt lgkmcnt(15)
    v_mfma_f32_16x16x32_f16 v[80:83], v[128:131], v[240:243], v[80:83]
    ds_read_b64 v[170:171], v52 offset:2696
    s_waitcnt lgkmcnt(15)
    v_mfma_f32_16x16x32_f16 v[80:83], v[144:147], v[224:227], v[80:83]
    ds_read_b128 v[204:207], v53 offset:1664
    s_add_u32 s56, s56, s40
    v_mfma_f32_16x16x32_f16 v[84:87], v[132:135], v[240:243], v[84:87]
    ds_read_b64 v[172:173], v52 offset:2176
    buffer_load_dwordx4 a[168:171], v1, s[16:19], s59 offen offset:2048 sc1
    v_mfma_f32_16x16x32_f16 v[84:87], v[144:147], v[228:231], v[84:87]
    ds_read_b64 v[174:175], v52 offset:2184
    s_lshl_b32 s56, s56, 2
    v_mfma_f32_16x16x32_f16 v[88:91], v[136:139], v[240:243], v[88:91]
    ds_read_b128 v[208:211], v53 offset:2176
    v_mfma_f32_16x16x32_f16 v[88:91], v[144:147], v[232:235], v[88:91]
    ds_read_b64 v[176:177], v52 offset:1664
    s_add_u32 s85, s56, 14966784
    v_mfma_f32_16x16x32_f16 v[92:95], v[140:143], v[240:243], 0
    ds_read_b64 v[178:179], v52 offset:1672
    buffer_load_dwordx4 a[172:175], v1, s[16:19], s59 offen offset:3072 sc1
    v_mfma_f32_16x16x32_f16 v[92:95], v[144:147], v[236:239], v[92:95]
    ds_read_b128 v[212:215], v53 offset:2688
    v_accvgpr_read_b32 v118, a213
    s_waitcnt lgkmcnt(15)
    v_mfma_f32_16x16x32_f16 v[84:87], v[128:131], v[244:247], v[84:87]
    ds_read_b64 v[180:181], v52 offset:1152
    s_waitcnt lgkmcnt(15)
    v_mfma_f32_16x16x32_f16 v[84:87], v[148:151], v[224:227], v[84:87]
    ds_read_b64 v[182:183], v52 offset:1160
    v_accvgpr_read_b32 v119, a214
    v_mfma_f32_16x16x32_f16 v[88:91], v[132:135], v[244:247], v[88:91]
    ds_read_b128 v[216:219], v53 offset:3200
    s_add_u32 s59, s84, 45056
    buffer_load_dwordx4 a[176:179], v1, s[16:19], s59 offen offset:0 sc1
    v_mfma_f32_16x16x32_f16 v[88:91], v[148:151], v[228:231], v[88:91]
    ds_read_b64 v[184:185], v52 offset:640
    v_min_u32 v3, 53, v0
    v_mfma_f32_16x16x32_f16 v[92:95], v[136:139], v[244:247], v[92:95]
    ds_read_b64 v[186:187], v52 offset:648
    v_mfma_f32_16x16x32_f16 v[92:95], v[148:151], v[232:235], v[92:95]
    ds_read_b128 v[220:223], v53 offset:3712
    v_lshlrev_b32 v3, 7, v3
    s_waitcnt lgkmcnt(15)
    v_mfma_f32_16x16x32_f16 v[88:91], v[128:131], v[248:251], v[88:91]
    ds_read_b64 v[188:189], v52 offset:128
    buffer_load_dwordx4 a[180:183], v1, s[16:19], s59 offen offset:1024 sc1
    s_waitcnt lgkmcnt(15)
    v_mfma_f32_16x16x32_f16 v[88:91], v[152:155], v[224:227], v[88:91]
    ds_read_b64 v[190:191], v52 offset:136
    s_lshl_b32 s54, s83, 2
    v_mfma_f32_16x16x32_f16 v[92:95], v[132:135], v[248:251], v[92:95]
    s_add_u32 s54, s54, s40
    v_mfma_f32_16x16x32_f16 v[92:95], v[152:155], v[228:231], v[92:95]
    s_mul_i32 s54, s54, 6912
    s_mul_i32 s65, s82, 221184
    s_waitcnt lgkmcnt(15)
    v_mfma_f32_16x16x32_f16 v[92:95], v[128:131], v[252:255], v[92:95]
    s_add_u32 s65, s65, s54
    buffer_load_dwordx4 a[184:187], v1, s[16:19], s59 offen offset:2048 sc1
    s_waitcnt lgkmcnt(15)
    v_mfma_f32_16x16x32_f16 v[92:95], v[156:159], v[224:227], v[92:95]
    s_add_u32 s65, s65, 7536640
    s_waitcnt lgkmcnt(0)
    v_mfma_f32_16x16x32_f16 v[64:67], v[160:163], v[192:195], v[64:67]
    v_mfma_f32_16x16x32_f16 v[68:71], v[160:163], v[196:199], v[68:71]
    ds_read_b128 v[224:227], v53 offset:64
    v_mfma_f32_16x16x32_f16 v[68:71], v[164:167], v[192:195], v[68:71]
    ds_read_b64 v[128:129], v52 offset:3648
    buffer_load_dwordx4 a[188:191], v1, s[16:19], s59 offen offset:3072 sc1
    v_mfma_f32_16x16x32_f16 v[72:75], v[164:167], v[196:199], v[72:75]
    ds_read_b64 v[130:131], v52 offset:3656
    v_mfma_f32_16x16x32_f16 v[72:75], v[160:163], v[200:203], v[72:75]
    ds_read_b128 v[228:231], v53 offset:576
    v_mfma_f32_16x16x32_f16 v[72:75], v[168:171], v[192:195], v[72:75]
    ds_read_b64 v[132:133], v52 offset:3136
    v_mfma_f32_16x16x32_f16 v[76:79], v[164:167], v[200:203], v[76:79]
    ds_read_b64 v[134:135], v52 offset:3144
    s_add_u32 s59, s84, 49152
    buffer_load_dwordx4 a[192:195], v1, s[16:19], s59 offen offset:0 sc1
    v_mfma_f32_16x16x32_f16 v[76:79], v[168:171], v[196:199], v[76:79]
    ds_read_b128 v[232:235], v53 offset:1088
    v_mfma_f32_16x16x32_f16 v[80:83], v[168:171], v[200:203], v[80:83]
    ds_read_b64 v[136:137], v52 offset:2624
    v_mfma_f32_16x16x32_f16 v[76:79], v[160:163], v[204:207], v[76:79]
    ds_read_b64 v[138:139], v52 offset:2632
    v_mfma_f32_16x16x32_f16 v[76:79], v[172:175], v[192:195], v[76:79]
    ds_read_b128 v[236:239], v53 offset:1600
    buffer_load_dwordx4 a[196:199], v1, s[16:19], s59 offen offset:1024 sc1
    v_mfma_f32_16x16x32_f16 v[80:83], v[164:167], v[204:207], v[80:83]
    ds_read_b64 v[140:141], v52 offset:2112
    v_mfma_f32_16x16x32_f16 v[80:83], v[172:175], v[196:199], v[80:83]
    ds_read_b64 v[142:143], v52 offset:2120
    v_mfma_f32_16x16x32_f16 v[84:87], v[168:171], v[204:207], v[84:87]
    ds_read_b128 v[240:243], v53 offset:2112
    v_mfma_f32_16x16x32_f16 v[84:87], v[172:175], v[200:203], v[84:87]
    ds_read_b64 v[144:145], v52 offset:1600
    buffer_load_dwordx4 a[200:203], v1, s[16:19], s59 offen offset:2048 sc1
    v_mfma_f32_16x16x32_f16 v[88:91], v[172:175], v[204:207], v[88:91]
    ds_read_b64 v[146:147], v52 offset:1608
    v_mfma_f32_16x16x32_f16 v[80:83], v[160:163], v[208:211], v[80:83]
    ds_read_b128 v[244:247], v53 offset:2624
    v_mfma_f32_16x16x32_f16 v[80:83], v[176:179], v[192:195], v[80:83]
    ds_read_b64 v[148:149], v52 offset:1088
    v_mfma_f32_16x16x32_f16 v[84:87], v[164:167], v[208:211], v[84:87]
    ds_read_b64 v[150:151], v52 offset:1096
    buffer_load_dwordx4 a[204:207], v1, s[16:19], s59 offen offset:3072 sc1
    v_mfma_f32_16x16x32_f16 v[84:87], v[176:179], v[196:199], v[84:87]
    ds_read_b128 v[248:251], v53 offset:3136
    v_mfma_f32_16x16x32_f16 v[88:91], v[168:171], v[208:211], v[88:91]
    ds_read_b64 v[152:153], v52 offset:576
    v_mfma_f32_16x16x32_f16 v[88:91], v[176:179], v[200:203], v[88:91]
    ds_read_b64 v[154:155], v52 offset:584
    v_mfma_f32_16x16x32_f16 v[92:95], v[172:175], v[208:211], v[92:95]
    ds_read_b128 v[252:255], v53 offset:3648
    s_add_u32 s59, s84, 53248
    buffer_load_dwordx4 a[208:211], v1, s[16:19], s59 offen offset:0 sc1
    v_mfma_f32_16x16x32_f16 v[92:95], v[176:179], v[204:207], v[92:95]
    ds_read_b64 v[156:157], v52 offset:64
    v_mfma_f32_16x16x32_f16 v[84:87], v[160:163], v[212:215], v[84:87]
    ds_read_b64 v[158:159], v52 offset:72
    v_mfma_f32_16x16x32_f16 v[84:87], v[180:183], v[192:195], v[84:87]
    v_mfma_f32_16x16x32_f16 v[88:91], v[164:167], v[212:215], v[88:91]
    buffer_load_dwordx4 a[212:215], v1, s[16:19], s59 offen offset:1024 sc1
    v_mfma_f32_16x16x32_f16 v[88:91], v[180:183], v[196:199], v[88:91]
    v_mfma_f32_16x16x32_f16 v[92:95], v[168:171], v[212:215], v[92:95]
    v_mfma_f32_16x16x32_f16 v[92:95], v[180:183], v[200:203], v[92:95]
    v_mfma_f32_16x16x32_f16 v[88:91], v[160:163], v[216:219], v[88:91]
    buffer_load_dwordx4 a[216:219], v1, s[16:19], s59 offen offset:2048 sc1
    v_mfma_f32_16x16x32_f16 v[88:91], v[184:187], v[192:195], v[88:91]
    v_mfma_f32_16x16x32_f16 v[92:95], v[164:167], v[216:219], v[92:95]
    v_mfma_f32_16x16x32_f16 v[92:95], v[184:187], v[196:199], v[92:95]
    v_mfma_f32_16x16x32_f16 v[92:95], v[160:163], v[220:223], v[92:95]
    buffer_load_dwordx4 a[220:223], v1, s[16:19], s59 offen offset:3072 sc1
    v_mfma_f32_16x16x32_f16 v[92:95], v[188:191], v[192:195], v[92:95]
    s_waitcnt lgkmcnt(0)
    v_mfma_f32_16x16x32_f16 v[64:67], v[128:131], v[224:227], v[64:67]
    v_mfma_f32_16x16x32_f16 v[68:71], v[128:131], v[228:231], v[68:71]
    ds_read_b128 v[192:195], v53 offset:0
    v_mfma_f32_16x16x32_f16 v[68:71], v[132:135], v[224:227], v[68:71]
    ds_read_b64 v[160:161], v52 offset:3584
    s_add_u32 s59, s84, 57344
    buffer_load_dwordx4 a[224:227], v1, s[16:19], s59 offen offset:0 sc1
    v_mfma_f32_16x16x32_f16 v[72:75], v[132:135], v[228:231], v[72:75]
    ds_read_b64 v[162:163], v52 offset:3592
    v_mfma_f32_16x16x32_f16 v[72:75], v[128:131], v[232:235], v[72:75]
    ds_read_b128 v[196:199], v53 offset:512
    v_mfma_f32_16x16x32_f16 v[72:75], v[136:139], v[224:227], v[72:75]
    ds_read_b64 v[164:165], v52 offset:3072
    v_mfma_f32_16x16x32_f16 v[76:79], v[132:135], v[232:235], v[76:79]
    ds_read_b64 v[166:167], v52 offset:3080
    buffer_load_dwordx4 a[228:231], v1, s[16:19], s59 offen offset:1024 sc1
    v_mfma_f32_16x16x32_f16 v[76:79], v[136:139], v[228:231], v[76:79]
    ds_read_b128 v[200:203], v53 offset:1024
    v_mfma_f32_16x16x32_f16 v[80:83], v[136:139], v[232:235], v[80:83]
    ds_read_b64 v[168:169], v52 offset:2560
    v_mfma_f32_16x16x32_f16 v[76:79], v[128:131], v[236:239], v[76:79]
    ds_read_b64 v[170:171], v52 offset:2568
    v_mfma_f32_16x16x32_f16 v[76:79], v[140:143], v[224:227], v[76:79]
    ds_read_b128 v[204:207], v53 offset:1536
    buffer_load_dwordx4 a[232:235], v1, s[16:19], s59 offen offset:2048 sc1
    v_mfma_f32_16x16x32_f16 v[80:83], v[132:135], v[236:239], v[80:83]
    ds_read_b64 v[172:173], v52 offset:2048
    v_mfma_f32_16x16x32_f16 v[80:83], v[140:143], v[228:231], v[80:83]
    ds_read_b64 v[174:175], v52 offset:2056
    v_mfma_f32_16x16x32_f16 v[84:87], v[136:139], v[236:239], v[84:87]
    ds_read_b128 v[208:211], v53 offset:2048
    v_mfma_f32_16x16x32_f16 v[84:87], v[140:143], v[232:235], v[84:87]
    ds_read_b64 v[176:177], v52 offset:1536
    buffer_load_dword v122, v118, s[16:19], 0 offen sc1
    v_mfma_f32_16x16x32_f16 v[88:91], v[140:143], v[236:239], v[88:91]
    ds_read_b64 v[178:179], v52 offset:1544
    v_mfma_f32_16x16x32_f16 v[80:83], v[128:131], v[240:243], v[80:83]
    ds_read_b128 v[212:215], v53 offset:2560
    v_mfma_f32_16x16x32_f16 v[80:83], v[144:147], v[224:227], v[80:83]
    ds_read_b64 v[180:181], v52 offset:1024
    v_mfma_f32_16x16x32_f16 v[84:87], v[132:135], v[240:243], v[84:87]
    ds_read_b64 v[182:183], v52 offset:1032
    buffer_load_dwordx4 a[236:239], v1, s[16:19], s59 offen offset:3072 sc1
    v_mfma_f32_16x16x32_f16 v[84:87], v[144:147], v[228:231], v[84:87]
    ds_read_b128 v[216:219], v53 offset:3072
    v_mfma_f32_16x16x32_f16 v[88:91], v[136:139], v[240:243], v[88:91]
    ds_read_b64 v[184:185], v52 offset:512
    v_mfma_f32_16x16x32_f16 v[88:91], v[144:147], v[232:235], v[88:91]
    ds_read_b64 v[186:187], v52 offset:520
    v_mfma_f32_16x16x32_f16 v[92:95], v[140:143], v[240:243], v[92:95]
    ds_read_b128 v[220:223], v53 offset:3584
    s_add_u32 s59, s84, 61440
    buffer_load_dwordx4 a[240:243], v1, s[16:19], s59 offen offset:0 sc1
    v_mfma_f32_16x16x32_f16 v[92:95], v[144:147], v[236:239], v[92:95]
    ds_read_b64 v[188:189], v52 offset:0
    v_mfma_f32_16x16x32_f16 v[84:87], v[128:131], v[244:247], v[84:87]
    ds_read_b64 v[190:191], v52 offset:8
    v_mfma_f32_16x16x32_f16 v[84:87], v[148:151], v[224:227], v[84:87]
    v_mfma_f32_16x16x32_f16 v[88:91], v[132:135], v[244:247], v[88:91]
    buffer_load_dwordx4 a[244:247], v1, s[16:19], s59 offen offset:1024 sc1
    v_mfma_f32_16x16x32_f16 v[88:91], v[148:151], v[228:231], v[88:91]
    v_mfma_f32_16x16x32_f16 v[92:95], v[136:139], v[244:247], v[92:95]
    v_mfma_f32_16x16x32_f16 v[92:95], v[148:151], v[232:235], v[92:95]
    v_mfma_f32_16x16x32_f16 v[88:91], v[128:131], v[248:251], v[88:91]
    buffer_load_dwordx4 a[248:251], v1, s[16:19], s59 offen offset:2048 sc1
    v_mfma_f32_16x16x32_f16 v[88:91], v[152:155], v[224:227], v[88:91]
    v_mfma_f32_16x16x32_f16 v[92:95], v[132:135], v[248:251], v[92:95]
    v_mfma_f32_16x16x32_f16 v[92:95], v[152:155], v[228:231], v[92:95]
    v_mfma_f32_16x16x32_f16 v[92:95], v[128:131], v[252:255], v[92:95]
    buffer_load_dwordx4 a[252:255], v1, s[16:19], s59 offen offset:3072 sc1
    v_mfma_f32_16x16x32_f16 v[92:95], v[156:159], v[224:227], v[92:95]
    s_waitcnt vmcnt(5)
    v_cmp_ne_u32 vcc, v120, v122
    s_nop 0
    s_cmp_eq_u64 vcc, 0
    s_cselect_b32 s97, 1, 0
    s_cselect_b32 s54, 0, 2147418112
    s_waitcnt lgkmcnt(0)
    v_mfma_f32_16x16x32_f16 v[64:67], v[160:163], v[192:195], v[64:67]
    v_mfma_f32_16x16x32_f16 v[68:71], v[160:163], v[196:199], v[68:71]
    ds_read_b64 v[128:129], v6 offset:0
    v_mfma_f32_16x16x32_f16 v[68:71], v[164:167], v[192:195], v[68:71]
    ds_read_b64 v[130:131], v6 offset:512
    s_or_b32 s58, s66, s54
    buffer_load_dwordx4 v[16:19], v1, s[16:19], s58 offen offset:0 sc1
    v_mfma_f32_16x16x32_f16 v[72:75], v[164:167], v[196:199], v[72:75]
    ds_read_b64 v[132:133], v6 offset:1024
    v_mfma_f32_16x16x32_f16 v[72:75], v[160:163], v[200:203], v[72:75]
    ds_read_b64 v[134:135], v6 offset:1536
    v_mfma_f32_16x16x32_f16 v[72:75], v[168:171], v[192:195], v[72:75]
    v_mfma_f32_16x16x32_f16 v[76:79], v[164:167], v[200:203], v[76:79]
    buffer_load_dwordx4 v[20:23], v1, s[16:19], s58 offen offset:1024 sc1
    v_mfma_f32_16x16x32_f16 v[76:79], v[168:171], v[196:199], v[76:79]
    v_mfma_f32_16x16x32_f16 v[80:83], v[168:171], v[200:203], v[80:83]
    v_mfma_f32_16x16x32_f16 v[76:79], v[160:163], v[204:207], v[76:79]
    v_mfma_f32_16x16x32_f16 v[76:79], v[172:175], v[192:195], v[76:79]
    buffer_load_dwordx4 v[24:27], v1, s[16:19], s58 offen offset:2048 sc1
    v_mfma_f32_16x16x32_f16 v[80:83], v[164:167], v[204:207], v[80:83]
    s_waitcnt lgkmcnt(0)
    v_mfma_f32_16x16x32_f16 v[80:83], v[172:175], v[196:199], v[80:83]
    v_fma_mix_f32 v136, v128, v101, 0 op_sel:[0,0,0] op_sel_hi:[1,0,0]
    v_mfma_f32_16x16x32_f16 v[84:87], v[168:171], v[204:207], v[84:87]
    v_fma_mix_f32 v137, v128, v101, 0 op_sel:[1,0,0] op_sel_hi:[1,0,0]
    v_mfma_f32_16x16x32_f16 v[84:87], v[172:175], v[200:203], v[84:87]
    v_fma_mix_f32 v138, v129, v101, 0 op_sel:[0,0,0] op_sel_hi:[1,0,0]
    buffer_load_dwordx4 v[28:31], v1, s[16:19], s58 offen offset:3072 sc1
    v_mfma_f32_16x16x32_f16 v[88:91], v[172:175], v[204:207], v[88:91]
    v_fma_mix_f32 v139, v129, v101, 0 op_sel:[1,0,0] op_sel_hi:[1,0,0]
    v_mfma_f32_16x16x32_f16 v[80:83], v[160:163], v[208:211], v[80:83]
    v_fma_mix_f32 v140, v130, v101, 0 op_sel:[0,0,0] op_sel_hi:[1,0,0]
    v_mfma_f32_16x16x32_f16 v[80:83], v[176:179], v[192:195], v[80:83]
    v_fma_mix_f32 v141, v130, v101, 0 op_sel:[1,0,0] op_sel_hi:[1,0,0]
    v_mfma_f32_16x16x32_f16 v[84:87], v[164:167], v[208:211], v[84:87]
    v_fma_mix_f32 v142, v131, v101, 0 op_sel:[0,0,0] op_sel_hi:[1,0,0]
    s_or_b32 s58, s67, s54
    buffer_load_dwordx4 v[32:35], v1, s[16:19], s58 offen offset:0 sc1
    v_mfma_f32_16x16x32_f16 v[84:87], v[176:179], v[196:199], v[84:87]
    v_fma_mix_f32 v143, v131, v101, 0 op_sel:[1,0,0] op_sel_hi:[1,0,0]
    v_mfma_f32_16x16x32_f16 v[88:91], v[168:171], v[208:211], v[88:91]
    v_fma_mix_f32 v144, v132, v101, 0 op_sel:[0,0,0] op_sel_hi:[1,0,0]
    v_mfma_f32_16x16x32_f16 v[88:91], v[176:179], v[200:203], v[88:91]
    v_fma_mix_f32 v145, v132, v101, 0 op_sel:[1,0,0] op_sel_hi:[1,0,0]
    v_mfma_f32_16x16x32_f16 v[92:95], v[172:175], v[208:211], v[92:95]
    v_fma_mix_f32 v146, v133, v101, 0 op_sel:[0,0,0] op_sel_hi:[1,0,0]
    buffer_load_dwordx4 v[36:39], v1, s[16:19], s58 offen offset:1024 sc1
    v_mfma_f32_16x16x32_f16 v[92:95], v[176:179], v[204:207], v[92:95]
    v_fma_mix_f32 v147, v133, v101, 0 op_sel:[1,0,0] op_sel_hi:[1,0,0]
    v_mfma_f32_16x16x32_f16 v[84:87], v[160:163], v[212:215], v[84:87]
    v_fma_mix_f32 v148, v134, v101, 0 op_sel:[0,0,0] op_sel_hi:[1,0,0]
    v_mfma_f32_16x16x32_f16 v[84:87], v[180:183], v[192:195], v[84:87]
    v_fma_mix_f32 v149, v134, v101, 0 op_sel:[1,0,0] op_sel_hi:[1,0,0]
    v_mfma_f32_16x16x32_f16 v[88:91], v[164:167], v[212:215], v[88:91]
    v_fma_mix_f32 v150, v135, v101, 0 op_sel:[0,0,0] op_sel_hi:[1,0,0]
    buffer_load_dwordx4 v[40:43], v1, s[16:19], s58 offen offset:2048 sc1
    v_mfma_f32_16x16x32_f16 v[88:91], v[180:183], v[196:199], v[88:91]
    v_fma_mix_f32 v151, v135, v101, 0 op_sel:[1,0,0] op_sel_hi:[1,0,0]
    v_mfma_f32_16x16x32_f16 v[92:95], v[168:171], v[212:215], v[92:95]
    v_mfma_f32_16x16x32_f16 v[92:95], v[180:183], v[200:203], v[92:95]
    v_mfma_f32_16x16x32_f16 v[88:91], v[160:163], v[216:219], v[88:91]
    buffer_load_dwordx4 v[44:47], v1, s[16:19], s58 offen offset:3072 sc1
    v_mfma_f32_16x16x32_f16 v[88:91], v[184:187], v[192:195], v[88:91]
    v_mfma_f32_16x16x32_f16 v[92:95], v[164:167], v[216:219], v[92:95]
    v_mfma_f32_16x16x32_f16 v[92:95], v[184:187], v[196:199], v[92:95]
    v_mfma_f32_16x16x32_f16 v[92:95], v[160:163], v[220:223], v[92:95]
    s_or_b32 s58, s68, s54
    buffer_load_dwordx4 v[48:51], v1, s[16:19], s58 offen offset:0 sc1
    v_mfma_f32_16x16x32_f16 v[92:95], v[188:191], v[192:195], v[92:95]
    s_cmp_lg_u32 s62, 0
    s_cbranch_scc1 Lfin1_3
    s_nop 5
    ds_write_b128 v4, v[80:83] offset:0
    ds_write_b128 v4, v[84:87] offset:1024
    ds_write_b128 v4, v[88:91] offset:2048
    ds_write_b128 v4, v[92:95] offset:3072
    .p2align 3
    v_fma_f32 v136, v64, v100, v136
    v_fma_f32 v137, v65, v100, v137
    v_fma_f32 v138, v66, v100, v138
    v_fma_f32 v139, v67, v100, v139
    v_fma_f32 v140, v68, v100, v140
    v_fma_f32 v141, v69, v100, v141
    v_fma_f32 v142, v70, v100, v142
    v_fma_f32 v143, v71, v100, v143
    v_fma_f32 v144, v72, v100, v144
    v_fma_f32 v145, v73, v100, v145
    v_fma_f32 v146, v74, v100, v146
    v_fma_f32 v147, v75, v100, v147
    v_fma_f32 v148, v76, v100, v148
    v_fma_f32 v149, v77, v100, v149
    v_fma_f32 v150, v78, v100, v150
    v_fma_f32 v151, v79, v100, v151
    s_branch Lfind_4
Lfin1_3:
    s_nop 5
    ds_write_b128 v4, v[64:67] offset:0
    ds_write_b128 v4, v[68:71] offset:1024
    ds_write_b128 v4, v[72:75] offset:2048
    ds_write_b128 v4, v[76:79] offset:3072
    .p2align 3
    v_fma_f32 v136, v80, v100, v136
    v_fma_f32 v137, v81, v100, v137
    v_fma_f32 v138, v82, v100, v138
    v_fma_f32 v139, v83, v100, v139
    v_fma_f32 v140, v84, v100, v140
    v_fma_f32 v141, v85, v100, v141
    v_fma_f32 v142, v86, v100, v142
    v_fma_f32 v143, v87, v100, v143
    v_fma_f32 v144, v88, v100, v144
    v_fma_f32 v145, v89, v100, v145
    v_fma_f32 v146, v90, v100, v146
    v_fma_f32 v147, v91, v100, v147
    v_fma_f32 v148, v92, v100, v148
    v_fma_f32 v149, v93, v100, v149
    v_fma_f32 v150, v94, v100, v150
    v_fma_f32 v151, v95, v100, v151
Lfind_4:
    s_waitcnt lgkmcnt(0)
    s_barrier
    ds_read_b128 v[152:155], v5 offset:0
    ds_read_b128 v[156:159], v5 offset:1024
    ds_read_b128 v[160:163], v5 offset:2048
    ds_read_b128 v[164:167], v5 offset:3072
    buffer_load_dwordx4 v[52:55], v1, s[16:19], s58 offen offset:1024 sc1
    buffer_load_dwordx4 v[56:59], v1, s[16:19], s58 offen offset:2048 sc1
    s_waitcnt lgkmcnt(3)
    v_fmac_f32 v136, v152, v100
    v_fmac_f32 v137, v153, v100
    v_fmac_f32 v138, v154, v100
    v_fmac_f32 v139, v155, v100
    v_cvt_pk_bf16_f32 v128, v136, v137
    v_cvt_pk_bf16_f32 v129, v138, v139
    ds_write_b64 v7, v[128:129] offset:0
    buffer_load_dwordx4 v[60:63], v1, s[16:19], s58 offen offset:3072 sc1
    s_waitcnt lgkmcnt(3)
    v_fmac_f32 v140, v156, v100
    v_fmac_f32 v141, v157, v100
    v_fmac_f32 v142, v158, v100
    v_fmac_f32 v143, v159, v100
    v_cvt_pk_bf16_f32 v130, v140, v141
    v_cvt_pk_bf16_f32 v131, v142, v143
    ds_write_b64 v7, v[130:131] offset:512
    s_or_b32 s58, s69, s54
    buffer_load_dwordx4 v[104:107], v1, s[16:19], s58 offen offset:0 sc1
    s_waitcnt lgkmcnt(3)
    v_fmac_f32 v144, v160, v100
    v_fmac_f32 v145, v161, v100
    v_fmac_f32 v146, v162, v100
    v_fmac_f32 v147, v163, v100
    v_cvt_pk_bf16_f32 v132, v144, v145
    v_cvt_pk_bf16_f32 v133, v146, v147
    ds_write_b64 v7, v[132:133] offset:1024
    s_or_b32 s58, s69, s54
    s_cmp_lt_u32 s40, 2
    s_cselect_b32 s58, s58, 2147418112
    buffer_load_dwordx4 v[108:111], v1, s[16:19], s58 offen offset:1024 sc1
    s_waitcnt lgkmcnt(3)
    v_fmac_f32 v148, v164, v100
    v_fmac_f32 v149, v165, v100
    v_fmac_f32 v150, v166, v100
    v_fmac_f32 v151, v167, v100
    v_cvt_pk_bf16_f32 v134, v148, v149
    v_cvt_pk_bf16_f32 v135, v150, v151
    ds_write_b64 v7, v[134:135] offset:1536
    s_or_b32 s58, s70, s54
    buffer_load_dwordx4 v[112:115], v1, s[16:19], s58 offen offset:0 sc1
    s_waitcnt lgkmcnt(0)
    ds_read_b128 v[88:91], v8 offset:0
    ds_read_b128 v[92:95], v8 offset:1024
    s_waitcnt lgkmcnt(1)
    buffer_store_dwordx4 v[88:91], v1, s[16:19], s64 offen offset:0 sc1
    s_waitcnt lgkmcnt(0)
    buffer_store_dwordx4 v[92:95], v1, s[16:19], s64 offen offset:1024 sc1
    s_cmp_lg_u32 s97, 0
    s_cbranch_scc1 L_hready
    s_mov_b32 s61, 0x20000
Lpoll_5:
    buffer_load_dword v122, v118, s[16:19], 0 offen sc1
    s_waitcnt vmcnt(0)
    v_cmp_ne_u32 vcc, v120, v122
    s_cbranch_vccz Lpd_6
    s_sleep 8
    s_sub_u32 s61, s61, 1
    s_cbranch_scc0 Lpoll_5
Lpd_6:
    buffer_load_dwordx4 v[16:19], v1, s[16:19], s66 offen offset:0 sc1
    buffer_load_dwordx4 v[20:23], v1, s[16:19], s66 offen offset:1024 sc1
    buffer_load_dwordx4 v[24:27], v1, s[16:19], s66 offen offset:2048 sc1
    buffer_load_dwordx4 v[28:31], v1, s[16:19], s66 offen offset:3072 sc1
    buffer_load_dwordx4 v[32:35], v1, s[16:19], s67 offen offset:0 sc1
    buffer_load_dwordx4 v[36:39], v1, s[16:19], s67 offen offset:1024 sc1
    buffer_load_dwordx4 v[40:43], v1, s[16:19], s67 offen offset:2048 sc1
    buffer_load_dwordx4 v[44:47], v1, s[16:19], s67 offen offset:3072 sc1
    buffer_load_dwordx4 v[48:51], v1, s[16:19], s68 offen offset:0 sc1
    buffer_load_dwordx4 v[52:55], v1, s[16:19], s68 offen offset:1024 sc1
    buffer_load_dwordx4 v[56:59], v1, s[16:19], s68 offen offset:2048 sc1
    buffer_load_dwordx4 v[60:63], v1, s[16:19], s68 offen offset:3072 sc1
    buffer_load_dwordx4 v[104:107], v1, s[16:19], s69 offen offset:0 sc1
    s_cmp_lt_u32 s40, 2
    s_cselect_b32 s58, s69, 2147418112
    buffer_load_dwordx4 v[108:111], v1, s[16:19], s58 offen offset:1024 sc1
    buffer_load_dwordx4 v[112:115], v1, s[16:19], s70 offen offset:0 sc1
L_hready:
    s_waitcnt vmcnt(14)
    v_mfma_f32_16x16x32_bf16 v[64:67], a[0:3], v[16:19], 0
    s_add_u32 s59, s84, 65536
    buffer_load_dwordx4 v[232:235], v1, s[16:19], s59 offen offset:0 sc1
    v_mfma_f32_16x16x32_bf16 v[68:71], a[4:7], v[16:19], 0
    v_mfma_f32_16x16x32_bf16 v[72:75], a[8:11], v[16:19], 0
    v_mfma_f32_16x16x32_bf16 v[76:79], a[12:15], v[16:19], 0
    v_mfma_f32_16x16x32_bf16 v[80:83], a[16:19], v[16:19], 0
    s_add_u32 s59, s84, 65536
    s_cmp_lt_u32 s40, 2
    s_cselect_b32 s59, s59, 2147418112
    buffer_load_dwordx4 v[236:239], v1, s[16:19], s59 offen offset:1024 sc1
    s_waitcnt vmcnt(15)
    v_mfma_f32_16x16x32_bf16 v[64:67], a[20:23], v[20:23], v[64:67]
    v_mfma_f32_16x16x32_bf16 v[68:71], a[24:27], v[20:23], v[68:71]
    buffer_load_dwordx4 v[240:243], v1, s[16:19], s59 offen offset:2048 sc1
    v_mfma_f32_16x16x32_bf16 v[72:75], a[28:31], v[20:23], v[72:75]
    v_mfma_f32_16x16x32_bf16 v[76:79], a[32:35], v[20:23], v[76:79]
    v_mfma_f32_16x16x32_bf16 v[80:83], a[36:39], v[20:23], v[80:83]
    s_waitcnt vmcnt(15)
    v_mfma_f32_16x16x32_bf16 v[64:67], a[40:43], v[24:27], v[64:67]
    v_mfma_f32_16x16x32_bf16 v[68:71], a[44:47], v[24:27], v[68:71]
    v_mfma_f32_16x16x32_bf16 v[72:75], a[48:51], v[24:27], v[72:75]
    buffer_load_dwordx4 v[244:247], v1, s[16:19], s59 offen offset:3072 sc1
    v_mfma_f32_16x16x32_bf16 v[76:79], a[52:55], v[24:27], v[76:79]
    v_mfma_f32_16x16x32_bf16 v[80:83], a[56:59], v[24:27], v[80:83]
    s_waitcnt vmcnt(15)
    v_mfma_f32_16x16x32_bf16 v[64:67], a[60:63], v[28:31], v[64:67]
    v_mfma_f32_16x16x32_bf16 v[68:71], a[64:67], v[28:31], v[68:71]
    v_mfma_f32_16x16x32_bf16 v[72:75], a[68:71], v[28:31], v[72:75]
    v_mfma_f32_16x16x32_bf16 v[76:79], a[72:75], v[28:31], v[76:79]
    s_add_u32 s59, s84, 69632
    s_cmp_lt_u32 s40, 2
    s_cselect_b32 s59, s59, 2147418112
    buffer_load_dwordx4 v[248:251], v1, s[16:19], s59 offen offset:0 sc1
    v_mfma_f32_16x16x32_bf16 v[80:83], a[76:79], v[28:31], v[80:83]
    s_waitcnt vmcnt(15)
    v_mfma_f32_16x16x32_bf16 v[64:67], a[80:83], v[32:35], v[64:67]
    buffer_load_dwordx4 v[252:255], v1, s[16:19], s59 offen offset:1024 sc1
    v_mfma_f32_16x16x32_bf16 v[68:71], a[84:87], v[32:35], v[68:71]
    v_mfma_f32_16x16x32_bf16 v[72:75], a[88:91], v[32:35], v[72:75]
    v_mfma_f32_16x16x32_bf16 v[76:79], a[92:95], v[32:35], v[76:79]
    v_mfma_f32_16x16x32_bf16 v[80:83], a[96:99], v[32:35], v[80:83]
    buffer_load_dwordx4 v[128:131], v1, s[16:19], s70 offen offset:1024 sc1
    s_waitcnt vmcnt(16)
    v_mfma_f32_16x16x32_bf16 v[64:67], a[100:103], v[36:39], v[64:67]
    v_mfma_f32_16x16x32_bf16 v[68:71], a[104:107], v[36:39], v[68:71]
    buffer_load_dwordx4 v[132:135], v1, s[16:19], s70 offen offset:2048 sc1
    v_mfma_f32_16x16x32_bf16 v[72:75], a[108:111], v[36:39], v[72:75]
    v_mfma_f32_16x16x32_bf16 v[76:79], a[112:115], v[36:39], v[76:79]
    v_mfma_f32_16x16x32_bf16 v[80:83], a[116:119], v[36:39], v[80:83]
    s_waitcnt vmcnt(16)
    v_mfma_f32_16x16x32_bf16 v[64:67], a[120:123], v[40:43], v[64:67]
    v_mfma_f32_16x16x32_bf16 v[68:71], a[124:127], v[40:43], v[68:71]
    v_mfma_f32_16x16x32_bf16 v[72:75], a[128:131], v[40:43], v[72:75]
    buffer_load_dwordx4 v[136:139], v1, s[16:19], s70 offen offset:3072 sc1
    v_mfma_f32_16x16x32_bf16 v[76:79], a[132:135], v[40:43], v[76:79]
    v_mfma_f32_16x16x32_bf16 v[80:83], a[136:139], v[40:43], v[80:83]
    s_waitcnt vmcnt(16)
    v_mfma_f32_16x16x32_bf16 v[64:67], a[140:143], v[44:47], v[64:67]
    v_mfma_f32_16x16x32_bf16 v[68:71], a[144:147], v[44:47], v[68:71]
    s_waitcnt vmcnt(9)
    buffer_store_dword v120, v121, s[16:19], s85 offen sc1
    v_mfma_f32_16x16x32_bf16 v[72:75], a[148:151], v[44:47], v[72:75]
    v_mfma_f32_16x16x32_bf16 v[76:79], a[152:155], v[44:47], v[76:79]
    buffer_load_dwordx4 v[140:143], v1, s[16:19], s71 offen offset:0 sc1
    v_mfma_f32_16x16x32_bf16 v[80:83], a[156:159], v[44:47], v[80:83]
    s_waitcnt vmcnt(16)
    v_mfma_f32_16x16x32_bf16 v[64:67], a[160:163], v[48:51], v[64:67]
    buffer_load_dwordx4 v[144:147], v1, s[16:19], s71 offen offset:1024 sc1
    v_mfma_f32_16x16x32_bf16 v[68:71], a[164:167], v[48:51], v[68:71]
    v_mfma_f32_16x16x32_bf16 v[72:75], a[168:171], v[48:51], v[72:75]
    v_mfma_f32_16x16x32_bf16 v[76:79], a[172:175], v[48:51], v[76:79]
    v_mfma_f32_16x16x32_bf16 v[80:83], a[176:179], v[48:51], v[80:83]
    buffer_load_dwordx4 v[148:151], v1, s[16:19], s71 offen offset:2048 sc1
    s_waitcnt vmcnt(17)
    v_mfma_f32_16x16x32_bf16 v[64:67], a[180:183], v[52:55], v[64:67]
    v_mfma_f32_16x16x32_bf16 v[68:71], a[184:187], v[52:55], v[68:71]
    buffer_load_dwordx4 v[152:155], v1, s[16:19], s71 offen offset:3072 sc1
    v_mfma_f32_16x16x32_bf16 v[72:75], a[188:191], v[52:55], v[72:75]
    v_mfma_f32_16x16x32_bf16 v[76:79], a[192:195], v[52:55], v[76:79]
    v_mfma_f32_16x16x32_bf16 v[80:83], a[196:199], v[52:55], v[80:83]
    s_waitcnt vmcnt(17)
    v_mfma_f32_16x16x32_bf16 v[64:67], a[200:203], v[56:59], v[64:67]
    v_mfma_f32_16x16x32_bf16 v[68:71], a[204:207], v[56:59], v[68:71]
    v_mfma_f32_16x16x32_bf16 v[72:75], a[208:211], v[56:59], v[72:75]
    buffer_load_dwordx4 v[156:159], v1, s[16:19], s72 offen offset:0 sc1
    v_mfma_f32_16x16x32_bf16 v[76:79], a[212:215], v[56:59], v[76:79]
    v_mfma_f32_16x16x32_bf16 v[80:83], a[216:219], v[56:59], v[80:83]
    s_waitcnt vmcnt(17)
    v_mfma_f32_16x16x32_bf16 v[64:67], a[220:223], v[60:63], v[64:67]
    v_mfma_f32_16x16x32_bf16 v[68:71], a[224:227], v[60:63], v[68:71]
    v_mfma_f32_16x16x32_bf16 v[72:75], a[228:231], v[60:63], v[72:75]
    v_mfma_f32_16x16x32_bf16 v[76:79], a[232:235], v[60:63], v[76:79]
    buffer_load_dwordx4 v[160:163], v1, s[16:19], s72 offen offset:1024 sc1
    v_mfma_f32_16x16x32_bf16 v[80:83], a[236:239], v[60:63], v[80:83]
    s_waitcnt vmcnt(17)
    s_waitcnt vmcnt(14)
    v_mfma_f32_16x16x32_bf16 v[64:67], a[240:243], v[104:107], v[64:67]
    buffer_load_dwordx4 v[164:167], v1, s[16:19], s72 offen offset:2048 sc1
    v_mfma_f32_16x16x32_bf16 v[68:71], a[244:247], v[104:107], v[68:71]
    v_mfma_f32_16x16x32_bf16 v[72:75], a[248:251], v[104:107], v[72:75]
    v_mfma_f32_16x16x32_bf16 v[76:79], a[252:255], v[104:107], v[76:79]
    v_mfma_f32_16x16x32_bf16 v[80:83], v[232:235], v[104:107], v[80:83]
    buffer_load_dwordx4 v[168:171], v1, s[16:19], s72 offen offset:3072 sc1
    s_waitcnt vmcnt(11)
    v_mfma_f32_16x16x32_bf16 v[64:67], v[236:239], v[108:111], v[64:67]
    v_mfma_f32_16x16x32_bf16 v[68:71], v[240:243], v[108:111], v[68:71]
    buffer_load_dwordx4 v[172:175], v1, s[16:19], s73 offen offset:0 sc1
    v_mfma_f32_16x16x32_bf16 v[72:75], v[244:247], v[108:111], v[72:75]
    v_mfma_f32_16x16x32_bf16 v[76:79], v[248:251], v[108:111], v[76:79]
    v_mfma_f32_16x16x32_bf16 v[80:83], v[252:255], v[108:111], v[80:83]
    v_mfma_f32_16x16x32_bf16 v[84:87], a[0:3], v[112:115], 0
    v_mfma_f32_16x16x32_bf16 v[88:91], a[4:7], v[112:115], 0
    v_mfma_f32_16x16x32_bf16 v[92:95], a[8:11], v[112:115], 0
    s_cmp_lt_u32 s40, 2
    s_cselect_b32 s58, s73, 2147418112
    buffer_load_dwordx4 v[176:179], v1, s[16:19], s58 offen offset:1024 sc1
    v_mfma_f32_16x16x32_bf16 v[96:99], a[12:15], v[112:115], 0
    v_mfma_f32_16x16x32_bf16 v[100:103], a[16:19], v[112:115], 0
    s_waitcnt vmcnt(12)
    v_mfma_f32_16x16x32_bf16 v[84:87], a[20:23], v[128:131], v[84:87]
    ds_write_b128 v9, v[64:67] offset:0
    v_mfma_f32_16x16x32_bf16 v[88:91], a[24:27], v[128:131], v[88:91]
    ds_write_b128 v9, v[68:71] offset:1024
    v_mfma_f32_16x16x32_bf16 v[92:95], a[28:31], v[128:131], v[92:95]
    ds_write_b128 v9, v[72:75] offset:2048
    v_mfma_f32_16x16x32_bf16 v[96:99], a[32:35], v[128:131], v[96:99]
    ds_write_b128 v9, v[76:79] offset:3072
    buffer_load_dwordx4 v[180:183], v1, s[16:19], s74 offen offset:0 sc1
    v_mfma_f32_16x16x32_bf16 v[100:103], a[36:39], v[128:131], v[100:103]
    ds_write_b128 v9, v[80:83] offset:4096
    s_waitcnt vmcnt(12)
    v_mfma_f32_16x16x32_bf16 v[84:87], a[40:43], v[132:135], v[84:87]
    buffer_load_dwordx4 v[184:187], v1, s[16:19], s74 offen offset:1024 sc1
    v_mfma_f32_16x16x32_bf16 v[88:91], a[44:47], v[132:135], v[88:91]
    v_mfma_f32_16x16x32_bf16 v[92:95], a[48:51], v[132:135], v[92:95]
    v_mfma_f32_16x16x32_bf16 v[96:99], a[52:55], v[132:135], v[96:99]
    v_mfma_f32_16x16x32_bf16 v[100:103], a[56:59], v[132:135], v[100:103]
    buffer_load_dwordx4 v[188:191], v1, s[16:19], s74 offen offset:2048 sc1
    s_waitcnt vmcnt(13)
    v_mfma_f32_16x16x32_bf16 v[84:87], a[60:63], v[136:139], v[84:87]
    v_mfma_f32_16x16x32_bf16 v[88:91], a[64:67], v[136:139], v[88:91]
    buffer_load_dwordx4 v[192:195], v1, s[16:19], s74 offen offset:3072 sc1
    v_mfma_f32_16x16x32_bf16 v[92:95], a[68:71], v[136:139], v[92:95]
    v_mfma_f32_16x16x32_bf16 v[96:99], a[72:75], v[136:139], v[96:99]
    v_mfma_f32_16x16x32_bf16 v[100:103], a[76:79], v[136:139], v[100:103]
    s_waitcnt vmcnt(13)
    v_mfma_f32_16x16x32_bf16 v[84:87], a[80:83], v[140:143], v[84:87]
    v_mfma_f32_16x16x32_bf16 v[88:91], a[84:87], v[140:143], v[88:91]
    v_lshrrev_b32 v8, 1, v0
    v_mfma_f32_16x16x32_bf16 v[92:95], a[88:91], v[140:143], v[92:95]
    buffer_load_dwordx4 v[196:199], v1, s[16:19], s75 offen offset:0 sc1
    v_mfma_f32_16x16x32_bf16 v[96:99], a[92:95], v[140:143], v[96:99]
    v_lshlrev_b32 v8, 12, v8
    v_mfma_f32_16x16x32_bf16 v[100:103], a[96:99], v[140:143], v[100:103]
    v_and_b32 v2, 1, v0
    s_waitcnt vmcnt(13)
    v_mfma_f32_16x16x32_bf16 v[84:87], a[100:103], v[144:147], v[84:87]
    v_mfma_f32_16x16x32_bf16 v[88:91], a[104:107], v[144:147], v[88:91]
    v_lshl_add_u32 v8, v2, 4, v8
    v_mfma_f32_16x16x32_bf16 v[92:95], a[108:111], v[144:147], v[92:95]
    v_mfma_f32_16x16x32_bf16 v[96:99], a[112:115], v[144:147], v[96:99]
    buffer_load_dwordx4 v[200:203], v1, s[16:19], s75 offen offset:1024 sc1
    s_mul_i32 s55, s40, 15360
    v_mfma_f32_16x16x32_bf16 v[100:103], a[116:119], v[144:147], v[100:103]
    v_add_u32 v2, s55, v1
    s_waitcnt vmcnt(13)
    v_mfma_f32_16x16x32_bf16 v[84:87], a[120:123], v[148:151], v[84:87]
    buffer_load_dwordx4 v[204:207], v1, s[16:19], s75 offen offset:2048 sc1
    v_mfma_f32_16x16x32_bf16 v[88:91], a[124:127], v[148:151], v[88:91]
    s_mul_i32 s65, s40, 3072
    v_mfma_f32_16x16x32_bf16 v[92:95], a[128:131], v[148:151], v[92:95]
    v_mfma_f32_16x16x32_bf16 v[96:99], a[132:135], v[148:151], v[96:99]
    s_add_u32 s65, s65, 124416
    v_mfma_f32_16x16x32_bf16 v[100:103], a[136:139], v[148:151], v[100:103]
    buffer_load_dwordx4 v[208:211], v1, s[16:19], s75 offen offset:3072 sc1
    v_lshl_add_u32 v3, v0, 3, s65
    s_waitcnt vmcnt(14)
    v_mfma_f32_16x16x32_bf16 v[84:87], a[140:143], v[152:155], v[84:87]
    v_mfma_f32_16x16x32_bf16 v[88:91], a[144:147], v[152:155], v[88:91]
    buffer_load_dwordx4 v[212:215], v1, s[16:19], s76 offen offset:0 sc1
    v_and_b32 v4, 15, v0
    v_mfma_f32_16x16x32_bf16 v[92:95], a[148:151], v[152:155], v[92:95]
    v_mfma_f32_16x16x32_bf16 v[96:99], a[152:155], v[152:155], v[96:99]
    v_mul_u32_u24 v4, 160, v4
    v_mfma_f32_16x16x32_bf16 v[100:103], a[156:159], v[152:155], v[100:103]
    v_lshrrev_b32 v5, 4, v0
    s_waitcnt vmcnt(14)
    v_mfma_f32_16x16x32_bf16 v[84:87], a[160:163], v[156:159], v[84:87]
    v_mfma_f32_16x16x32_bf16 v[88:91], a[164:167], v[156:159], v[88:91]
    v_lshl_add_u32 v4, v5, 3, v4
    v_mfma_f32_16x16x32_bf16 v[92:95], a[168:171], v[156:159], v[92:95]
    buffer_load_dwordx4 v[216:219], v1, s[16:19], s76 offen offset:1024 sc1
    v_mfma_f32_16x16x32_bf16 v[96:99], a[172:175], v[156:159], v[96:99]
    v_add_u32 v4, s94, v4
    v_mfma_f32_16x16x32_bf16 v[100:103], a[176:179], v[156:159], v[100:103]
    v_add_u32 v5, s94, v1
    s_waitcnt vmcnt(14)
    v_mfma_f32_16x16x32_bf16 v[84:87], a[180:183], v[160:163], v[84:87]
    v_mfma_f32_16x16x32_bf16 v[88:91], a[184:187], v[160:163], v[88:91]
    v_mfma_f32_16x16x32_bf16 v[92:95], a[188:191], v[160:163], v[92:95]
    v_mfma_f32_16x16x32_bf16 v[96:99], a[192:195], v[160:163], v[96:99]
    buffer_load_dwordx4 v[220:223], v1, s[16:19], s76 offen offset:2048 sc1
    v_mfma_f32_16x16x32_bf16 v[100:103], a[196:199], v[160:163], v[100:103]
    s_waitcnt vmcnt(14)
    v_mfma_f32_16x16x32_bf16 v[84:87], a[200:203], v[164:167], v[84:87]
    buffer_load_dwordx4 v[224:227], v1, s[16:19], s76 offen offset:3072 sc1
    v_mfma_f32_16x16x32_bf16 v[88:91], a[204:207], v[164:167], v[88:91]
    v_mfma_f32_16x16x32_bf16 v[92:95], a[208:211], v[164:167], v[92:95]
    v_mfma_f32_16x16x32_bf16 v[96:99], a[212:215], v[164:167], v[96:99]
    v_mfma_f32_16x16x32_bf16 v[100:103], a[216:219], v[164:167], v[100:103]
    buffer_load_dwordx4 v[228:231], v1, s[16:19], s77 offen offset:0 sc1
    s_waitcnt vmcnt(15)
    v_mfma_f32_16x16x32_bf16 v[84:87], a[220:223], v[168:171], v[84:87]
    v_mfma_f32_16x16x32_bf16 v[88:91], a[224:227], v[168:171], v[88:91]
    s_cmp_lt_u32 s40, 2
    s_cselect_b32 s58, s77, 2147418112
    buffer_load_dwordx4 v[16:19], v1, s[16:19], s58 offen offset:1024 sc1
    v_mfma_f32_16x16x32_bf16 v[92:95], a[228:231], v[168:171], v[92:95]
    v_mfma_f32_16x16x32_bf16 v[96:99], a[232:235], v[168:171], v[96:99]
    v_mfma_f32_16x16x32_bf16 v[100:103], a[236:239], v[168:171], v[100:103]
    s_waitcnt vmcnt(15)
    v_mfma_f32_16x16x32_bf16 v[84:87], a[240:243], v[172:175], v[84:87]
    v_mfma_f32_16x16x32_bf16 v[88:91], a[244:247], v[172:175], v[88:91]
    v_mfma_f32_16x16x32_bf16 v[92:95], a[248:251], v[172:175], v[92:95]
    buffer_load_dwordx4 v[20:23], v1, s[16:19], s78 offen offset:0 sc1
    v_mfma_f32_16x16x32_bf16 v[96:99], a[252:255], v[172:175], v[96:99]
    v_mfma_f32_16x16x32_bf16 v[100:103], v[232:235], v[172:175], v[100:103]
    s_waitcnt vmcnt(15)
    v_mfma_f32_16x16x32_bf16 v[84:87], v[236:239], v[176:179], v[84:87]
    v_mfma_f32_16x16x32_bf16 v[88:91], v[240:243], v[176:179], v[88:91]
    v_mfma_f32_16x16x32_bf16 v[92:95], v[244:247], v[176:179], v[92:95]
    v_mfma_f32_16x16x32_bf16 v[96:99], v[248:251], v[176:179], v[96:99]
    buffer_load_dwordx4 v[24:27], v1, s[16:19], s78 offen offset:1024 sc1
    v_mfma_f32_16x16x32_bf16 v[100:103], v[252:255], v[176:179], v[100:103]
    s_waitcnt vmcnt(15)
    v_mfma_f32_16x16x32_bf16 v[64:67], a[0:3], v[180:183], 0
    buffer_load_dwordx4 v[28:31], v1, s[16:19], s78 offen offset:2048 sc1
    v_mfma_f32_16x16x32_bf16 v[68:71], a[4:7], v[180:183], 0
    v_mfma_f32_16x16x32_bf16 v[72:75], a[8:11], v[180:183], 0
    v_mfma_f32_16x16x32_bf16 v[76:79], a[12:15], v[180:183], 0
    v_mfma_f32_16x16x32_bf16 v[80:83], a[16:19], v[180:183], 0
    buffer_load_dwordx4 v[32:35], v1, s[16:19], s78 offen offset:3072 sc1
    s_waitcnt vmcnt(16)
    v_mfma_f32_16x16x32_bf16 v[64:67], a[20:23], v[184:187], v[64:67]
    ds_write_b128 v10, v[84:87] offset:0
    v_mfma_f32_16x16x32_bf16 v[68:71], a[24:27], v[184:187], v[68:71]
    ds_write_b128 v10, v[88:91] offset:1024
    buffer_load_dwordx4 v[36:39], v1, s[16:19], s79 offen offset:0 sc1
    v_mfma_f32_16x16x32_bf16 v[72:75], a[28:31], v[184:187], v[72:75]
    ds_write_b128 v10, v[92:95] offset:2048
    v_mfma_f32_16x16x32_bf16 v[76:79], a[32:35], v[184:187], v[76:79]
    ds_write_b128 v10, v[96:99] offset:3072
    v_mfma_f32_16x16x32_bf16 v[80:83], a[36:39], v[184:187], v[80:83]
    ds_write_b128 v10, v[100:103] offset:4096
    s_waitcnt vmcnt(16)
    v_mfma_f32_16x16x32_bf16 v[64:67], a[40:43], v[188:191], v[64:67]
    v_mfma_f32_16x16x32_bf16 v[68:71], a[44:47], v[188:191], v[68:71]
    s_mov_b32 s60, 0xffff0000
    v_mfma_f32_16x16x32_bf16 v[72:75], a[48:51], v[188:191], v[72:75]
    buffer_load_dwordx4 v[40:43], v1, s[16:19], s79 offen offset:1024 sc1
    s_mov_b32 s56, 0xbfb8aa3b
    v_mfma_f32_16x16x32_bf16 v[76:79], a[52:55], v[188:191], v[76:79]
    ds_read_b64 v[128:129], v4 offset:0
    v_mfma_f32_16x16x32_bf16 v[80:83], a[56:59], v[188:191], v[80:83]
    s_waitcnt vmcnt(16)
    v_mfma_f32_16x16x32_bf16 v[64:67], a[60:63], v[192:195], v[64:67]
    v_mfma_f32_16x16x32_bf16 v[68:71], a[64:67], v[192:195], v[68:71]
    ds_read_b64 v[130:131], v4 offset:32
    v_mfma_f32_16x16x32_bf16 v[72:75], a[68:71], v[192:195], v[72:75]
    ds_read_b64 v[132:133], v4 offset:64
    v_mfma_f32_16x16x32_bf16 v[76:79], a[72:75], v[192:195], v[76:79]
    buffer_load_dwordx4 v[44:47], v1, s[16:19], s79 offen offset:2048 sc1
    ds_read_b64 v[134:135], v4 offset:96
    v_mfma_f32_16x16x32_bf16 v[80:83], a[76:79], v[192:195], v[80:83]
    s_waitcnt vmcnt(16)
    v_mfma_f32_16x16x32_bf16 v[64:67], a[80:83], v[196:199], v[64:67]
    buffer_load_dwordx4 v[48:51], v1, s[16:19], s79 offen offset:3072 sc1
    v_mfma_f32_16x16x32_bf16 v[68:71], a[84:87], v[196:199], v[68:71]
    ds_read_b64 v[136:137], v4 offset:128
    v_mfma_f32_16x16x32_bf16 v[72:75], a[88:91], v[196:199], v[72:75]
    v_mfma_f32_16x16x32_bf16 v[76:79], a[92:95], v[196:199], v[76:79]
    v_mfma_f32_16x16x32_bf16 v[80:83], a[96:99], v[196:199], v[80:83]
    buffer_load_dwordx4 v[52:55], v1, s[16:19], s80 offen offset:0 sc1
    s_waitcnt vmcnt(17)
    v_mfma_f32_16x16x32_bf16 v[64:67], a[100:103], v[200:203], v[64:67]
    v_mfma_f32_16x16x32_bf16 v[68:71], a[104:107], v[200:203], v[68:71]
    buffer_load_dwordx4 v[56:59], v1, s[16:19], s80 offen offset:1024 sc1
    s_waitcnt lgkmcnt(0)
    v_mfma_f32_16x16x32_bf16 v[72:75], a[108:111], v[200:203], v[72:75]
    v_lshlrev_b32 v138, 16, v128
    v_mfma_f32_16x16x32_bf16 v[76:79], a[112:115], v[200:203], v[76:79]
    v_and_b32 v139, s60, v128
    v_mfma_f32_16x16x32_bf16 v[80:83], a[116:119], v[200:203], v[80:83]
    s_waitcnt vmcnt(17)
    v_mfma_f32_16x16x32_bf16 v[64:67], a[120:123], v[204:207], v[64:67]
    v_mfma_f32_16x16x32_bf16 v[68:71], a[124:127], v[204:207], v[68:71]
    v_lshlrev_b32 v140, 16, v129
    v_mfma_f32_16x16x32_bf16 v[72:75], a[128:131], v[204:207], v[72:75]
    buffer_load_dwordx4 v[60:63], v1, s[16:19], s80 offen offset:2048 sc1
    v_and_b32 v141, s60, v129
    v_mfma_f32_16x16x32_bf16 v[76:79], a[132:135], v[204:207], v[76:79]
    v_lshlrev_b32 v142, 16, v130
    v_mfma_f32_16x16x32_bf16 v[80:83], a[136:139], v[204:207], v[80:83]
    s_waitcnt vmcnt(17)
    v_mfma_f32_16x16x32_bf16 v[64:67], a[140:143], v[208:211], v[64:67]
    v_mfma_f32_16x16x32_bf16 v[68:71], a[144:147], v[208:211], v[68:71]
    v_and_b32 v143, s60, v130
    v_mfma_f32_16x16x32_bf16 v[72:75], a[148:151], v[208:211], v[72:75]
    v_lshlrev_b32 v144, 16, v131
    v_mfma_f32_16x16x32_bf16 v[76:79], a[152:155], v[208:211], v[76:79]
    buffer_load_dwordx4 v[104:107], v1, s[16:19], s80 offen offset:3072 sc1
    v_and_b32 v145, s60, v131
    v_mfma_f32_16x16x32_bf16 v[80:83], a[156:159], v[208:211], v[80:83]
    s_waitcnt vmcnt(17)
    v_mfma_f32_16x16x32_bf16 v[64:67], a[160:163], v[212:215], v[64:67]
    buffer_load_dwordx4 v[108:111], v1, s[16:19], s81 offen offset:0 sc1
    v_mfma_f32_16x16x32_bf16 v[68:71], a[164:167], v[212:215], v[68:71]
    v_lshlrev_b32 v146, 16, v132
    v_mfma_f32_16x16x32_bf16 v[72:75], a[168:171], v[212:215], v[72:75]
    v_and_b32 v147, s60, v132
    v_mfma_f32_16x16x32_bf16 v[76:79], a[172:175], v[212:215], v[76:79]
    v_lshlrev_b32 v148, 16, v133
    v_mfma_f32_16x16x32_bf16 v[80:83], a[176:179], v[212:215], v[80:83]
    s_cmp_lt_u32 s40, 2
    s_cselect_b32 s58, s81, 2147418112
    buffer_load_dwordx4 v[112:115], v1, s[16:19], s58 offen offset:1024 sc1
    s_waitcnt vmcnt(18)
    v_mfma_f32_16x16x32_bf16 v[64:67], a[180:183], v[216:219], v[64:67]
    v_mfma_f32_16x16x32_bf16 v[68:71], a[184:187], v[216:219], v[68:71]
    v_and_b32 v149, s60, v133
    v_mfma_f32_16x16x32_bf16 v[72:75], a[188:191], v[216:219], v[72:75]
    v_lshlrev_b32 v150, 16, v134
    v_mfma_f32_16x16x32_bf16 v[76:79], a[192:195], v[216:219], v[76:79]
    v_and_b32 v151, s60, v134
    v_mfma_f32_16x16x32_bf16 v[80:83], a[196:199], v[216:219], v[80:83]
    s_waitcnt vmcnt(17)
    v_mfma_f32_16x16x32_bf16 v[64:67], a[200:203], v[220:223], v[64:67]
    buffer_load_dwordx4 v[122:125], v119, s[16:19], 0 offen sc1
    v_mfma_f32_16x16x32_bf16 v[68:71], a[204:207], v[220:223], v[68:71]
    v_lshlrev_b32 v152, 16, v135
    v_mfma_f32_16x16x32_bf16 v[72:75], a[208:211], v[220:223], v[72:75]
    v_and_b32 v153, s60, v135
    v_mfma_f32_16x16x32_bf16 v[76:79], a[212:215], v[220:223], v[76:79]
    v_lshlrev_b32 v154, 16, v136
    v_mfma_f32_16x16x32_bf16 v[80:83], a[216:219], v[220:223], v[80:83]
    s_waitcnt vmcnt(17)
    v_mfma_f32_16x16x32_bf16 v[64:67], a[220:223], v[224:227], v[64:67]
    v_mfma_f32_16x16x32_bf16 v[68:71], a[224:227], v[224:227], v[68:71]
    v_and_b32 v155, s60, v136
    v_mfma_f32_16x16x32_bf16 v[72:75], a[228:231], v[224:227], v[72:75]
    v_lshlrev_b32 v156, 16, v137
    v_mfma_f32_16x16x32_bf16 v[76:79], a[232:235], v[224:227], v[76:79]
    v_and_b32 v157, s60, v137
    v_mfma_f32_16x16x32_bf16 v[80:83], a[236:239], v[224:227], v[80:83]
    s_waitcnt vmcnt(16)
    v_mfma_f32_16x16x32_bf16 v[64:67], a[240:243], v[228:231], v[64:67]
    v_mfma_f32_16x16x32_bf16 v[68:71], a[244:247], v[228:231], v[68:71]
    v_mfma_f32_16x16x32_bf16 v[72:75], a[248:251], v[228:231], v[72:75]
    v_mfma_f32_16x16x32_bf16 v[76:79], a[252:255], v[228:231], v[76:79]
    v_mfma_f32_16x16x32_bf16 v[80:83], v[232:235], v[228:231], v[80:83]
    s_waitcnt vmcnt(15)
    v_mfma_f32_16x16x32_bf16 v[64:67], v[236:239], v[16:19], v[64:67]
    v_mfma_f32_16x16x32_bf16 v[68:71], v[240:243], v[16:19], v[68:71]
    v_mfma_f32_16x16x32_bf16 v[72:75], v[244:247], v[16:19], v[72:75]
    v_mfma_f32_16x16x32_bf16 v[76:79], v[248:251], v[16:19], v[76:79]
    v_mfma_f32_16x16x32_bf16 v[80:83], v[252:255], v[16:19], v[80:83]
    s_waitcnt vmcnt(14)
    v_mfma_f32_16x16x32_bf16 v[84:87], a[0:3], v[20:23], 0
    v_mfma_f32_16x16x32_bf16 v[88:91], a[4:7], v[20:23], 0
    v_mfma_f32_16x16x32_bf16 v[92:95], a[8:11], v[20:23], 0
    v_mfma_f32_16x16x32_bf16 v[96:99], a[12:15], v[20:23], 0
    v_mfma_f32_16x16x32_bf16 v[100:103], a[16:19], v[20:23], 0
    s_waitcnt vmcnt(13)
    v_mfma_f32_16x16x32_bf16 v[84:87], a[20:23], v[24:27], v[84:87]
    ds_write_b128 v11, v[64:67] offset:0
    v_mfma_f32_16x16x32_bf16 v[88:91], a[24:27], v[24:27], v[88:91]
    ds_write_b128 v11, v[68:71] offset:1024
    v_mfma_f32_16x16x32_bf16 v[92:95], a[28:31], v[24:27], v[92:95]
    ds_write_b128 v11, v[72:75] offset:2048
    v_mfma_f32_16x16x32_bf16 v[96:99], a[32:35], v[24:27], v[96:99]
    ds_write_b128 v11, v[76:79] offset:3072
    v_mfma_f32_16x16x32_bf16 v[100:103], a[36:39], v[24:27], v[100:103]
    ds_write_b128 v11, v[80:83] offset:4096
    s_waitcnt vmcnt(12)
    v_mfma_f32_16x16x32_bf16 v[84:87], a[40:43], v[28:31], v[84:87]
    s_waitcnt vmcnt(0)
    v_xor_b32 v122, v120, v122
    v_xor_b32 v123, v120, v123
    v_mfma_f32_16x16x32_bf16 v[88:91], a[44:47], v[28:31], v[88:91]
    v_xor_b32 v124, v120, v124
    v_xor_b32 v125, v120, v125
    v_mfma_f32_16x16x32_bf16 v[92:95], a[48:51], v[28:31], v[92:95]
    v_or3_b32 v122, v122, v123, v124
    v_or_b32 v122, v122, v125
    v_mfma_f32_16x16x32_bf16 v[96:99], a[52:55], v[28:31], v[96:99]
    v_cmp_ne_u32 vcc, 0, v122
    s_cbranch_vccnz Lslow_7
Lback_8:
    v_mfma_f32_16x16x32_bf16 v[100:103], a[56:59], v[28:31], v[100:103]
    v_mfma_f32_16x16x32_bf16 v[84:87], a[60:63], v[32:35], v[84:87]
    s_mov_b32 m0, s65
    v_mfma_f32_16x16x32_bf16 v[88:91], a[64:67], v[32:35], v[88:91]
    buffer_load_dwordx4 v8, s[16:19], s95 offen sc1 lds
    s_add_u32 m0, s65, 1024
    v_mfma_f32_16x16x32_bf16 v[92:95], a[68:71], v[32:35], v[92:95]
    s_add_u32 s57, s95, 131072
    v_mfma_f32_16x16x32_bf16 v[96:99], a[72:75], v[32:35], v[96:99]
    buffer_load_dwordx4 v8, s[16:19], s57 offen sc1 lds
    s_add_u32 m0, s65, 2048
    v_mfma_f32_16x16x32_bf16 v[100:103], a[76:79], v[32:35], v[100:103]
    s_add_u32 s57, s95, 262144
    v_mov_b32 v7, 2147418112
    v_cmp_lt_u32 vcc, 31, v0
    s_waitcnt lgkmcnt(0)
    s_barrier
    v_mfma_f32_16x16x32_bf16 v[84:87], a[80:83], v[36:39], v[84:87]
    ds_read_b128 v[160:163], v2 offset:24576
    v_mfma_f32_16x16x32_bf16 v[88:91], a[84:87], v[36:39], v[88:91]
    v_cndmask_b32 v8, v8, v7, vcc
    ds_read_b128 v[164:167], v2 offset:25600
    v_mfma_f32_16x16x32_bf16 v[92:95], a[88:91], v[36:39], v[92:95]
    buffer_load_dwordx4 v8, s[16:19], s57 offen sc1 lds
    ds_read_b128 v[168:171], v2 offset:26624
    v_mfma_f32_16x16x32_bf16 v[96:99], a[92:95], v[36:39], v[96:99]
    ds_read_b128 v[172:175], v2 offset:27648
    v_mfma_f32_16x16x32_bf16 v[100:103], a[96:99], v[36:39], v[100:103]
    ds_read_b128 v[176:179], v2 offset:28672
    v_mfma_f32_16x16x32_bf16 v[84:87], a[100:103], v[40:43], v[84:87]
    ds_read_b128 v[180:183], v2 offset:29696
    v_mfma_f32_16x16x32_bf16 v[88:91], a[104:107], v[40:43], v[88:91]
    ds_read_b128 v[184:187], v2 offset:30720
    v_mfma_f32_16x16x32_bf16 v[92:95], a[108:111], v[40:43], v[92:95]
    ds_read_b128 v[188:191], v2 offset:31744
    v_mfma_f32_16x16x32_bf16 v[96:99], a[112:115], v[40:43], v[96:99]
    ds_read_b128 v[192:195], v2 offset:32768
    v_mfma_f32_16x16x32_bf16 v[100:103], a[116:119], v[40:43], v[100:103]
    ds_read_b128 v[196:199], v2 offset:33792
    v_mfma_f32_16x16x32_bf16 v[84:87], a[120:123], v[44:47], v[84:87]
    ds_read_b128 v[200:203], v2 offset:34816
    v_mfma_f32_16x16x32_bf16 v[88:91], a[124:127], v[44:47], v[88:91]
    ds_read_b128 v[204:207], v2 offset:35840
    v_mfma_f32_16x16x32_bf16 v[92:95], a[128:131], v[44:47], v[92:95]
    ds_read_b128 v[208:211], v2 offset:36864
    v_mfma_f32_16x16x32_bf16 v[96:99], a[132:135], v[44:47], v[96:99]
    ds_read_b128 v[212:215], v2 offset:37888
    v_mfma_f32_16x16x32_bf16 v[100:103], a[136:139], v[44:47], v[100:103]
    ds_read_b128 v[216:219], v2 offset:38912
    v_mfma_f32_16x16x32_bf16 v[84:87], a[140:143], v[48:51], v[84:87]
    s_waitcnt lgkmcnt(5)
    v_mfma_f32_16x16x32_bf16 v[88:91], a[144:147], v[48:51], v[88:91]
    v_pk_add_f32 v[160:161], v[160:161], v[180:181]
    v_mfma_f32_16x16x32_bf16 v[92:95], a[148:151], v[48:51], v[92:95]
    v_pk_add_f32 v[162:163], v[162:163], v[182:183]
    v_mfma_f32_16x16x32_bf16 v[96:99], a[152:155], v[48:51], v[96:99]
    v_pk_add_f32 v[164:165], v[164:165], v[184:185]
    v_mfma_f32_16x16x32_bf16 v[100:103], a[156:159], v[48:51], v[100:103]
    v_pk_add_f32 v[166:167], v[166:167], v[186:187]
    v_mfma_f32_16x16x32_bf16 v[84:87], a[160:163], v[52:55], v[84:87]
    v_pk_add_f32 v[168:169], v[168:169], v[188:189]
    v_mfma_f32_16x16x32_bf16 v[88:91], a[164:167], v[52:55], v[88:91]
    v_pk_add_f32 v[170:171], v[170:171], v[190:191]
    v_mfma_f32_16x16x32_bf16 v[92:95], a[168:171], v[52:55], v[92:95]
    v_pk_add_f32 v[172:173], v[172:173], v[192:193]
    v_mfma_f32_16x16x32_bf16 v[96:99], a[172:175], v[52:55], v[96:99]
    v_pk_add_f32 v[174:175], v[174:175], v[194:195]
    v_mfma_f32_16x16x32_bf16 v[100:103], a[176:179], v[52:55], v[100:103]
    v_pk_add_f32 v[176:177], v[176:177], v[196:197]
    v_mfma_f32_16x16x32_bf16 v[84:87], a[180:183], v[56:59], v[84:87]
    v_pk_add_f32 v[178:179], v[178:179], v[198:199]
    v_mfma_f32_16x16x32_bf16 v[88:91], a[184:187], v[56:59], v[88:91]
    s_waitcnt lgkmcnt(0)
    v_mfma_f32_16x16x32_bf16 v[92:95], a[188:191], v[56:59], v[92:95]
    v_pk_add_f32 v[160:161], v[160:161], v[200:201]
    v_mfma_f32_16x16x32_bf16 v[96:99], a[192:195], v[56:59], v[96:99]
    v_pk_add_f32 v[162:163], v[162:163], v[202:203]
    v_mfma_f32_16x16x32_bf16 v[100:103], a[196:199], v[56:59], v[100:103]
    v_pk_add_f32 v[164:165], v[164:165], v[204:205]
    v_mfma_f32_16x16x32_bf16 v[84:87], a[200:203], v[60:63], v[84:87]
    v_pk_add_f32 v[166:167], v[166:167], v[206:207]
    v_mfma_f32_16x16x32_bf16 v[88:91], a[204:207], v[60:63], v[88:91]
    v_pk_add_f32 v[168:169], v[168:169], v[208:209]
    v_mfma_f32_16x16x32_bf16 v[92:95], a[208:211], v[60:63], v[92:95]
    v_pk_add_f32 v[170:171], v[170:171], v[210:211]
    v_mfma_f32_16x16x32_bf16 v[96:99], a[212:215], v[60:63], v[96:99]
    v_pk_add_f32 v[172:173], v[172:173], v[212:213]
    v_mfma_f32_16x16x32_bf16 v[100:103], a[216:219], v[60:63], v[100:103]
    v_pk_add_f32 v[174:175], v[174:175], v[214:215]
    v_mfma_f32_16x16x32_bf16 v[84:87], a[220:223], v[104:107], v[84:87]
    v_pk_add_f32 v[176:177], v[176:177], v[216:217]
    v_mfma_f32_16x16x32_bf16 v[88:91], a[224:227], v[104:107], v[88:91]
    v_pk_add_f32 v[178:179], v[178:179], v[218:219]
    v_mfma_f32_16x16x32_bf16 v[92:95], a[228:231], v[104:107], v[92:95]
    v_mfma_f32_16x16x32_bf16 v[96:99], a[232:235], v[104:107], v[96:99]
    v_mfma_f32_16x16x32_bf16 v[100:103], a[236:239], v[104:107], v[100:103]
    v_mfma_f32_16x16x32_bf16 v[84:87], a[240:243], v[108:111], v[84:87]
    v_mfma_f32_16x16x32_bf16 v[88:91], a[244:247], v[108:111], v[88:91]
    v_mfma_f32_16x16x32_bf16 v[92:95], a[248:251], v[108:111], v[92:95]
    v_mfma_f32_16x16x32_bf16 v[96:99], a[252:255], v[108:111], v[96:99]
    v_mfma_f32_16x16x32_bf16 v[100:103], v[232:235], v[108:111], v[100:103]
    v_mfma_f32_16x16x32_bf16 v[84:87], v[236:239], v[112:115], v[84:87]
    v_mfma_f32_16x16x32_bf16 v[88:91], v[240:243], v[112:115], v[88:91]
    v_mfma_f32_16x16x32_bf16 v[92:95], v[244:247], v[112:115], v[92:95]
    v_mfma_f32_16x16x32_bf16 v[96:99], v[248:251], v[112:115], v[96:99]
    v_mfma_f32_16x16x32_bf16 v[100:103], v[252:255], v[112:115], v[100:103]
    s_mov_b32 s57, s56
    s_waitcnt vmcnt(0)
    ds_read_b64_tr_b16 v[220:221], v3 offset:0
    ds_read_b64_tr_b16 v[222:223], v3 offset:512
    ds_read_b64_tr_b16 v[224:225], v3 offset:1024
    ds_read_b64_tr_b16 v[226:227], v3 offset:1536
    ds_read_b64_tr_b16 v[228:229], v3 offset:2048
    s_nop 1
    .p2align 3
    v_pk_add_f32 v[84:85], v[84:85], v[160:161]
    v_pk_add_f32 v[86:87], v[86:87], v[162:163]
    v_pk_add_f32 v[88:89], v[88:89], v[164:165]
    v_pk_add_f32 v[90:91], v[90:91], v[166:167]
    v_pk_add_f32 v[92:93], v[92:93], v[168:169]
    v_pk_add_f32 v[94:95], v[94:95], v[170:171]
    v_pk_add_f32 v[96:97], v[96:97], v[172:173]
    v_pk_add_f32 v[98:99], v[98:99], v[174:175]
    v_pk_add_f32 v[100:101], v[100:101], v[176:177]
    v_pk_add_f32 v[102:103], v[102:103], v[178:179]
    v_pk_mul_f32 v[200:201], v[84:85], s[56:57]
    v_pk_mul_f32 v[202:203], v[86:87], s[56:57]
    v_pk_mul_f32 v[204:205], v[88:89], s[56:57]
    v_pk_mul_f32 v[206:207], v[90:91], s[56:57]
    v_pk_mul_f32 v[208:209], v[92:93], s[56:57]
    v_pk_mul_f32 v[210:211], v[94:95], s[56:57]
    v_pk_mul_f32 v[212:213], v[96:97], s[56:57]
    v_pk_mul_f32 v[214:215], v[98:99], s[56:57]
    v_pk_mul_f32 v[216:217], v[100:101], s[56:57]
    v_pk_mul_f32 v[218:219], v[102:103], s[56:57]
    v_exp_f32 v200, v200
    v_exp_f32 v201, v201
    v_exp_f32 v202, v202
    v_exp_f32 v203, v203
    v_exp_f32 v204, v204
    v_exp_f32 v205, v205
    v_exp_f32 v206, v206
    v_exp_f32 v207, v207
    v_exp_f32 v208, v208
    v_exp_f32 v209, v209
    v_exp_f32 v210, v210
    v_exp_f32 v211, v211
    v_exp_f32 v212, v212
    v_exp_f32 v213, v213
    v_exp_f32 v214, v214
    v_exp_f32 v215, v215
    v_exp_f32 v216, v216
    v_exp_f32 v217, v217
    v_exp_f32 v218, v218
    v_exp_f32 v219, v219
    s_waitcnt lgkmcnt(0)
    v_lshlrev_b32 v180, 16, v220
    v_and_b32 v181, s60, v220
    v_lshlrev_b32 v182, 16, v221
    v_and_b32 v183, s60, v221
    v_lshlrev_b32 v184, 16, v222
    v_and_b32 v185, s60, v222
    v_lshlrev_b32 v186, 16, v223
    v_and_b32 v187, s60, v223
    v_lshlrev_b32 v188, 16, v224
    v_and_b32 v189, s60, v224
    v_lshlrev_b32 v190, 16, v225
    v_and_b32 v191, s60, v225
    v_lshlrev_b32 v192, 16, v226
    v_and_b32 v193, s60, v226
    v_lshlrev_b32 v194, 16, v227
    v_and_b32 v195, s60, v227
    v_lshlrev_b32 v196, 16, v228
    v_and_b32 v197, s60, v228
    v_lshlrev_b32 v198, 16, v229
    v_and_b32 v199, s60, v229
    .p2align 3
    v_pk_mul_f32 v[84:85], v[84:85], v[180:181]
    v_pk_mul_f32 v[86:87], v[86:87], v[182:183]
    v_pk_mul_f32 v[88:89], v[88:89], v[184:185]
    v_pk_mul_f32 v[90:91], v[90:91], v[186:187]
    v_pk_mul_f32 v[92:93], v[92:93], v[188:189]
    v_pk_mul_f32 v[94:95], v[94:95], v[190:191]
    v_pk_mul_f32 v[96:97], v[96:97], v[192:193]
    v_pk_mul_f32 v[98:99], v[98:99], v[194:195]
    v_pk_mul_f32 v[100:101], v[100:101], v[196:197]
    v_pk_mul_f32 v[102:103], v[102:103], v[198:199]
    v_pk_add_f32 v[200:201], v[200:201], 1.0 op_sel_hi:[1,0]
    v_pk_add_f32 v[202:203], v[202:203], 1.0 op_sel_hi:[1,0]
    v_pk_add_f32 v[204:205], v[204:205], 1.0 op_sel_hi:[1,0]
    v_pk_add_f32 v[206:207], v[206:207], 1.0 op_sel_hi:[1,0]
    v_pk_add_f32 v[208:209], v[208:209], 1.0 op_sel_hi:[1,0]
    v_pk_add_f32 v[210:211], v[210:211], 1.0 op_sel_hi:[1,0]
    v_pk_add_f32 v[212:213], v[212:213], 1.0 op_sel_hi:[1,0]
    v_pk_add_f32 v[214:215], v[214:215], 1.0 op_sel_hi:[1,0]
    v_pk_add_f32 v[216:217], v[216:217], 1.0 op_sel_hi:[1,0]
    v_pk_add_f32 v[218:219], v[218:219], 1.0 op_sel_hi:[1,0]
    v_rcp_f32 v200, v200
    v_rcp_f32 v201, v201
    v_rcp_f32 v202, v202
    v_rcp_f32 v203, v203
    v_rcp_f32 v204, v204
    v_rcp_f32 v205, v205
    v_rcp_f32 v206, v206
    v_rcp_f32 v207, v207
    v_rcp_f32 v208, v208
    v_rcp_f32 v209, v209
    v_rcp_f32 v210, v210
    v_rcp_f32 v211, v211
    v_rcp_f32 v212, v212
    v_rcp_f32 v213, v213
    v_rcp_f32 v214, v214
    v_rcp_f32 v215, v215
    v_rcp_f32 v216, v216
    v_rcp_f32 v217, v217
    v_rcp_f32 v218, v218
    v_rcp_f32 v219, v219
    s_nop 0
    s_nop 0
    v_pk_fma_f32 v[84:85], v[84:85], v[200:201], v[138:139]
    v_pk_fma_f32 v[86:87], v[86:87], v[202:203], v[140:141]
    v_pk_fma_f32 v[88:89], v[88:89], v[204:205], v[142:143]
    v_pk_fma_f32 v[90:91], v[90:91], v[206:207], v[144:145]
    v_pk_fma_f32 v[92:93], v[92:93], v[208:209], v[146:147]
    v_pk_fma_f32 v[94:95], v[94:95], v[210:211], v[148:149]
    v_pk_fma_f32 v[96:97], v[96:97], v[212:213], v[150:151]
    v_pk_fma_f32 v[98:99], v[98:99], v[214:215], v[152:153]
    v_pk_fma_f32 v[100:101], v[100:101], v[216:217], v[154:155]
    v_pk_fma_f32 v[102:103], v[102:103], v[218:219], v[156:157]
    v_cvt_pk_bf16_f32 v160, v84, v85
    v_cvt_pk_bf16_f32 v161, v86, v87
    ds_write_b64 v4, v[160:161] offset:0
    v_cvt_pk_bf16_f32 v162, v88, v89
    v_cvt_pk_bf16_f32 v163, v90, v91
    ds_write_b64 v4, v[162:163] offset:32
    v_cvt_pk_bf16_f32 v164, v92, v93
    v_cvt_pk_bf16_f32 v165, v94, v95
    ds_write_b64 v4, v[164:165] offset:64
    v_cvt_pk_bf16_f32 v166, v96, v97
    v_cvt_pk_bf16_f32 v167, v98, v99
    ds_write_b64 v4, v[166:167] offset:96
    v_cvt_pk_bf16_f32 v168, v100, v101
    v_cvt_pk_bf16_f32 v169, v102, v103
    ds_write_b64 v4, v[168:169] offset:128
    s_waitcnt lgkmcnt(0)
    ds_read_b128 v[128:131], v5 offset:0
    ds_read_b128 v[132:135], v5 offset:1024
    ds_read_b128 v[136:139], v5 offset:2048
    s_waitcnt lgkmcnt(2)
    buffer_store_dwordx4 v[128:131], v12, s[20:23], s86 offen
    s_waitcnt lgkmcnt(1)
    buffer_store_dwordx4 v[132:135], v13, s[20:23], s86 offen
    s_waitcnt lgkmcnt(0)
    buffer_store_dwordx4 v[136:139], v15, s[20:23], s86 offen
L_end:
    s_endpgm
    .p2align 6
L_spare:
    v_lshrrev_b32 v4, 3, v0
    v_and_b32 v5, 7, v0
    s_add_u32 s68, s88, L_spare - L_pc + 256
    s_addc_u32 s69, s89, 0
    s_mov_b32 s70, 0x2000
    s_mov_b32 s71, 0x20000
    v_and_b32 v10, 15, v0
    s_lshl_b32 s55, s40, 11
    v_lshlrev_b32 v10, 7, v10
    buffer_load_dword v126, v10, s[68:71], s55 offen
    s_and_b32 s48, s2, 7
    s_mov_b64 s[24:25], s[64:65]
    s_mov_b64 s[20:21], s[66:67]
    v_lshlrev_b32 v1, 4, v0
    s_mov_b32 s18, 15007744
    s_mov_b32 s19, 0x20000
    v_mov_b32 v121, 2147418112
    v_writelane_b32 v121, 0, 0
    s_mov_b32 s22, 2621440
    s_mov_b32 s23, 0x20000
    s_mov_b32 s26, 2211840
    s_mov_b32 s27, 0x20000
    s_lshl_b32 s58, s48, 2
    s_and_b32 s56, s49, 3
    s_lshr_b32 s82, s48, 1
    s_and_b32 s56, s49, 7
    s_lshl3_add_u32 s82, s82, s56
    s_and_b32 s56, s48, 1
    s_lshr_b32 s83, s49, 3
    s_lshl2_add_u32 s83, s56, s83
    s_add_u32 s58, s58, s49
    s_sub_u32 s58, s58, 28
    s_lshl_b32 s59, s48, 3
    s_add_u32 s59, s59, s49
    s_sub_u32 s59, s59, 48
    s_cmp_lt_u32 s48, 6
    s_cselect_b32 s47, s58, s59
    s_mul_i32 s58, s42, 27
    s_add_u32 s58, s58, s43
    s_add_u32 s59, s47, 216
    s_cmp_lg_u32 s44, 0
    s_cselect_b32 s45, s58, s59
    s_cmp_lt_u32 s47, 24
    s_cselect_b32 s46, 3, 2
    s_and_b32 s62, s40, 1
    s_lshr_b32 s63, s40, 1
    v_lshlrev_b32 v10, 21, v0
    v_mov_b32 v118, v1
    v_mov_b32 v119, v1
    v_mul_u32_u24 v54, 3456, v4
    v_lshl_add_u32 v54, v5, 4, v54
    s_lshl_b32 s64, s42, 1
    s_add_u32 s64, s64, s62
    s_mul_i32 s64, s64, 138240
    s_lshl_b32 s55, s43, 7
    s_add_u32 s64, s64, s55
    s_mov_b32 s98, 2211840
    s_mov_b32 s99, 0x20000
    s_cmp_eq_u32 s63, 0
    s_cselect_b32 s96, s8, s12
    s_cselect_b32 s97, s9, s13
    s_lshl_b32 s55, s49, 2
    s_add_u32 s55, s55, s40
    s_mul_i32 s55, s55, 768
    s_add_u32 s55, s55, 8448
    v_min_u32 v11, 5, v0
    v_lshlrev_b32 v11, 7, v11
    buffer_load_dword v120, v121, s[16:19], 0 offen sc1
    buffer_load_dword v124, v11, s[88:91], s55 offen
    s_add_u32 s56, s45, 0
    s_min_u32 s56, s56, 319
    s_lshl_b32 s55, s56, 1
    s_add_u32 s55, s55, s63
    s_lshl_b32 s55, s55, 8
    v_lshl_add_u32 v12, v0, 2, s55
    s_lshl_b32 s55, s56, 2
    v_mov_b32 v13, s55
    global_load_dword a160, v12, s[28:29] nt
    global_load_dword a161, v12, s[30:31] nt
    global_load_dword a162, v12, s[32:33] nt
    global_load_dword a163, v12, s[34:35] nt
    global_load_dword a164, v13, s[36:37]
    global_load_dword a165, v13, s[38:39]
    s_add_u32 s56, s45, 40
    s_min_u32 s56, s56, 319
    s_lshl_b32 s55, s56, 1
    s_add_u32 s55, s55, s63
    s_lshl_b32 s55, s55, 8
    v_lshl_add_u32 v12, v0, 2, s55
    s_lshl_b32 s55, s56, 2
    v_mov_b32 v13, s55
    global_load_dword a168, v12, s[28:29] nt
    global_load_dword a169, v12, s[30:31] nt
    global_load_dword a170, v12, s[32:33] nt
    global_load_dword a171, v12, s[34:35] nt
    global_load_dword a172, v13, s[36:37]
    global_load_dword a173, v13, s[38:39]
    s_add_u32 s56, s45, 80
    s_min_u32 s56, s56, 319
    s_lshl_b32 s55, s56, 1
    s_add_u32 s55, s55, s63
    s_lshl_b32 s55, s55, 8
    v_lshl_add_u32 v12, v0, 2, s55
    s_lshl_b32 s55, s56, 2
    v_mov_b32 v13, s55
    global_load_dword a176, v12, s[28:29] nt
    global_load_dword a177, v12, s[30:31] nt
    global_load_dword a178, v12, s[32:33] nt
    global_load_dword a179, v12, s[34:35] nt
    global_load_dword a180, v13, s[36:37]
    global_load_dword a181, v13, s[38:39]
    s_mul_i32 s58, s40, 12288
    s_add_u32 s58, s58, L_tab - L_pc + 0
    buffer_load_dwordx4 a[192:195], v1, s[88:91], s58 offen offset:0
    buffer_load_dwordx4 a[196:199], v1, s[88:91], s58 offen offset:1024
    buffer_load_dwordx4 a[200:203], v1, s[88:91], s58 offen offset:2048
    buffer_load_dwordx4 a[204:207], v1, s[88:91], s58 offen offset:3072
    s_mul_i32 s58, s40, 12288
    s_add_u32 s58, s58, L_tab - L_pc + 4096
    buffer_load_dwordx4 a[208:211], v1, s[88:91], s58 offen offset:0
    buffer_load_dwordx4 a[212:215], v1, s[88:91], s58 offen offset:1024
    buffer_load_dwordx4 a[232:235], v1, s[88:91], s58 offen offset:2048
    buffer_load_dwordx4 a[236:239], v1, s[88:91], s58 offen offset:3072
    s_mul_i32 s58, s40, 12288
    s_add_u32 s58, s58, L_tab - L_pc + 8192
    buffer_load_dwordx4 a[240:243], v1, s[88:91], s58 offen offset:0
    buffer_load_dwordx4 a[244:247], v1, s[88:91], s58 offen offset:1024
    buffer_load_dwordx4 a[248:251], v1, s[88:91], s58 offen offset:2048
    buffer_load_dwordx4 a[252:255], v1, s[88:91], s58 offen offset:3072
    s_mul_i32 s3, s63, 2624
    s_add_u32 s3, s3, 147460
    v_lshrrev_b32 v4, 4, v0
    s_lshl_b32 s1, s62, 2
    v_add_u32 v4, s1, v4
    v_and_b32 v5, 15, v0
    v_cmp_eq_u32 s[54:55], 2, v4
    v_cmp_eq_u32 s[56:57], 3, v4
    v_cmp_eq_u32 s[58:59], 4, v4
    v_cmp_lt_u32 vcc, 4, v4
    v_mov_b32 v6, 8
    v_cndmask_b32 v6, v6, 4, s[54:55]
    v_cndmask_b32 v6, v6, 2, s[56:57]
    v_cndmask_b32 v6, v6, 1, s[58:59]
    v_cndmask_b32 v6, v6, 0, vcc
    v_mul_u32_u24 v7, v6, v5
    v_lshlrev_b32 v8, 4, v6
    v_lshl_add_u32 v9, v4, 2, 0
    v_mov_b32 v10, 256
    v_cndmask_b32 v9, v9, v10, s[54:55]
    v_mov_b32 v10, 384
    v_cndmask_b32 v9, v9, v10, s[56:57]
    v_mov_b32 v10, 512
    v_cndmask_b32 v9, v9, v10, s[58:59]
    v_mov_b32 v10, 645
    v_cndmask_b32 v9, v9, v10, vcc
    v_add_u32 v9, v9, v7
    v_add_u32 v11, v9, v8
    v_lshl_add_u32 v6, v4, 4, v5
    v_mov_b32 v10, 80
    v_cmp_eq_u32 s[60:61], v10, v6
    v_mov_b32 v10, 640
    s_nop 0
    v_cndmask_b32 v9, v9, v10, s[60:61]
    v_lshl_add_u32 v9, v9, 2, s3
    v_accvgpr_write_b32 a224, v9
    v_lshl_add_u32 v11, v11, 2, s3
    v_accvgpr_write_b32 a228, v11
    v_lshl_add_u32 v9, v4, 2, 1
    v_mov_b32 v10, 257
    v_cndmask_b32 v9, v9, v10, s[54:55]
    v_mov_b32 v10, 385
    v_cndmask_b32 v9, v9, v10, s[56:57]
    v_mov_b32 v10, 544
    v_cndmask_b32 v9, v9, v10, s[58:59]
    v_mov_b32 v10, 645
    v_cndmask_b32 v9, v9, v10, vcc
    v_add_u32 v9, v9, v7
    v_add_u32 v11, v9, v8
    v_lshl_add_u32 v9, v9, 2, s3
    v_accvgpr_write_b32 a225, v9
    v_lshl_add_u32 v11, v11, 2, s3
    v_accvgpr_write_b32 a229, v11
    v_lshl_add_u32 v9, v4, 2, 2
    v_mov_b32 v10, 258
    v_cndmask_b32 v9, v9, v10, s[54:55]
    v_mov_b32 v10, 448
    v_cndmask_b32 v9, v9, v10, s[56:57]
    v_mov_b32 v10, 576
    v_cndmask_b32 v9, v9, v10, s[58:59]
    v_mov_b32 v10, 645
    v_cndmask_b32 v9, v9, v10, vcc
    v_add_u32 v9, v9, v7
    v_add_u32 v11, v9, v8
    v_lshl_add_u32 v9, v9, 2, s3
    v_accvgpr_write_b32 a226, v9
    v_lshl_add_u32 v11, v11, 2, s3
    v_accvgpr_write_b32 a230, v11
    v_lshl_add_u32 v9, v4, 2, 3
    v_mov_b32 v10, 259
    v_cndmask_b32 v9, v9, v10, s[54:55]
    v_mov_b32 v10, 449
    v_cndmask_b32 v9, v9, v10, s[56:57]
    v_mov_b32 v10, 608
    v_cndmask_b32 v9, v9, v10, s[58:59]
    v_mov_b32 v10, 645
    v_cndmask_b32 v9, v9, v10, vcc
    v_add_u32 v9, v9, v7
    v_add_u32 v11, v9, v8
    v_lshl_add_u32 v9, v9, 2, s3
    v_accvgpr_write_b32 a227, v9
    v_lshl_add_u32 v11, v11, 2, s3
    v_accvgpr_write_b32 a231, v11
    s_mul_i32 s0, s40, 14
    s_cmp_eq_u32 s40, 3
    s_cselect_b32 s1, 1, 0
    s_sub_u32 s0, s0, s1
    s_mul_i32 s1, s83, 54
    s_add_u32 s1, s0, s1
    s_mul_i32 s1, s1, 5120
    s_add_u32 s84, s1, 5308416
    s_add_u32 s1, s40, 1
    s_and_b32 s1, s1, 3
    s_lshl_b32 s3, s82, 2
    s_add_u32 s1, s1, s3
    s_mul_i32 s1, s1, 54
    s_add_u32 s1, s1, s0
    s_lshl_b32 s1, s1, 10
    s_add_u32 s66, s1, 7536640
    s_add_u32 s67, s66, 4096
    s_add_u32 s68, s66, 8192
    s_add_u32 s69, s66, 12288
    s_add_u32 s1, s40, 2
    s_and_b32 s1, s1, 3
    s_lshl_b32 s3, s82, 2
    s_add_u32 s1, s1, s3
    s_mul_i32 s1, s1, 54
    s_add_u32 s1, s1, s0
    s_lshl_b32 s1, s1, 10
    s_add_u32 s70, s1, 7536640
    s_add_u32 s71, s70, 4096
    s_add_u32 s72, s70, 8192
    s_add_u32 s73, s70, 12288
    s_add_u32 s1, s40, 3
    s_and_b32 s1, s1, 3
    s_lshl_b32 s3, s82, 2
    s_add_u32 s1, s1, s3
    s_mul_i32 s1, s1, 54
    s_add_u32 s1, s1, s0
    s_lshl_b32 s1, s1, 10
    s_add_u32 s74, s1, 7536640
    s_add_u32 s75, s74, 4096
    s_add_u32 s76, s74, 8192
    s_add_u32 s77, s74, 12288
    s_add_u32 s1, s40, 4
    s_and_b32 s1, s1, 3
    s_lshl_b32 s3, s82, 2
    s_add_u32 s1, s1, s3
    s_mul_i32 s1, s1, 54
    s_add_u32 s1, s1, s0
    s_lshl_b32 s1, s1, 10
    s_add_u32 s78, s1, 7536640
    s_add_u32 s79, s78, 4096
    s_add_u32 s80, s78, 8192
    s_add_u32 s81, s78, 12288
    s_lshl_b32 s86, s82, 2
    s_add_u32 s86, s86, s40
    s_mul_i32 s86, s86, 20480
    s_mul_i32 s0, s83, 160
    s_add_u32 s86, s86, s0
    s_mul_i32 s94, s40, 3072
    s_add_u32 s94, s94, 112128
    s_mul_i32 s95, s83, 80
    s_lshl_b32 s95, s95, 12
    s_lshl_b32 s0, s82, 2
    s_add_u32 s0, s0, s40
    s_lshl_b32 s0, s0, 5
    s_add_u32 s95, s95, s0
    s_add_u32 s95, s95, 2686976
    s_waitcnt vmcnt(0)
    s_lshl_b32 s0, s82, 12
    s_add_u32 s0, s0, 14835712
    v_min_u32 v2, 26, v0
    v_lshl_add_u32 v2, v2, 7, s0
    v_accvgpr_write_b32 a213, v2
    s_mul_i32 s0, s83, 5120
    s_add_u32 s0, s0, 14966784
    v_min_u32 v2, 39, v0
    v_lshl_add_u32 v2, v2, 7, s0
    v_accvgpr_write_b32 a214, v2
    s_mul_i32 s0, s63, 28832
    s_add_u32 s0, s0, 0
    v_lshl_add_u32 v2, v0, 3, s0
    v_accvgpr_write_b32 a192, v2
    v_and_b32 v12, 15, v0
    v_lshrrev_b32 v13, 4, v0
    v_mul_u32_u24 v2, 544, v12
    v_lshl_add_u32 v2, v13, 4, v2
    v_add_u32 v3, s0, v2
    v_accvgpr_write_b32 a194, v3
    s_mul_i32 s1, s62, 8704
    v_add_u32 v3, s1, v3
    v_accvgpr_write_b32 a193, v3
    s_mul_i32 s3, s63, 2624
    s_add_u32 s3, s3, 147456
    v_mov_b32 v2, s3
    v_accvgpr_write_b32 a198, v2
    v_lshlrev_b32 v140, 16, v232
    v_and_b32 v141, 0xffff0000, v232
    v_lshlrev_b32 v142, 16, v233
    v_and_b32 v143, 0xffff0000, v233
    v_lshlrev_b32 v144, 16, v234
    v_and_b32 v145, 0xffff0000, v234
    v_lshlrev_b32 v146, 16, v235
    v_and_b32 v147, 0xffff0000, v235
    v_lshlrev_b32 v148, 16, v236
    v_and_b32 v149, 0xffff0000, v236
    v_lshlrev_b32 v150, 16, v237
    v_and_b32 v151, 0xffff0000, v237
    v_lshlrev_b32 v152, 16, v238
    v_and_b32 v153, 0xffff0000, v238
    v_lshlrev_b32 v154, 16, v239
    v_and_b32 v155, 0xffff0000, v239
    v_lshlrev_b32 v156, 16, v240
    v_and_b32 v157, 0xffff0000, v240
    v_lshlrev_b32 v158, 16, v241
    v_and_b32 v159, 0xffff0000, v241
    v_pk_add_f32 v[160:161], v[140:141], v[142:143]
    v_pk_add_f32 v[162:163], v[144:145], v[146:147]
    v_pk_add_f32 v[160:161], v[160:161], v[148:149]
    v_pk_add_f32 v[162:163], v[162:163], v[150:151]
    v_pk_add_f32 v[160:161], v[160:161], v[152:153]
    v_pk_add_f32 v[162:163], v[162:163], v[154:155]
    v_pk_add_f32 v[160:161], v[160:161], v[156:157]
    v_pk_add_f32 v[162:163], v[162:163], v[158:159]
    v_pk_add_f32 v[160:161], v[160:161], v[162:163]
    v_add_f32 v160, v160, v161
    s_nop 1
    v_add_f32 v160, v160, v160 quad_perm:[1,0,3,2]
    s_nop 1
    v_add_f32 v160, v160, v160 quad_perm:[2,3,0,1]
    s_nop 1
    v_add_f32 v160, v160, v160 row_half_mirror
    s_nop 1
    v_add_f32 v160, v160, v160 row_mirror
    v_mov_b32 v161, v160
    s_nop 1
    v_permlane16_swap_b32 v160, v161
    s_nop 0
    v_add_f32 v160, v160, v161
    v_mul_f32 v160, 0x3acccccd, v160
    v_pk_add_f32 v[164:165], v[140:141], v[160:161] op_sel_hi:[1,0] neg_lo:[0,1] neg_hi:[0,1]
    v_pk_add_f32 v[166:167], v[142:143], v[160:161] op_sel_hi:[1,0] neg_lo:[0,1] neg_hi:[0,1]
    v_pk_add_f32 v[168:169], v[144:145], v[160:161] op_sel_hi:[1,0] neg_lo:[0,1] neg_hi:[0,1]
    v_pk_add_f32 v[170:171], v[146:147], v[160:161] op_sel_hi:[1,0] neg_lo:[0,1] neg_hi:[0,1]
    v_pk_add_f32 v[172:173], v[148:149], v[160:161] op_sel_hi:[1,0] neg_lo:[0,1] neg_hi:[0,1]
    v_pk_add_f32 v[174:175], v[150:151], v[160:161] op_sel_hi:[1,0] neg_lo:[0,1] neg_hi:[0,1]
    v_pk_add_f32 v[176:177], v[152:153], v[160:161] op_sel_hi:[1,0] neg_lo:[0,1] neg_hi:[0,1]
    v_pk_add_f32 v[178:179], v[154:155], v[160:161] op_sel_hi:[1,0] neg_lo:[0,1] neg_hi:[0,1]
    v_pk_add_f32 v[180:181], v[156:157], v[160:161] op_sel_hi:[1,0] neg_lo:[0,1] neg_hi:[0,1]
    v_pk_add_f32 v[182:183], v[158:159], v[160:161] op_sel_hi:[1,0] neg_lo:[0,1] neg_hi:[0,1]
    v_pk_mul_f32 v[162:163], v[164:165], v[164:165]
    v_pk_mul_f32 v[184:185], v[166:167], v[166:167]
    v_pk_fma_f32 v[162:163], v[168:169], v[168:169], v[162:163]
    v_pk_fma_f32 v[184:185], v[170:171], v[170:171], v[184:185]
    v_pk_fma_f32 v[162:163], v[172:173], v[172:173], v[162:163]
    v_pk_fma_f32 v[184:185], v[174:175], v[174:175], v[184:185]
    v_pk_fma_f32 v[162:163], v[176:177], v[176:177], v[162:163]
    v_pk_fma_f32 v[184:185], v[178:179], v[178:179], v[184:185]
    v_pk_fma_f32 v[162:163], v[180:181], v[180:181], v[162:163]
    v_pk_fma_f32 v[184:185], v[182:183], v[182:183], v[184:185]
    v_pk_add_f32 v[162:163], v[162:163], v[184:185]
    v_add_f32 v162, v162, v163
    s_nop 1
    v_add_f32 v162, v162, v162 quad_perm:[1,0,3,2]
    s_nop 1
    v_add_f32 v162, v162, v162 quad_perm:[2,3,0,1]
    s_nop 1
    v_add_f32 v162, v162, v162 row_half_mirror
    s_nop 1
    v_add_f32 v162, v162, v162 row_mirror
    v_mov_b32 v163, v162
    s_nop 1
    v_permlane16_swap_b32 v162, v163
    s_nop 0
    v_add_f32 v162, v162, v163
    v_mul_f32 v162, 0x3acccccd, v162
    v_cvt_pk_bf16_f32 v162, v162, v162
    v_lshlrev_b32 v162, 16, v162
    v_add_f32 v162, 0x3727c5ac, v162
    v_cvt_pk_bf16_f32 v162, v162, v162
    v_lshlrev_b32 v162, 16, v162
    v_sqrt_f32 v162, v162
    v_cvt_pk_bf16_f32 v160, v160, v160
    v_lshlrev_b32 v160, 16, v160
    v_cvt_pk_bf16_f32 v162, v162, v162
    v_lshlrev_b32 v162, 16, v162
    v_rcp_f32 v163, v162
    v_sub_f32 v184, 0, v160
    v_mul_f32 v187, v162, v162
    v_mul_f32 v161, v163, v163
    v_mul_f32 v186, 0xc0135761, v163
    v_mul_f32 v161, v161, v163
    v_mul_f32 v162, v184, v163
    v_mul_f32 v185, 0xbdd2d3e8, v161
    v_pk_fma_f32 v[164:165], v[140:141], v[162:163], v[162:163] op_sel:[0,1,0] op_sel_hi:[1,1,0]
    v_pk_fma_f32 v[166:167], v[142:143], v[162:163], v[162:163] op_sel:[0,1,0] op_sel_hi:[1,1,0]
    v_pk_fma_f32 v[168:169], v[144:145], v[162:163], v[162:163] op_sel:[0,1,0] op_sel_hi:[1,1,0]
    v_pk_fma_f32 v[170:171], v[146:147], v[162:163], v[162:163] op_sel:[0,1,0] op_sel_hi:[1,1,0]
    v_pk_fma_f32 v[172:173], v[148:149], v[162:163], v[162:163] op_sel:[0,1,0] op_sel_hi:[1,1,0]
    v_pk_fma_f32 v[174:175], v[150:151], v[162:163], v[162:163] op_sel:[0,1,0] op_sel_hi:[1,1,0]
    v_pk_fma_f32 v[176:177], v[152:153], v[162:163], v[162:163] op_sel:[0,1,0] op_sel_hi:[1,1,0]
    v_pk_fma_f32 v[178:179], v[154:155], v[162:163], v[162:163] op_sel:[0,1,0] op_sel_hi:[1,1,0]
    v_pk_fma_f32 v[180:181], v[156:157], v[162:163], v[162:163] op_sel:[0,1,0] op_sel_hi:[1,1,0]
    v_pk_fma_f32 v[182:183], v[158:159], v[162:163], v[162:163] op_sel:[0,1,0] op_sel_hi:[1,1,0]
    v_cvt_pk_f16_f32 v188, v164, v165
    v_cvt_pk_f16_f32 v189, v166, v167
    v_cvt_pk_f16_f32 v190, v168, v169
    v_cvt_pk_f16_f32 v191, v170, v171
    v_cvt_pk_f16_f32 v192, v172, v173
    v_cvt_pk_f16_f32 v193, v174, v175
    v_cvt_pk_f16_f32 v194, v176, v177
    v_cvt_pk_f16_f32 v195, v178, v179
    v_cvt_pk_f16_f32 v196, v180, v181
    v_cvt_pk_f16_f32 v197, v182, v183
    v_lshrrev_b32 v2, 5, v0
    v_mul_u32_u24 v2, 1344, v2
    v_and_b32 v3, 31, v0
    v_lshl_add_u32 v2, v3, 3, v2
    s_mul_i32 s55, s40, 2688
    s_add_u32 s55, s55, 98304
    v_add_u32 v2, s55, v2
    ds_write_b64 v2, v[188:189] offset:0
    ds_write_b64 v2, v[190:191] offset:256
    ds_write_b64 v2, v[192:193] offset:512
    ds_write_b64 v2, v[194:195] offset:768
    ds_write_b64 v2, v[196:197] offset:1024
    v_lshrrev_b32 v4, 1, v0
    v_mov_b32 v5, 2147418112
    v_cmp_ne_u32 vcc, 0, v3
    s_lshl_b32 s55, s2, 2
    s_add_u32 s55, s55, s40
    v_cndmask_b32 v4, v4, v5, vcc
    s_lshl_b32 s55, s55, 5
    s_add_u32 s55, s55, 32768
    v_bfe_u32 v6, v0, 2, 2
    v_mul_u32_u24 v2, 1344, v6
    v_lshrrev_b32 v3, 4, v0
    v_lshl_add_u32 v2, v3, 5, v2
    v_and_b32 v7, 3, v0
    v_lshl_add_u32 v2, v7, 3, v2
    s_lshl_b32 s56, s40, 7
    s_add_u32 s56, s56, 98304
    v_add_u32 v2, s56, v2
    buffer_store_dwordx4 v[184:187], v4, s[16:19], s55 offen sc1
    s_waitcnt lgkmcnt(0)
    s_barrier
    ds_read_b64_tr_b16 v[200:201], v2 offset:0
    ds_read_b64_tr_b16 v[202:203], v2 offset:5376
    ds_read_b64_tr_b16 v[204:205], v2 offset:512
    ds_read_b64_tr_b16 v[206:207], v2 offset:5888
    ds_read_b64_tr_b16 v[208:209], v2 offset:1024
    ds_read_b64_tr_b16 v[210:211], v2 offset:6400
    s_mul_i32 s55, s2, 10240
    s_lshl_b32 s56, s40, 10
    s_add_u32 s55, s55, s56
    s_add_u32 s55, s55, 65536
    s_add_u32 s56, s55, 4096
    s_add_u32 s57, s55, 8192
    s_cmp_lt_u32 s40, 2
    s_cselect_b32 s57, s57, 2147418112
    s_waitcnt lgkmcnt(4)
    buffer_store_dwordx4 v[200:203], v1, s[16:19], s55 offen sc1
    s_waitcnt lgkmcnt(2)
    buffer_store_dwordx4 v[204:207], v1, s[16:19], s56 offen sc1
    s_waitcnt lgkmcnt(0)
    buffer_store_dwordx4 v[208:211], v1, s[16:19], s57 offen sc1
    s_lshl_b32 s60, s2, 2
    s_add_u32 s60, s60, 4096
    s_cmp_eq_u32 s40, 0
    s_cselect_b32 s60, s60, 2147418112
    v_add_u32 v118, 4096, v1
    v_min_u32 v2, 53, v0
    s_lshr_b32 s0, s83, 1
    s_lshl_b32 s0, s0, 10
    s_add_u32 s0, s0, 17408
    v_lshl_add_u32 v119, v2, 4, s0
    s_mov_b32 s97, s46
    s_mov_b32 s87, 0
    v_accvgpr_read_b32 v224, a224
    v_accvgpr_read_b32 v225, a225
    v_accvgpr_read_b32 v226, a226
    v_accvgpr_read_b32 v227, a227
    v_accvgpr_read_b32 v228, a228
    v_accvgpr_read_b32 v229, a229
    v_accvgpr_read_b32 v230, a230
    v_accvgpr_read_b32 v231, a231
    v_accvgpr_read_b32 v46, a193
    v_accvgpr_read_b32 v47, a194
    v_accvgpr_read_b32 v51, a198
    v_readfirstlane_b32 s41, v120
    s_nop 3
    s_mul_i32 s41, s41, 1664525
    s_add_u32 s41, s41, 1013904223
    v_mov_b32 v120, s41
L_kgen:
    v_accvgpr_read_b32 v116, a164
    v_accvgpr_read_b32 v117, a165
    v_accvgpr_read_b32 v112, a160
    v_accvgpr_read_b32 v113, a161
    v_accvgpr_read_b32 v114, a162
    v_accvgpr_read_b32 v115, a163
    v_accvgpr_read_b32 v134, a192
    s_lshl_b32 s55, s63, 4
    v_lshrrev_b32 v128, s55, v116
    v_lshlrev_b32 v128, 16, v128
    v_mul_f32 v128, 0x3fb8aa3b, v128
    v_exp_f32 v128, v128
    v_lshrrev_b32 v135, s55, v117
    v_lshlrev_b32 v135, 16, v135
    v_cvt_pk_bf16_f32 v128, v128, v128
    v_lshlrev_b32 v128, 16, v128
    v_lshlrev_b32 v130, 16, v112
    v_and_b32 v131, 0xffff0000, v112
    v_mul_f32 v130, 0x3fb8aa3b, v130
    v_mul_f32 v131, 0x3fb8aa3b, v131
    v_exp_f32 v130, v130
    v_exp_f32 v131, v131
    v_lshlrev_b32 v132, 16, v113
    v_and_b32 v133, 0xffff0000, v113
    v_cvt_pk_bf16_f32 v129, v130, v131
    v_lshlrev_b32 v152, 16, v114
    v_lshlrev_b32 v153, 16, v115
    v_and_b32 v154, 0xffff0000, v114
    v_and_b32 v155, 0xffff0000, v115
    v_lshlrev_b32 v130, 16, v129
    v_and_b32 v131, 0xffff0000, v129
    v_mul_f32 v130, v130, v128
    v_mul_f32 v132, v132, v128
    v_mul_f32 v131, v131, v128
    v_mul_f32 v133, v133, v128
    v_mul_f32 v130, 0xbfb8aa3b, v130
    v_mul_f32 v132, 0x3e22f983, v132
    v_mul_f32 v131, 0xbfb8aa3b, v131
    v_mul_f32 v133, 0x3e22f983, v133
    s_cmp_lg_u32 s62, 0
    s_cbranch_scc1 L_role1s
    v_add_u32 v134, 11424, v134
    v_mul_f32 v136, 0x41000000, v130
    v_mul_f32 v138, 0x41000000, v132
    v_mul_f32 v137, 0x41000000, v131
    v_mul_f32 v139, 0x41000000, v133
    v_fract_f32 v138, v138
    v_fract_f32 v139, v139
    v_exp_f32 v136, v136
    v_cos_f32 v152, v138
    v_sin_f32 v153, v138
    v_exp_f32 v137, v137
    v_cos_f32 v154, v139
    v_sin_f32 v155, v139
    s_nop 0
    .p2align 3
    v_pk_mul_f32 v[152:153], v[152:153], v[136:137] op_sel:[0,0] op_sel_hi:[1,0]
    v_pk_mul_f32 v[154:155], v[154:155], v[136:137] op_sel:[0,1] op_sel_hi:[1,1]
    v_mov_b32 v144, 0x3c00
    v_mov_b32 v145, 0x3c00
    v_pk_mul_f32 v[136:137], v[152:153], v[152:153] op_sel_hi:[0,1]
    v_pk_mul_f32 v[138:139], v[154:155], v[154:155] op_sel_hi:[0,1]
    v_pk_fma_f32 v[156:157], v[152:153], v[152:153], v[136:137] op_sel:[1,1,0] op_sel_hi:[1,0,1] neg_lo:[0,1,0]
    v_pk_fma_f32 v[158:159], v[154:155], v[154:155], v[138:139] op_sel:[1,1,0] op_sel_hi:[1,0,1] neg_lo:[0,1,0]
    v_cvt_pk_f16_f32 v146, v152, v153
    v_cvt_pk_f16_f32 v147, v154, v155
    ds_write2_b64 v134, v[144:145], v[146:147] offset0:0 offset1:68
    v_pk_mul_f32 v[140:141], v[152:153], v[156:157] op_sel_hi:[0,1]
    v_pk_mul_f32 v[142:143], v[154:155], v[158:159] op_sel_hi:[0,1]
    v_pk_fma_f32 v[172:173], v[152:153], v[156:157], v[140:141] op_sel:[1,1,0] op_sel_hi:[1,0,1] neg_lo:[0,1,0]
    v_pk_fma_f32 v[174:175], v[154:155], v[158:159], v[142:143] op_sel:[1,1,0] op_sel_hi:[1,0,1] neg_lo:[0,1,0]
    v_cvt_pk_f16_f32 v148, v156, v157
    v_cvt_pk_f16_f32 v149, v158, v159
    v_cvt_pk_f16_f32 v150, v172, v173
    v_cvt_pk_f16_f32 v151, v174, v175
    ds_write2_b64 v134, v[148:149], v[150:151] offset0:136 offset1:204
    v_add_u32 v134, 2176, v134
    v_pk_mul_f32 v[136:137], v[156:157], v[156:157] op_sel_hi:[0,1]
    v_pk_mul_f32 v[140:141], v[172:173], v[156:157] op_sel_hi:[0,1]
    v_pk_mul_f32 v[138:139], v[158:159], v[158:159] op_sel_hi:[0,1]
    v_pk_mul_f32 v[142:143], v[174:175], v[158:159] op_sel_hi:[0,1]
    v_pk_fma_f32 v[160:161], v[156:157], v[156:157], v[136:137] op_sel:[1,1,0] op_sel_hi:[1,0,1] neg_lo:[0,1,0]
    v_pk_fma_f32 v[168:169], v[172:173], v[156:157], v[140:141] op_sel:[1,1,0] op_sel_hi:[1,0,1] neg_lo:[0,1,0]
    v_pk_fma_f32 v[162:163], v[158:159], v[158:159], v[138:139] op_sel:[1,1,0] op_sel_hi:[1,0,1] neg_lo:[0,1,0]
    v_pk_fma_f32 v[170:171], v[174:175], v[158:159], v[142:143] op_sel:[1,1,0] op_sel_hi:[1,0,1] neg_lo:[0,1,0]
    v_cvt_pk_f16_f32 v144, v160, v161
    v_cvt_pk_f16_f32 v145, v162, v163
    v_cvt_pk_f16_f32 v146, v168, v169
    v_cvt_pk_f16_f32 v147, v170, v171
    ds_write2_b64 v134, v[144:145], v[146:147] offset0:0 offset1:68
    v_pk_mul_f32 v[136:137], v[160:161], v[156:157] op_sel_hi:[0,1]
    v_pk_mul_f32 v[140:141], v[168:169], v[156:157] op_sel_hi:[0,1]
    v_pk_mul_f32 v[138:139], v[162:163], v[158:159] op_sel_hi:[0,1]
    v_pk_mul_f32 v[142:143], v[170:171], v[158:159] op_sel_hi:[0,1]
    v_pk_fma_f32 v[164:165], v[160:161], v[156:157], v[136:137] op_sel:[1,1,0] op_sel_hi:[1,0,1] neg_lo:[0,1,0]
    v_pk_fma_f32 v[172:173], v[168:169], v[156:157], v[140:141] op_sel:[1,1,0] op_sel_hi:[1,0,1] neg_lo:[0,1,0]
    v_pk_fma_f32 v[166:167], v[162:163], v[158:159], v[138:139] op_sel:[1,1,0] op_sel_hi:[1,0,1] neg_lo:[0,1,0]
    v_pk_fma_f32 v[174:175], v[170:171], v[158:159], v[142:143] op_sel:[1,1,0] op_sel_hi:[1,0,1] neg_lo:[0,1,0]
    v_cvt_pk_f16_f32 v148, v164, v165
    v_cvt_pk_f16_f32 v149, v166, v167
    v_cvt_pk_f16_f32 v150, v172, v173
    v_cvt_pk_f16_f32 v151, v174, v175
    ds_write2_b64 v134, v[148:149], v[150:151] offset0:136 offset1:204
    v_add_u32 v134, 2176, v134
    v_pk_mul_f32 v[136:137], v[164:165], v[156:157] op_sel_hi:[0,1]
    v_pk_mul_f32 v[140:141], v[172:173], v[156:157] op_sel_hi:[0,1]
    v_pk_mul_f32 v[138:139], v[166:167], v[158:159] op_sel_hi:[0,1]
    v_pk_mul_f32 v[142:143], v[174:175], v[158:159] op_sel_hi:[0,1]
    v_pk_fma_f32 v[160:161], v[164:165], v[156:157], v[136:137] op_sel:[1,1,0] op_sel_hi:[1,0,1] neg_lo:[0,1,0]
    v_pk_fma_f32 v[168:169], v[172:173], v[156:157], v[140:141] op_sel:[1,1,0] op_sel_hi:[1,0,1] neg_lo:[0,1,0]
    v_pk_fma_f32 v[162:163], v[166:167], v[158:159], v[138:139] op_sel:[1,1,0] op_sel_hi:[1,0,1] neg_lo:[0,1,0]
    v_pk_fma_f32 v[170:171], v[174:175], v[158:159], v[142:143] op_sel:[1,1,0] op_sel_hi:[1,0,1] neg_lo:[0,1,0]
    v_cvt_pk_f16_f32 v144, v160, v161
    v_cvt_pk_f16_f32 v145, v162, v163
    v_cvt_pk_f16_f32 v146, v168, v169
    v_cvt_pk_f16_f32 v147, v170, v171
    ds_write2_b64 v134, v[144:145], v[146:147] offset0:0 offset1:68
    v_pk_mul_f32 v[136:137], v[160:161], v[156:157] op_sel_hi:[0,1]
    v_pk_mul_f32 v[140:141], v[168:169], v[156:157] op_sel_hi:[0,1]
    v_pk_mul_f32 v[138:139], v[162:163], v[158:159] op_sel_hi:[0,1]
    v_pk_mul_f32 v[142:143], v[170:171], v[158:159] op_sel_hi:[0,1]
    v_pk_fma_f32 v[164:165], v[160:161], v[156:157], v[136:137] op_sel:[1,1,0] op_sel_hi:[1,0,1] neg_lo:[0,1,0]
    v_pk_fma_f32 v[172:173], v[168:169], v[156:157], v[140:141] op_sel:[1,1,0] op_sel_hi:[1,0,1] neg_lo:[0,1,0]
    v_pk_fma_f32 v[166:167], v[162:163], v[158:159], v[138:139] op_sel:[1,1,0] op_sel_hi:[1,0,1] neg_lo:[0,1,0]
    v_pk_fma_f32 v[174:175], v[170:171], v[158:159], v[142:143] op_sel:[1,1,0] op_sel_hi:[1,0,1] neg_lo:[0,1,0]
    v_cvt_pk_f16_f32 v148, v164, v165
    v_cvt_pk_f16_f32 v149, v166, v167
    v_cvt_pk_f16_f32 v150, v172, v173
    v_cvt_pk_f16_f32 v151, v174, v175
    ds_write2_b64 v134, v[148:149], v[150:151] offset0:136 offset1:204
    v_add_u32 v134, 2176, v134
    v_pk_mul_f32 v[136:137], v[164:165], v[156:157] op_sel_hi:[0,1]
    v_pk_mul_f32 v[140:141], v[172:173], v[156:157] op_sel_hi:[0,1]
    v_pk_mul_f32 v[138:139], v[166:167], v[158:159] op_sel_hi:[0,1]
    v_pk_mul_f32 v[142:143], v[174:175], v[158:159] op_sel_hi:[0,1]
    v_pk_fma_f32 v[160:161], v[164:165], v[156:157], v[136:137] op_sel:[1,1,0] op_sel_hi:[1,0,1] neg_lo:[0,1,0]
    v_pk_fma_f32 v[168:169], v[172:173], v[156:157], v[140:141] op_sel:[1,1,0] op_sel_hi:[1,0,1] neg_lo:[0,1,0]
    v_pk_fma_f32 v[162:163], v[166:167], v[158:159], v[138:139] op_sel:[1,1,0] op_sel_hi:[1,0,1] neg_lo:[0,1,0]
    v_pk_fma_f32 v[170:171], v[174:175], v[158:159], v[142:143] op_sel:[1,1,0] op_sel_hi:[1,0,1] neg_lo:[0,1,0]
    v_cvt_pk_f16_f32 v144, v160, v161
    v_cvt_pk_f16_f32 v145, v162, v163
    v_cvt_pk_f16_f32 v146, v168, v169
    v_cvt_pk_f16_f32 v147, v170, v171
    ds_write2_b64 v134, v[144:145], v[146:147] offset0:0 offset1:68
    v_pk_mul_f32 v[136:137], v[160:161], v[156:157] op_sel_hi:[0,1]
    v_pk_mul_f32 v[140:141], v[168:169], v[156:157] op_sel_hi:[0,1]
    v_pk_mul_f32 v[138:139], v[162:163], v[158:159] op_sel_hi:[0,1]
    v_pk_mul_f32 v[142:143], v[170:171], v[158:159] op_sel_hi:[0,1]
    v_pk_fma_f32 v[164:165], v[160:161], v[156:157], v[136:137] op_sel:[1,1,0] op_sel_hi:[1,0,1] neg_lo:[0,1,0]
    v_pk_fma_f32 v[172:173], v[168:169], v[156:157], v[140:141] op_sel:[1,1,0] op_sel_hi:[1,0,1] neg_lo:[0,1,0]
    v_pk_fma_f32 v[166:167], v[162:163], v[158:159], v[138:139] op_sel:[1,1,0] op_sel_hi:[1,0,1] neg_lo:[0,1,0]
    v_pk_fma_f32 v[174:175], v[170:171], v[158:159], v[142:143] op_sel:[1,1,0] op_sel_hi:[1,0,1] neg_lo:[0,1,0]
    v_cvt_pk_f16_f32 v148, v164, v165
    v_cvt_pk_f16_f32 v149, v166, v167
    v_cvt_pk_f16_f32 v150, v172, v173
    v_cvt_pk_f16_f32 v151, v174, v175
    ds_write2_b64 v134, v[148:149], v[150:151] offset0:136 offset1:204
    v_add_u32 v134, 2176, v134
    v_pk_mul_f32 v[136:137], v[164:165], v[156:157] op_sel_hi:[0,1]
    v_pk_mul_f32 v[140:141], v[172:173], v[156:157] op_sel_hi:[0,1]
    v_pk_mul_f32 v[138:139], v[166:167], v[158:159] op_sel_hi:[0,1]
    v_pk_mul_f32 v[142:143], v[174:175], v[158:159] op_sel_hi:[0,1]
    v_pk_fma_f32 v[160:161], v[164:165], v[156:157], v[136:137] op_sel:[1,1,0] op_sel_hi:[1,0,1] neg_lo:[0,1,0]
    v_pk_fma_f32 v[168:169], v[172:173], v[156:157], v[140:141] op_sel:[1,1,0] op_sel_hi:[1,0,1] neg_lo:[0,1,0]
    v_pk_fma_f32 v[162:163], v[166:167], v[158:159], v[138:139] op_sel:[1,1,0] op_sel_hi:[1,0,1] neg_lo:[0,1,0]
    v_pk_fma_f32 v[170:171], v[174:175], v[158:159], v[142:143] op_sel:[1,1,0] op_sel_hi:[1,0,1] neg_lo:[0,1,0]
    v_cvt_pk_f16_f32 v144, v160, v161
    v_cvt_pk_f16_f32 v145, v162, v163
    v_cvt_pk_f16_f32 v146, v168, v169
    v_cvt_pk_f16_f32 v147, v170, v171
    ds_write2_b64 v134, v[144:145], v[146:147] offset0:0 offset1:68
    v_pk_mul_f32 v[136:137], v[160:161], v[156:157] op_sel_hi:[0,1]
    v_pk_mul_f32 v[140:141], v[168:169], v[156:157] op_sel_hi:[0,1]
    v_pk_mul_f32 v[138:139], v[162:163], v[158:159] op_sel_hi:[0,1]
    v_pk_mul_f32 v[142:143], v[170:171], v[158:159] op_sel_hi:[0,1]
    v_pk_fma_f32 v[164:165], v[160:161], v[156:157], v[136:137] op_sel:[1,1,0] op_sel_hi:[1,0,1] neg_lo:[0,1,0]
    v_pk_fma_f32 v[172:173], v[168:169], v[156:157], v[140:141] op_sel:[1,1,0] op_sel_hi:[1,0,1] neg_lo:[0,1,0]
    v_pk_fma_f32 v[166:167], v[162:163], v[158:159], v[138:139] op_sel:[1,1,0] op_sel_hi:[1,0,1] neg_lo:[0,1,0]
    v_pk_fma_f32 v[174:175], v[170:171], v[158:159], v[142:143] op_sel:[1,1,0] op_sel_hi:[1,0,1] neg_lo:[0,1,0]
    v_cvt_pk_f16_f32 v148, v164, v165
    v_cvt_pk_f16_f32 v149, v166, v167
    v_cvt_pk_f16_f32 v150, v172, v173
    v_cvt_pk_f16_f32 v151, v174, v175
    ds_write2_b64 v134, v[148:149], v[150:151] offset0:136 offset1:204
    v_add_u32 v134, 2176, v134
    v_pk_mul_f32 v[136:137], v[164:165], v[156:157] op_sel_hi:[0,1]
    v_pk_mul_f32 v[140:141], v[172:173], v[156:157] op_sel_hi:[0,1]
    v_pk_mul_f32 v[138:139], v[166:167], v[158:159] op_sel_hi:[0,1]
    v_pk_mul_f32 v[142:143], v[174:175], v[158:159] op_sel_hi:[0,1]
    v_pk_fma_f32 v[160:161], v[164:165], v[156:157], v[136:137] op_sel:[1,1,0] op_sel_hi:[1,0,1] neg_lo:[0,1,0]
    v_pk_fma_f32 v[168:169], v[172:173], v[156:157], v[140:141] op_sel:[1,1,0] op_sel_hi:[1,0,1] neg_lo:[0,1,0]
    v_pk_fma_f32 v[162:163], v[166:167], v[158:159], v[138:139] op_sel:[1,1,0] op_sel_hi:[1,0,1] neg_lo:[0,1,0]
    v_pk_fma_f32 v[170:171], v[174:175], v[158:159], v[142:143] op_sel:[1,1,0] op_sel_hi:[1,0,1] neg_lo:[0,1,0]
    v_cvt_pk_f16_f32 v144, v160, v161
    v_cvt_pk_f16_f32 v145, v162, v163
    v_cvt_pk_f16_f32 v146, v168, v169
    v_cvt_pk_f16_f32 v147, v170, v171
    ds_write2_b64 v134, v[144:145], v[146:147] offset0:0 offset1:68
    v_pk_mul_f32 v[136:137], v[160:161], v[156:157] op_sel_hi:[0,1]
    v_pk_mul_f32 v[140:141], v[168:169], v[156:157] op_sel_hi:[0,1]
    v_pk_mul_f32 v[138:139], v[162:163], v[158:159] op_sel_hi:[0,1]
    v_pk_mul_f32 v[142:143], v[170:171], v[158:159] op_sel_hi:[0,1]
    v_pk_fma_f32 v[164:165], v[160:161], v[156:157], v[136:137] op_sel:[1,1,0] op_sel_hi:[1,0,1] neg_lo:[0,1,0]
    v_pk_fma_f32 v[172:173], v[168:169], v[156:157], v[140:141] op_sel:[1,1,0] op_sel_hi:[1,0,1] neg_lo:[0,1,0]
    v_pk_fma_f32 v[166:167], v[162:163], v[158:159], v[138:139] op_sel:[1,1,0] op_sel_hi:[1,0,1] neg_lo:[0,1,0]
    v_pk_fma_f32 v[174:175], v[170:171], v[158:159], v[142:143] op_sel:[1,1,0] op_sel_hi:[1,0,1] neg_lo:[0,1,0]
    v_cvt_pk_f16_f32 v148, v164, v165
    v_cvt_pk_f16_f32 v149, v166, v167
    v_cvt_pk_f16_f32 v150, v172, v173
    v_cvt_pk_f16_f32 v151, v174, v175
    ds_write2_b64 v134, v[148:149], v[150:151] offset0:136 offset1:204
    v_add_u32 v134, 2176, v134
    v_pk_mul_f32 v[136:137], v[164:165], v[156:157] op_sel_hi:[0,1]
    v_pk_mul_f32 v[140:141], v[172:173], v[156:157] op_sel_hi:[0,1]
    v_pk_mul_f32 v[138:139], v[166:167], v[158:159] op_sel_hi:[0,1]
    v_pk_mul_f32 v[142:143], v[174:175], v[158:159] op_sel_hi:[0,1]
    v_pk_fma_f32 v[160:161], v[164:165], v[156:157], v[136:137] op_sel:[1,1,0] op_sel_hi:[1,0,1] neg_lo:[0,1,0]
    v_pk_fma_f32 v[168:169], v[172:173], v[156:157], v[140:141] op_sel:[1,1,0] op_sel_hi:[1,0,1] neg_lo:[0,1,0]
    v_pk_fma_f32 v[162:163], v[166:167], v[158:159], v[138:139] op_sel:[1,1,0] op_sel_hi:[1,0,1] neg_lo:[0,1,0]
    v_pk_fma_f32 v[170:171], v[174:175], v[158:159], v[142:143] op_sel:[1,1,0] op_sel_hi:[1,0,1] neg_lo:[0,1,0]
    v_cvt_pk_f16_f32 v144, v160, v161
    v_cvt_pk_f16_f32 v145, v162, v163
    v_cvt_pk_f16_f32 v146, v168, v169
    v_cvt_pk_f16_f32 v147, v170, v171
    ds_write2_b64 v134, v[144:145], v[146:147] offset0:0 offset1:68
    v_pk_mul_f32 v[136:137], v[160:161], v[156:157] op_sel_hi:[0,1]
    v_pk_mul_f32 v[140:141], v[168:169], v[156:157] op_sel_hi:[0,1]
    v_pk_mul_f32 v[138:139], v[162:163], v[158:159] op_sel_hi:[0,1]
    v_pk_mul_f32 v[142:143], v[170:171], v[158:159] op_sel_hi:[0,1]
    v_pk_fma_f32 v[164:165], v[160:161], v[156:157], v[136:137] op_sel:[1,1,0] op_sel_hi:[1,0,1] neg_lo:[0,1,0]
    v_pk_fma_f32 v[172:173], v[168:169], v[156:157], v[140:141] op_sel:[1,1,0] op_sel_hi:[1,0,1] neg_lo:[0,1,0]
    v_pk_fma_f32 v[166:167], v[162:163], v[158:159], v[138:139] op_sel:[1,1,0] op_sel_hi:[1,0,1] neg_lo:[0,1,0]
    v_pk_fma_f32 v[174:175], v[170:171], v[158:159], v[142:143] op_sel:[1,1,0] op_sel_hi:[1,0,1] neg_lo:[0,1,0]
    v_cvt_pk_f16_f32 v148, v164, v165
    v_cvt_pk_f16_f32 v149, v166, v167
    v_cvt_pk_f16_f32 v150, v172, v173
    v_cvt_pk_f16_f32 v151, v174, v175
    ds_write2_b64 v134, v[148:149], v[150:151] offset0:136 offset1:204
    v_add_u32 v134, 2176, v134
    v_pk_mul_f32 v[136:137], v[164:165], v[156:157] op_sel_hi:[0,1]
    v_pk_mul_f32 v[140:141], v[172:173], v[156:157] op_sel_hi:[0,1]
    v_pk_mul_f32 v[138:139], v[166:167], v[158:159] op_sel_hi:[0,1]
    v_pk_mul_f32 v[142:143], v[174:175], v[158:159] op_sel_hi:[0,1]
    v_pk_fma_f32 v[160:161], v[164:165], v[156:157], v[136:137] op_sel:[1,1,0] op_sel_hi:[1,0,1] neg_lo:[0,1,0]
    v_pk_fma_f32 v[168:169], v[172:173], v[156:157], v[140:141] op_sel:[1,1,0] op_sel_hi:[1,0,1] neg_lo:[0,1,0]
    v_pk_fma_f32 v[162:163], v[166:167], v[158:159], v[138:139] op_sel:[1,1,0] op_sel_hi:[1,0,1] neg_lo:[0,1,0]
    v_pk_fma_f32 v[170:171], v[174:175], v[158:159], v[142:143] op_sel:[1,1,0] op_sel_hi:[1,0,1] neg_lo:[0,1,0]
    v_cvt_pk_f16_f32 v144, v160, v161
    v_cvt_pk_f16_f32 v145, v162, v163
    v_cvt_pk_f16_f32 v146, v168, v169
    v_cvt_pk_f16_f32 v147, v170, v171
    ds_write2_b64 v134, v[144:145], v[146:147] offset0:0 offset1:68
    v_pk_mul_f32 v[136:137], v[160:161], v[156:157] op_sel_hi:[0,1]
    v_pk_mul_f32 v[140:141], v[168:169], v[156:157] op_sel_hi:[0,1]
    v_pk_mul_f32 v[138:139], v[162:163], v[158:159] op_sel_hi:[0,1]
    v_pk_mul_f32 v[142:143], v[170:171], v[158:159] op_sel_hi:[0,1]
    v_pk_fma_f32 v[164:165], v[160:161], v[156:157], v[136:137] op_sel:[1,1,0] op_sel_hi:[1,0,1] neg_lo:[0,1,0]
    v_pk_fma_f32 v[172:173], v[168:169], v[156:157], v[140:141] op_sel:[1,1,0] op_sel_hi:[1,0,1] neg_lo:[0,1,0]
    v_pk_fma_f32 v[166:167], v[162:163], v[158:159], v[138:139] op_sel:[1,1,0] op_sel_hi:[1,0,1] neg_lo:[0,1,0]
    v_pk_fma_f32 v[174:175], v[170:171], v[158:159], v[142:143] op_sel:[1,1,0] op_sel_hi:[1,0,1] neg_lo:[0,1,0]
    v_cvt_pk_f16_f32 v148, v164, v165
    v_cvt_pk_f16_f32 v149, v166, v167
    v_cvt_pk_f16_f32 v150, v172, v173
    v_cvt_pk_f16_f32 v151, v174, v175
    ds_write2_b64 v134, v[148:149], v[150:151] offset0:136 offset1:204
    v_add_u32 v134, 2176, v134
    s_branch L_kbars
    .p2align 3
L_role1s:
    v_max_f32 v136, |v152|, |v153|
    v_max3_f32 v136, |v154|, |v155|, v136
    s_nop 1
    v_max_f32 v136, v136, v136 quad_perm:[1,0,3,2]
    s_nop 1
    v_max_f32 v136, v136, v136 quad_perm:[2,3,0,1]
    s_nop 1
    v_max_f32 v136, v136, v136 row_half_mirror
    s_nop 1
    v_max_f32 v136, v136, v136 row_mirror
    v_mov_b32 v137, v136
    s_nop 1
    v_permlane16_swap_b32 v136, v137
    s_nop 0
    v_max_f32 v136, v136, v137
    v_mov_b32 v137, v136
    s_nop 1
    v_permlane32_swap_b32 v136, v137
    s_nop 0
    v_max_f32 v136, v136, v137
    v_frexp_exp_i32_f32 v136, v136
    v_add_f32 v128, v128, v128
    v_ldexp_f32 v138, v128, v136
    v_mov_b32 v139, v135
    v_sub_u32 v136, 0, v136
    v_ldexp_f32 v152, v152, v136
    v_ldexp_f32 v153, v153, v136
    v_ldexp_f32 v154, v154, v136
    v_ldexp_f32 v155, v155, v136
    v_add_u32 v137, s87, v51
    v_mov_b32 v136, 0
    ds_write_b64 v137, v[138:139] offset:2600
    ds_write_b32 v137, v136
    v_mul_f32 v136, 0x3f800000, v130
    v_mul_f32 v138, 0x3f800000, v132
    v_mul_f32 v137, 0x3f800000, v131
    v_mul_f32 v139, 0x3f800000, v133
    v_fract_f32 v138, v138
    v_fract_f32 v139, v139
    v_exp_f32 v136, v136
    v_cos_f32 v156, v138
    v_sin_f32 v157, v138
    v_exp_f32 v137, v137
    v_cos_f32 v158, v139
    v_sin_f32 v159, v139
    s_nop 0
    .p2align 3
    v_pk_mul_f32 v[156:157], v[156:157], v[136:137] op_sel:[0,0] op_sel_hi:[1,0]
    v_pk_mul_f32 v[158:159], v[158:159], v[136:137] op_sel:[0,1] op_sel_hi:[1,1]
    v_mul_f32 v136, 0x43800000, v130
    v_mul_f32 v138, 0x43800000, v132
    v_mul_f32 v137, 0x43800000, v131
    v_mul_f32 v139, 0x43800000, v133
    v_fract_f32 v138, v138
    v_fract_f32 v139, v139
    v_exp_f32 v136, v136
    v_cos_f32 v160, v138
    v_sin_f32 v161, v138
    v_exp_f32 v137, v137
    v_cos_f32 v162, v139
    v_sin_f32 v163, v139
    s_nop 0
    .p2align 3
    v_pk_mul_f32 v[160:161], v[160:161], v[136:137] op_sel:[0,0] op_sel_hi:[1,0]
    v_pk_mul_f32 v[162:163], v[162:163], v[136:137] op_sel:[0,1] op_sel_hi:[1,1]
    v_mul_f32 v136, 0x44800000, v130
    v_mul_f32 v138, 0x44800000, v132
    v_mul_f32 v137, 0x44800000, v131
    v_mul_f32 v139, 0x44800000, v133
    v_fract_f32 v138, v138
    v_fract_f32 v139, v139
    v_exp_f32 v136, v136
    v_cos_f32 v164, v138
    v_sin_f32 v165, v138
    v_exp_f32 v137, v137
    v_cos_f32 v166, v139
    v_sin_f32 v167, v139
    s_nop 0
    .p2align 3
    v_pk_mul_f32 v[164:165], v[164:165], v[136:137] op_sel:[0,0] op_sel_hi:[1,0]
    v_pk_mul_f32 v[166:167], v[166:167], v[136:137] op_sel:[0,1] op_sel_hi:[1,1]
    v_cvt_pk_f16_f32 v144, v152, -v153
    v_cvt_pk_f16_f32 v145, v154, -v155
    v_pk_mul_f32 v[136:137], v[152:153], v[156:157] op_sel_hi:[0,1]
    v_pk_mul_f32 v[138:139], v[154:155], v[158:159] op_sel_hi:[0,1]
    v_pk_fma_f32 v[172:173], v[152:153], v[156:157], v[136:137] op_sel:[1,1,0] op_sel_hi:[1,0,1] neg_lo:[0,1,0]
    v_pk_fma_f32 v[174:175], v[154:155], v[158:159], v[138:139] op_sel:[1,1,0] op_sel_hi:[1,0,1] neg_lo:[0,1,0]
    v_cvt_pk_f16_f32 v146, v172, -v173
    v_cvt_pk_f16_f32 v147, v174, -v175
    ds_write2_b64 v134, v[144:145], v[146:147] offset0:0 offset1:68
    v_pk_mul_f32 v[136:137], v[172:173], v[156:157] op_sel_hi:[0,1]
    v_pk_mul_f32 v[138:139], v[174:175], v[158:159] op_sel_hi:[0,1]
    v_pk_fma_f32 v[176:177], v[172:173], v[156:157], v[136:137] op_sel:[1,1,0] op_sel_hi:[1,0,1] neg_lo:[0,1,0]
    v_pk_fma_f32 v[178:179], v[174:175], v[158:159], v[138:139] op_sel:[1,1,0] op_sel_hi:[1,0,1] neg_lo:[0,1,0]
    v_cvt_pk_f16_f32 v148, v176, -v177
    v_cvt_pk_f16_f32 v149, v178, -v179
    v_pk_mul_f32 v[136:137], v[176:177], v[156:157] op_sel_hi:[0,1]
    v_pk_mul_f32 v[138:139], v[178:179], v[158:159] op_sel_hi:[0,1]
    v_pk_fma_f32 v[180:181], v[176:177], v[156:157], v[136:137] op_sel:[1,1,0] op_sel_hi:[1,0,1] neg_lo:[0,1,0]
    v_pk_fma_f32 v[182:183], v[178:179], v[158:159], v[138:139] op_sel:[1,1,0] op_sel_hi:[1,0,1] neg_lo:[0,1,0]
    v_cvt_pk_f16_f32 v150, v180, -v181
    v_cvt_pk_f16_f32 v151, v182, -v183
    ds_write2_b64 v134, v[148:149], v[150:151] offset0:136 offset1:204
    v_add_u32 v134, 2176, v134
    v_pk_mul_f32 v[136:137], v[180:181], v[156:157] op_sel_hi:[0,1]
    v_pk_mul_f32 v[138:139], v[182:183], v[158:159] op_sel_hi:[0,1]
    v_pk_fma_f32 v[184:185], v[180:181], v[156:157], v[136:137] op_sel:[1,1,0] op_sel_hi:[1,0,1] neg_lo:[0,1,0]
    v_pk_fma_f32 v[186:187], v[182:183], v[158:159], v[138:139] op_sel:[1,1,0] op_sel_hi:[1,0,1] neg_lo:[0,1,0]
    v_cvt_pk_f16_f32 v144, v184, -v185
    v_cvt_pk_f16_f32 v145, v186, -v187
    v_pk_mul_f32 v[136:137], v[184:185], v[156:157] op_sel_hi:[0,1]
    v_pk_mul_f32 v[138:139], v[186:187], v[158:159] op_sel_hi:[0,1]
    v_pk_fma_f32 v[188:189], v[184:185], v[156:157], v[136:137] op_sel:[1,1,0] op_sel_hi:[1,0,1] neg_lo:[0,1,0]
    v_pk_fma_f32 v[190:191], v[186:187], v[158:159], v[138:139] op_sel:[1,1,0] op_sel_hi:[1,0,1] neg_lo:[0,1,0]
    v_cvt_pk_f16_f32 v146, v188, -v189
    v_cvt_pk_f16_f32 v147, v190, -v191
    ds_write2_b64 v134, v[144:145], v[146:147] offset0:0 offset1:68
    v_pk_mul_f32 v[136:137], v[188:189], v[156:157] op_sel_hi:[0,1]
    v_pk_mul_f32 v[138:139], v[190:191], v[158:159] op_sel_hi:[0,1]
    v_pk_fma_f32 v[192:193], v[188:189], v[156:157], v[136:137] op_sel:[1,1,0] op_sel_hi:[1,0,1] neg_lo:[0,1,0]
    v_pk_fma_f32 v[194:195], v[190:191], v[158:159], v[138:139] op_sel:[1,1,0] op_sel_hi:[1,0,1] neg_lo:[0,1,0]
    v_cvt_pk_f16_f32 v148, v192, -v193
    v_cvt_pk_f16_f32 v149, v194, -v195
    v_pk_mul_f32 v[136:137], v[192:193], v[156:157] op_sel_hi:[0,1]
    v_pk_mul_f32 v[138:139], v[194:195], v[158:159] op_sel_hi:[0,1]
    v_pk_fma_f32 v[196:197], v[192:193], v[156:157], v[136:137] op_sel:[1,1,0] op_sel_hi:[1,0,1] neg_lo:[0,1,0]
    v_pk_fma_f32 v[198:199], v[194:195], v[158:159], v[138:139] op_sel:[1,1,0] op_sel_hi:[1,0,1] neg_lo:[0,1,0]
    v_cvt_pk_f16_f32 v150, v196, -v197
    v_cvt_pk_f16_f32 v151, v198, -v199
    ds_write2_b64 v134, v[148:149], v[150:151] offset0:136 offset1:204
    v_add_u32 v134, 2176, v134
    v_pk_mul_f32 v[136:137], v[152:153], v[160:161] op_sel_hi:[0,1]
    v_pk_mul_f32 v[138:139], v[154:155], v[162:163] op_sel_hi:[0,1]
    v_pk_fma_f32 v[200:201], v[152:153], v[160:161], v[136:137] op_sel:[1,1,0] op_sel_hi:[1,0,1] neg_lo:[0,1,0]
    v_pk_fma_f32 v[202:203], v[154:155], v[162:163], v[138:139] op_sel:[1,1,0] op_sel_hi:[1,0,1] neg_lo:[0,1,0]
    v_cvt_pk_f16_f32 v144, v200, -v201
    v_cvt_pk_f16_f32 v145, v202, -v203
    v_pk_mul_f32 v[136:137], v[176:177], v[160:161] op_sel_hi:[0,1]
    v_pk_mul_f32 v[138:139], v[178:179], v[162:163] op_sel_hi:[0,1]
    v_pk_fma_f32 v[204:205], v[176:177], v[160:161], v[136:137] op_sel:[1,1,0] op_sel_hi:[1,0,1] neg_lo:[0,1,0]
    v_pk_fma_f32 v[206:207], v[178:179], v[162:163], v[138:139] op_sel:[1,1,0] op_sel_hi:[1,0,1] neg_lo:[0,1,0]
    v_cvt_pk_f16_f32 v146, v204, -v205
    v_cvt_pk_f16_f32 v147, v206, -v207
    ds_write2_b64 v134, v[144:145], v[146:147] offset0:0 offset1:68
    v_pk_mul_f32 v[136:137], v[184:185], v[160:161] op_sel_hi:[0,1]
    v_pk_mul_f32 v[138:139], v[186:187], v[162:163] op_sel_hi:[0,1]
    v_pk_fma_f32 v[208:209], v[184:185], v[160:161], v[136:137] op_sel:[1,1,0] op_sel_hi:[1,0,1] neg_lo:[0,1,0]
    v_pk_fma_f32 v[210:211], v[186:187], v[162:163], v[138:139] op_sel:[1,1,0] op_sel_hi:[1,0,1] neg_lo:[0,1,0]
    v_cvt_pk_f16_f32 v148, v208, -v209
    v_cvt_pk_f16_f32 v149, v210, -v211
    v_pk_mul_f32 v[136:137], v[192:193], v[160:161] op_sel_hi:[0,1]
    v_pk_mul_f32 v[138:139], v[194:195], v[162:163] op_sel_hi:[0,1]
    v_pk_fma_f32 v[212:213], v[192:193], v[160:161], v[136:137] op_sel:[1,1,0] op_sel_hi:[1,0,1] neg_lo:[0,1,0]
    v_pk_fma_f32 v[214:215], v[194:195], v[162:163], v[138:139] op_sel:[1,1,0] op_sel_hi:[1,0,1] neg_lo:[0,1,0]
    v_cvt_pk_f16_f32 v150, v212, -v213
    v_cvt_pk_f16_f32 v151, v214, -v215
    ds_write2_b64 v134, v[148:149], v[150:151] offset0:136 offset1:204
    v_add_u32 v134, 2176, v134
    v_pk_mul_f32 v[136:137], v[200:201], v[160:161] op_sel_hi:[0,1]
    v_pk_mul_f32 v[138:139], v[202:203], v[162:163] op_sel_hi:[0,1]
    v_pk_fma_f32 v[216:217], v[200:201], v[160:161], v[136:137] op_sel:[1,1,0] op_sel_hi:[1,0,1] neg_lo:[0,1,0]
    v_pk_fma_f32 v[218:219], v[202:203], v[162:163], v[138:139] op_sel:[1,1,0] op_sel_hi:[1,0,1] neg_lo:[0,1,0]
    v_cvt_pk_f16_f32 v144, v216, -v217
    v_cvt_pk_f16_f32 v145, v218, -v219
    v_pk_mul_f32 v[136:137], v[208:209], v[160:161] op_sel_hi:[0,1]
    v_pk_mul_f32 v[138:139], v[210:211], v[162:163] op_sel_hi:[0,1]
    v_pk_fma_f32 v[220:221], v[208:209], v[160:161], v[136:137] op_sel:[1,1,0] op_sel_hi:[1,0,1] neg_lo:[0,1,0]
    v_pk_fma_f32 v[222:223], v[210:211], v[162:163], v[138:139] op_sel:[1,1,0] op_sel_hi:[1,0,1] neg_lo:[0,1,0]
    v_cvt_pk_f16_f32 v146, v220, -v221
    v_cvt_pk_f16_f32 v147, v222, -v223
    ds_write2_b64 v134, v[144:145], v[146:147] offset0:0 offset1:68
    v_pk_mul_f32 v[136:137], v[216:217], v[160:161] op_sel_hi:[0,1]
    v_pk_mul_f32 v[138:139], v[218:219], v[162:163] op_sel_hi:[0,1]
    v_pk_fma_f32 v[172:173], v[216:217], v[160:161], v[136:137] op_sel:[1,1,0] op_sel_hi:[1,0,1] neg_lo:[0,1,0]
    v_pk_fma_f32 v[174:175], v[218:219], v[162:163], v[138:139] op_sel:[1,1,0] op_sel_hi:[1,0,1] neg_lo:[0,1,0]
    v_cvt_pk_f16_f32 v148, v172, -v173
    v_cvt_pk_f16_f32 v149, v174, -v175
    v_pk_mul_f32 v[136:137], v[220:221], v[160:161] op_sel_hi:[0,1]
    v_pk_mul_f32 v[138:139], v[222:223], v[162:163] op_sel_hi:[0,1]
    v_pk_fma_f32 v[180:181], v[220:221], v[160:161], v[136:137] op_sel:[1,1,0] op_sel_hi:[1,0,1] neg_lo:[0,1,0]
    v_pk_fma_f32 v[182:183], v[222:223], v[162:163], v[138:139] op_sel:[1,1,0] op_sel_hi:[1,0,1] neg_lo:[0,1,0]
    v_cvt_pk_f16_f32 v150, v180, -v181
    v_cvt_pk_f16_f32 v151, v182, -v183
    ds_write2_b64 v134, v[148:149], v[150:151] offset0:136 offset1:204
    v_add_u32 v134, 2176, v134
    v_pk_mul_f32 v[136:137], v[152:153], v[164:165] op_sel_hi:[0,1]
    v_pk_mul_f32 v[138:139], v[154:155], v[166:167] op_sel_hi:[0,1]
    v_pk_fma_f32 v[200:201], v[152:153], v[164:165], v[136:137] op_sel:[1,1,0] op_sel_hi:[1,0,1] neg_lo:[0,1,0]
    v_pk_fma_f32 v[202:203], v[154:155], v[166:167], v[138:139] op_sel:[1,1,0] op_sel_hi:[1,0,1] neg_lo:[0,1,0]
    v_cvt_pk_f16_f32 v144, v200, -v201
    v_cvt_pk_f16_f32 v145, v202, -v203
    v_pk_mul_f32 v[136:137], v[200:201], v[160:161] op_sel_hi:[0,1]
    v_pk_mul_f32 v[138:139], v[202:203], v[162:163] op_sel_hi:[0,1]
    v_pk_fma_f32 v[204:205], v[200:201], v[160:161], v[136:137] op_sel:[1,1,0] op_sel_hi:[1,0,1] neg_lo:[0,1,0]
    v_pk_fma_f32 v[206:207], v[202:203], v[162:163], v[138:139] op_sel:[1,1,0] op_sel_hi:[1,0,1] neg_lo:[0,1,0]
    v_cvt_pk_f16_f32 v146, v204, -v205
    v_cvt_pk_f16_f32 v147, v206, -v207
    ds_write2_b64 v134, v[144:145], v[146:147] offset0:0 offset1:68
    v_pk_mul_f32 v[136:137], v[204:205], v[160:161] op_sel_hi:[0,1]
    v_pk_mul_f32 v[138:139], v[206:207], v[162:163] op_sel_hi:[0,1]
    v_pk_fma_f32 v[212:213], v[204:205], v[160:161], v[136:137] op_sel:[1,1,0] op_sel_hi:[1,0,1] neg_lo:[0,1,0]
    v_pk_fma_f32 v[214:215], v[206:207], v[162:163], v[138:139] op_sel:[1,1,0] op_sel_hi:[1,0,1] neg_lo:[0,1,0]
    v_cvt_pk_f16_f32 v148, v212, -v213
    v_cvt_pk_f16_f32 v149, v214, -v215
    v_pk_mul_f32 v[136:137], v[212:213], v[160:161] op_sel_hi:[0,1]
    v_pk_mul_f32 v[138:139], v[214:215], v[162:163] op_sel_hi:[0,1]
    v_pk_fma_f32 v[204:205], v[212:213], v[160:161], v[136:137] op_sel:[1,1,0] op_sel_hi:[1,0,1] neg_lo:[0,1,0]
    v_pk_fma_f32 v[206:207], v[214:215], v[162:163], v[138:139] op_sel:[1,1,0] op_sel_hi:[1,0,1] neg_lo:[0,1,0]
    v_cvt_pk_f16_f32 v150, v204, -v205
    v_cvt_pk_f16_f32 v151, v206, -v207
    ds_write2_b64 v134, v[148:149], v[150:151] offset0:136 offset1:204
    v_add_u32 v134, 2176, v134
    v_pk_mul_f32 v[136:137], v[200:201], v[164:165] op_sel_hi:[0,1]
    v_pk_mul_f32 v[138:139], v[202:203], v[166:167] op_sel_hi:[0,1]
    v_pk_fma_f32 v[208:209], v[200:201], v[164:165], v[136:137] op_sel:[1,1,0] op_sel_hi:[1,0,1] neg_lo:[0,1,0]
    v_pk_fma_f32 v[210:211], v[202:203], v[166:167], v[138:139] op_sel:[1,1,0] op_sel_hi:[1,0,1] neg_lo:[0,1,0]
    v_cvt_pk_f16_f32 v144, v208, -v209
    v_cvt_pk_f16_f32 v145, v210, -v211
    ds_write_b64 v134, v[144:145] offset:0
L_kbars:
    s_waitcnt vmcnt(0) lgkmcnt(0)
    s_barrier
    buffer_store_dword v120, v121, s[16:19], s60 offen sc1
    s_mov_b32 s60, 2147418112
    ds_read_b128 v[64:67], v46 offset:0
    ds_read_b128 v[128:131], v47 offset:11424
    ds_read_b128 v[160:163], v47 offset:20128
    ds_read_b128 v[68:71], v46 offset:64
    ds_read_b128 v[132:135], v47 offset:11488
    ds_read_b128 v[164:167], v47 offset:20192
    ds_read_b128 v[72:75], v46 offset:128
    ds_read_b128 v[136:139], v47 offset:11552
    ds_read_b128 v[168:171], v47 offset:20256
    ds_read_b128 v[76:79], v46 offset:192
    ds_read_b128 v[140:143], v47 offset:11616
    ds_read_b128 v[172:175], v47 offset:20320
    ds_read_b128 v[80:83], v46 offset:256
    ds_read_b128 v[144:147], v47 offset:11680
    ds_read_b128 v[176:179], v47 offset:20384
    ds_read_b128 v[84:87], v46 offset:320
    ds_read_b128 v[148:151], v47 offset:11744
    ds_read_b128 v[180:183], v47 offset:20448
    ds_read_b128 v[88:91], v46 offset:384
    ds_read_b128 v[152:155], v47 offset:11808
    ds_read_b128 v[184:187], v47 offset:20512
    ds_read_b128 v[92:95], v46 offset:448
    ds_read_b128 v[156:159], v47 offset:11872
    ds_read_b128 v[188:191], v47 offset:20576
    s_waitcnt lgkmcnt(15)
    v_mfma_f32_16x16x32_f16 v[96:99], v[64:67], v[128:131], 0
    v_mfma_f32_16x16x32_f16 v[100:103], v[64:67], v[160:163], 0
    s_waitcnt lgkmcnt(15)
    v_mfma_f32_16x16x32_f16 v[96:99], v[68:71], v[132:135], v[96:99]
    v_mfma_f32_16x16x32_f16 v[100:103], v[68:71], v[164:167], v[100:103]
    s_waitcnt lgkmcnt(15)
    v_mfma_f32_16x16x32_f16 v[96:99], v[72:75], v[136:139], v[96:99]
    v_mfma_f32_16x16x32_f16 v[100:103], v[72:75], v[168:171], v[100:103]
    s_waitcnt lgkmcnt(12)
    v_mfma_f32_16x16x32_f16 v[96:99], v[76:79], v[140:143], v[96:99]
    v_mfma_f32_16x16x32_f16 v[100:103], v[76:79], v[172:175], v[100:103]
    s_waitcnt lgkmcnt(9)
    v_mfma_f32_16x16x32_f16 v[96:99], v[80:83], v[144:147], v[96:99]
    v_mfma_f32_16x16x32_f16 v[100:103], v[80:83], v[176:179], v[100:103]
    s_waitcnt lgkmcnt(6)
    v_mfma_f32_16x16x32_f16 v[96:99], v[84:87], v[148:151], v[96:99]
    v_mfma_f32_16x16x32_f16 v[100:103], v[84:87], v[180:183], v[100:103]
    s_waitcnt lgkmcnt(3)
    v_mfma_f32_16x16x32_f16 v[96:99], v[88:91], v[152:155], v[96:99]
    v_mfma_f32_16x16x32_f16 v[100:103], v[88:91], v[184:187], v[100:103]
    s_waitcnt lgkmcnt(0)
    v_mfma_f32_16x16x32_f16 v[96:99], v[92:95], v[156:159], v[96:99]
    v_mfma_f32_16x16x32_f16 v[100:103], v[92:95], v[188:191], v[100:103]
    s_nop 6
    ds_write_b32 v224, v96
    ds_write_b32 v225, v97
    ds_write_b32 v226, v98
    ds_write_b32 v227, v99
    ds_write_b32 v228, v100
    ds_write_b32 v229, v101
    ds_write_b32 v230, v102
    ds_write_b32 v231, v103
    s_sub_u32 s97, s97, 1
    s_cmp_eq_u32 s97, 0
    s_cbranch_scc1 L_kdone
    s_add_u32 s87, s87, 5248
    v_add_u32 v224, 5248, v224
    v_add_u32 v225, 5248, v225
    v_add_u32 v226, 5248, v226
    v_add_u32 v227, 5248, v227
    v_add_u32 v228, 5248, v228
    v_add_u32 v229, 5248, v229
    v_add_u32 v230, 5248, v230
    v_add_u32 v231, 5248, v231
    v_accvgpr_mov_b32 a160, a168
    v_accvgpr_mov_b32 a168, a176
    v_accvgpr_mov_b32 a161, a169
    v_accvgpr_mov_b32 a169, a177
    v_accvgpr_mov_b32 a162, a170
    v_accvgpr_mov_b32 a170, a178
    v_accvgpr_mov_b32 a163, a171
    v_accvgpr_mov_b32 a171, a179
    v_accvgpr_mov_b32 a164, a172
    v_accvgpr_mov_b32 a172, a180
    v_accvgpr_mov_b32 a165, a173
    v_accvgpr_mov_b32 a173, a181
    s_waitcnt lgkmcnt(0)
    s_barrier
    s_branch L_kgen
L_kdone:
    s_cmp_lg_u32 s40, 0
    s_cbranch_scc1 L_sp_polled
    s_mov_b32 s61, 0x20000
Lpoll_9:
    buffer_load_dwordx4 v[122:125], v118, s[16:19], 0 offen sc1
    s_waitcnt vmcnt(0)
    v_xor_b32 v122, v120, v122
    v_xor_b32 v123, v120, v123
    v_xor_b32 v124, v120, v124
    v_xor_b32 v125, v120, v125
    v_or3_b32 v122, v122, v123, v124
    v_or_b32 v122, v122, v125
    v_cmp_ne_u32 vcc, 0, v122
    s_cbranch_vccz Lpd_10
    s_sleep 16
    s_sub_u32 s61, s61, 1
    s_cbranch_scc0 Lpoll_9
Lpd_10:
L_sp_polled:
    s_waitcnt lgkmcnt(0)
    s_barrier
    v_accvgpr_read_b32 v2, a215
    s_mul_i32 s0, s40, 655360
    s_lshl_b32 s1, s45, 5
    s_add_u32 s0, s0, s1
    s_add_u32 s0, s0, 65536
    s_add_u32 s1, s0, 327680
    buffer_load_dwordx4 v[56:59], v2, s[16:19], s0 offen sc1
    buffer_load_dwordx4 v[60:63], v2, s[16:19], s1 offen sc1
    v_accvgpr_read_b32 v24, a232
    v_accvgpr_read_b32 v25, a233
    v_accvgpr_read_b32 v26, a234
    v_accvgpr_read_b32 v27, a235
    v_accvgpr_read_b32 v28, a236
    v_accvgpr_read_b32 v29, a237
    v_accvgpr_read_b32 v30, a238
    v_accvgpr_read_b32 v31, a239
    v_accvgpr_read_b32 v32, a240
    v_accvgpr_read_b32 v33, a241
    v_accvgpr_read_b32 v34, a242
    v_accvgpr_read_b32 v35, a243
    v_accvgpr_read_b32 v36, a244
    v_accvgpr_read_b32 v37, a245
    v_accvgpr_read_b32 v38, a246
    v_accvgpr_read_b32 v39, a247
    v_accvgpr_read_b32 v40, a248
    v_accvgpr_read_b32 v41, a249
    v_accvgpr_read_b32 v42, a250
    v_accvgpr_read_b32 v43, a251
    v_accvgpr_read_b32 v44, a252
    v_accvgpr_read_b32 v45, a253
    v_subrev_u32 v24, 10240, v24
    v_subrev_u32 v25, 10240, v25
    v_subrev_u32 v26, 10240, v26
    v_subrev_u32 v27, 10240, v27
    v_subrev_u32 v28, 10240, v28
    v_subrev_u32 v29, 10240, v29
    v_subrev_u32 v30, 10240, v30
    v_subrev_u32 v31, 10240, v31
    v_subrev_u32 v32, 10240, v32
    v_subrev_u32 v33, 10240, v33
    v_subrev_u32 v34, 10240, v34
    v_subrev_u32 v35, 10240, v35
    v_subrev_u32 v36, 10240, v36
    v_subrev_u32 v37, 10240, v37
    v_subrev_u32 v38, 10240, v38
    v_subrev_u32 v39, 10240, v39
    v_subrev_u32 v40, 10240, v40
    v_subrev_u32 v41, 10240, v41
    v_subrev_u32 v42, 10240, v42
    v_subrev_u32 v43, 10240, v43
    v_subrev_u32 v44, 10240, v44
    v_subrev_u32 v45, 10240, v45
    v_accvgpr_read_b32 v48, a195
    v_accvgpr_read_b32 v49, a196
    v_accvgpr_read_b32 v50, a197
    v_accvgpr_read_b32 v51, a198
    v_accvgpr_read_b32 v52, a199
    v_accvgpr_read_b32 v53, a200
    v_mov_b32 v4, 0
    v_mov_b32 v5, 0
    v_mov_b32 v6, 0
    v_mov_b32 v7, 0
    ds_write_b128 v48, v[4:7]
L_conv_early:
    buffer_load_dwordx4 v[122:125], v119, s[16:19], 0 offen sc1
    ds_read_b32 v128, v24
    ds_read_b32 v129, v25
    ds_read_b32 v130, v26
    ds_read_b32 v131, v27
    ds_read_b32 v132, v28
    ds_read_b32 v133, v29
    ds_read_b32 v134, v30
    ds_read_b32 v135, v31
    ds_read_b32 v136, v32
    ds_read_b32 v137, v33
    ds_read_b32 v138, v34
    ds_read_b32 v140, v35
    ds_read_b32 v141, v36
    ds_read_b32 v142, v37
    ds_read_b32 v143, v38
    ds_read_b32 v144, v39
    ds_read_b32 v145, v40
    ds_read_b32 v146, v41
    ds_read_b32 v147, v42
    ds_read_b32 v148, v43
    ds_read_b32 v149, v44
    ds_read_b32 v150, v45
    ds_read_b64 v[100:101], v51 offset:2600
    s_waitcnt vmcnt(1)
    ds_write_b128 v50, v[56:59]
    ds_write_b128 v50, v[60:63] offset:512
    s_waitcnt lgkmcnt(14)
    .p2align 3
    v_cvt_pk_f16_f32 v64, v128, v129
    v_cvt_pk_f16_f32 v65, v130, v131
    v_cvt_pk_f16_f32 v66, v132, v133
    v_cvt_pk_f16_f32 v67, v134, v135
    ds_write_b128 v49, v[64:67] offset:0
    v_cvt_pk_f16_f32 v68, v129, v130
    v_cvt_pk_f16_f32 v69, v131, v132
    v_cvt_pk_f16_f32 v70, v133, v134
    v_cvt_pk_f16_f32 v71, v135, v136
    ds_write_b128 v49, v[68:71] offset:4160
    v_cvt_pk_f16_f32 v72, v130, v131
    v_cvt_pk_f16_f32 v73, v132, v133
    v_cvt_pk_f16_f32 v74, v134, v135
    v_cvt_pk_f16_f32 v75, v136, v137
    ds_write_b128 v49, v[72:75] offset:8320
    v_cvt_pk_f16_f32 v76, v131, v132
    v_cvt_pk_f16_f32 v77, v133, v134
    v_cvt_pk_f16_f32 v78, v135, v136
    v_cvt_pk_f16_f32 v79, v137, v138
    ds_write_b128 v49, v[76:79] offset:12480
    s_waitcnt lgkmcnt(7)
    .p2align 3
    v_cvt_pk_f16_f32 v80, v140, v141
    v_cvt_pk_f16_f32 v81, v142, v143
    v_cvt_pk_f16_f32 v82, v144, v145
    v_cvt_pk_f16_f32 v83, v146, v147
    ds_write_b128 v49, v[80:83] offset:1024
    v_cvt_pk_f16_f32 v84, v141, v142
    v_cvt_pk_f16_f32 v85, v143, v144
    v_cvt_pk_f16_f32 v86, v145, v146
    v_cvt_pk_f16_f32 v87, v147, v148
    ds_write_b128 v49, v[84:87] offset:5184
    v_cvt_pk_f16_f32 v88, v142, v143
    v_cvt_pk_f16_f32 v89, v144, v145
    v_cvt_pk_f16_f32 v90, v146, v147
    v_cvt_pk_f16_f32 v91, v148, v149
    ds_write_b128 v49, v[88:91] offset:9344
    v_cvt_pk_f16_f32 v92, v143, v144
    v_cvt_pk_f16_f32 v93, v145, v146
    v_cvt_pk_f16_f32 v94, v147, v148
    v_cvt_pk_f16_f32 v95, v149, v150
    ds_write_b128 v49, v[92:95] offset:13504
    s_waitcnt vmcnt(0)
    buffer_store_dword v120, v121, s[16:19], s60 offen sc1
    v_xor_b32 v122, v120, v122
    v_xor_b32 v123, v120, v123
    v_xor_b32 v124, v120, v124
    v_xor_b32 v125, v120, v125
    v_or3_b32 v122, v122, v123, v124
    v_or_b32 v122, v122, v125
    v_cmp_ne_u32 vcc, 0, v122
    s_nop 0
    s_cmp_eq_u64 vcc, 0
    s_cselect_b32 s96, 0, 2147418112
    s_waitcnt lgkmcnt(0)
    s_barrier
    ds_read_b128 v[224:227], v53 offset:192
    ds_read_b64 v[128:129], v52 offset:3776
    ds_read_b64 v[130:131], v52 offset:3784
    ds_read_b128 v[228:231], v53 offset:704
    ds_read_b64 v[132:133], v52 offset:3264
    ds_read_b64 v[134:135], v52 offset:3272
    ds_read_b128 v[232:235], v53 offset:1216
    ds_read_b64 v[136:137], v52 offset:2752
    ds_read_b64 v[138:139], v52 offset:2760
    ds_read_b128 v[236:239], v53 offset:1728
    ds_read_b64 v[140:141], v52 offset:2240
    ds_read_b64 v[142:143], v52 offset:2248
    ds_read_b128 v[240:243], v53 offset:2240
    ds_read_b64 v[144:145], v52 offset:1728
    ds_read_b64 v[146:147], v52 offset:1736
    ds_read_b128 v[244:247], v53 offset:2752
    ds_read_b64 v[148:149], v52 offset:1216
    ds_read_b64 v[150:151], v52 offset:1224
    ds_read_b128 v[248:251], v53 offset:3264
    ds_read_b64 v[152:153], v52 offset:704
    ds_read_b64 v[154:155], v52 offset:712
    ds_read_b128 v[252:255], v53 offset:3776
    ds_read_b64 v[156:157], v52 offset:192
    ds_read_b64 v[158:159], v52 offset:200
    s_waitcnt lgkmcnt(15)
    s_waitcnt lgkmcnt(15)
    v_mfma_f32_16x16x32_f16 v[64:67], v[128:131], v[224:227], 0
    v_accvgpr_read_b32 v4, a201
    s_waitcnt lgkmcnt(15)
    v_mfma_f32_16x16x32_f16 v[68:71], v[128:131], v[228:231], 0
    v_accvgpr_read_b32 v5, a202
    s_waitcnt lgkmcnt(15)
    v_mfma_f32_16x16x32_f16 v[68:71], v[132:135], v[224:227], v[68:71]
    v_accvgpr_read_b32 v6, a203
    s_add_u32 s59, s84, 0
    s_or_b32 s59, s59, s96
    buffer_load_dwordx4 a[0:3], v1, s[16:19], s59 offen offset:0 sc1
    v_mfma_f32_16x16x32_f16 v[72:75], v[132:135], v[228:231], 0
    v_accvgpr_read_b32 v7, a204
    s_waitcnt lgkmcnt(15)
    v_mfma_f32_16x16x32_f16 v[72:75], v[128:131], v[232:235], v[72:75]
    v_accvgpr_read_b32 v8, a205
    s_waitcnt lgkmcnt(15)
    v_mfma_f32_16x16x32_f16 v[72:75], v[136:139], v[224:227], v[72:75]
    s_lshl_b32 s55, s45, 1
    v_mfma_f32_16x16x32_f16 v[76:79], v[132:135], v[232:235], 0
    s_add_u32 s55, s55, s63
    buffer_load_dwordx4 a[4:7], v1, s[16:19], s59 offen offset:1024 sc1
    v_mfma_f32_16x16x32_f16 v[76:79], v[136:139], v[228:231], v[76:79]
    s_lshl_b32 s55, s55, 12
    v_mfma_f32_16x16x32_f16 v[80:83], v[136:139], v[232:235], 0
    ds_read_b128 v[192:195], v53 offset:128
    s_waitcnt lgkmcnt(15)
    v_mfma_f32_16x16x32_f16 v[76:79], v[128:131], v[236:239], v[76:79]
    ds_read_b64 v[160:161], v52 offset:3712
    s_lshl_b32 s57, s62, 11
    s_waitcnt lgkmcnt(14)
    v_mfma_f32_16x16x32_f16 v[76:79], v[140:143], v[224:227], v[76:79]
    ds_read_b64 v[162:163], v52 offset:3720
    buffer_load_dwordx4 a[8:11], v1, s[16:19], s59 offen offset:2048 sc1
    v_mfma_f32_16x16x32_f16 v[80:83], v[132:135], v[236:239], v[80:83]
    ds_read_b128 v[196:199], v53 offset:640
    s_add_u32 s55, s55, s57
    v_mfma_f32_16x16x32_f16 v[80:83], v[140:143], v[228:231], v[80:83]
    ds_read_b64 v[164:165], v52 offset:3200
    v_mfma_f32_16x16x32_f16 v[84:87], v[136:139], v[236:239], 0
    ds_read_b64 v[166:167], v52 offset:3208
    s_add_u32 s64, s55, 2686976
    v_mfma_f32_16x16x32_f16 v[84:87], v[140:143], v[232:235], v[84:87]
    ds_read_b128 v[200:203], v53 offset:1152
    buffer_load_dwordx4 a[12:15], v1, s[16:19], s59 offen offset:3072 sc1
    v_mfma_f32_16x16x32_f16 v[88:91], v[140:143], v[236:239], 0
    ds_read_b64 v[168:169], v52 offset:2688
    s_lshl_b32 s56, s45, 5
    s_waitcnt lgkmcnt(15)
    v_mfma_f32_16x16x32_f16 v[80:83], v[128:131], v[240:243], v[80:83]
    ds_read_b64 v[170:171], v52 offset:2696
    s_waitcnt lgkmcnt(15)
    v_mfma_f32_16x16x32_f16 v[80:83], v[144:147], v[224:227], v[80:83]
    ds_read_b128 v[204:207], v53 offset:1664
    s_add_u32 s56, s56, s40
    v_mfma_f32_16x16x32_f16 v[84:87], v[132:135], v[240:243], v[84:87]
    ds_read_b64 v[172:173], v52 offset:2176
    s_add_u32 s59, s84, 4096
    s_or_b32 s59, s59, s96
    buffer_load_dwordx4 a[16:19], v1, s[16:19], s59 offen offset:0 sc1
    v_mfma_f32_16x16x32_f16 v[84:87], v[144:147], v[228:231], v[84:87]
    ds_read_b64 v[174:175], v52 offset:2184
    s_lshl_b32 s56, s56, 2
    v_mfma_f32_16x16x32_f16 v[88:91], v[136:139], v[240:243], v[88:91]
    ds_read_b128 v[208:211], v53 offset:2176
    v_mfma_f32_16x16x32_f16 v[88:91], v[144:147], v[232:235], v[88:91]
    ds_read_b64 v[176:177], v52 offset:1664
    s_add_u32 s85, s56, 14966784
    v_mfma_f32_16x16x32_f16 v[92:95], v[140:143], v[240:243], 0
    ds_read_b64 v[178:179], v52 offset:1672
    buffer_load_dwordx4 a[20:23], v1, s[16:19], s59 offen offset:1024 sc1
    v_mfma_f32_16x16x32_f16 v[92:95], v[144:147], v[236:239], v[92:95]
    ds_read_b128 v[212:215], v53 offset:2688
    s_waitcnt lgkmcnt(15)
    v_mfma_f32_16x16x32_f16 v[84:87], v[128:131], v[244:247], v[84:87]
    ds_read_b64 v[180:181], v52 offset:1152
    s_waitcnt lgkmcnt(15)
    v_mfma_f32_16x16x32_f16 v[84:87], v[148:151], v[224:227], v[84:87]
    ds_read_b64 v[182:183], v52 offset:1160
    v_mfma_f32_16x16x32_f16 v[88:91], v[132:135], v[244:247], v[88:91]
    ds_read_b128 v[216:219], v53 offset:3200
    buffer_load_dwordx4 a[24:27], v1, s[16:19], s59 offen offset:2048 sc1
    v_mfma_f32_16x16x32_f16 v[88:91], v[148:151], v[228:231], v[88:91]
    ds_read_b64 v[184:185], v52 offset:640
    v_mfma_f32_16x16x32_f16 v[92:95], v[136:139], v[244:247], v[92:95]
    ds_read_b64 v[186:187], v52 offset:648
    v_mfma_f32_16x16x32_f16 v[92:95], v[148:151], v[232:235], v[92:95]
    ds_read_b128 v[220:223], v53 offset:3712
    s_waitcnt lgkmcnt(15)
    v_mfma_f32_16x16x32_f16 v[88:91], v[128:131], v[248:251], v[88:91]
    ds_read_b64 v[188:189], v52 offset:128
    buffer_load_dwordx4 a[28:31], v1, s[16:19], s59 offen offset:3072 sc1
    s_waitcnt lgkmcnt(15)
    v_mfma_f32_16x16x32_f16 v[88:91], v[152:155], v[224:227], v[88:91]
    ds_read_b64 v[190:191], v52 offset:136
    v_mfma_f32_16x16x32_f16 v[92:95], v[132:135], v[248:251], v[92:95]
    v_mfma_f32_16x16x32_f16 v[92:95], v[152:155], v[228:231], v[92:95]
    s_waitcnt lgkmcnt(15)
    v_mfma_f32_16x16x32_f16 v[92:95], v[128:131], v[252:255], v[92:95]
    s_add_u32 s59, s84, 8192
    s_or_b32 s59, s59, s96
    buffer_load_dwordx4 a[32:35], v1, s[16:19], s59 offen offset:0 sc1
    s_waitcnt lgkmcnt(15)
    v_mfma_f32_16x16x32_f16 v[92:95], v[156:159], v[224:227], v[92:95]
    s_waitcnt lgkmcnt(0)
    v_mfma_f32_16x16x32_f16 v[64:67], v[160:163], v[192:195], v[64:67]
    v_mfma_f32_16x16x32_f16 v[68:71], v[160:163], v[196:199], v[68:71]
    ds_read_b128 v[224:227], v53 offset:64
    v_mfma_f32_16x16x32_f16 v[68:71], v[164:167], v[192:195], v[68:71]
    ds_read_b64 v[128:129], v52 offset:3648
    buffer_load_dwordx4 a[36:39], v1, s[16:19], s59 offen offset:1024 sc1
    v_mfma_f32_16x16x32_f16 v[72:75], v[164:167], v[196:199], v[72:75]
    ds_read_b64 v[130:131], v52 offset:3656
    v_mfma_f32_16x16x32_f16 v[72:75], v[160:163], v[200:203], v[72:75]
    ds_read_b128 v[228:231], v53 offset:576
    v_mfma_f32_16x16x32_f16 v[72:75], v[168:171], v[192:195], v[72:75]
    ds_read_b64 v[132:133], v52 offset:3136
    v_mfma_f32_16x16x32_f16 v[76:79], v[164:167], v[200:203], v[76:79]
    ds_read_b64 v[134:135], v52 offset:3144
    buffer_load_dwordx4 a[40:43], v1, s[16:19], s59 offen offset:2048 sc1
    v_mfma_f32_16x16x32_f16 v[76:79], v[168:171], v[196:199], v[76:79]
    ds_read_b128 v[232:235], v53 offset:1088
    v_mfma_f32_16x16x32_f16 v[80:83], v[168:171], v[200:203], v[80:83]
    ds_read_b64 v[136:137], v52 offset:2624
    v_mfma_f32_16x16x32_f16 v[76:79], v[160:163], v[204:207], v[76:79]
    ds_read_b64 v[138:139], v52 offset:2632
    v_mfma_f32_16x16x32_f16 v[76:79], v[172:175], v[192:195], v[76:79]
    ds_read_b128 v[236:239], v53 offset:1600
    buffer_load_dwordx4 a[44:47], v1, s[16:19], s59 offen offset:3072 sc1
    v_mfma_f32_16x16x32_f16 v[80:83], v[164:167], v[204:207], v[80:83]
    ds_read_b64 v[140:141], v52 offset:2112
    v_mfma_f32_16x16x32_f16 v[80:83], v[172:175], v[196:199], v[80:83]
    ds_read_b64 v[142:143], v52 offset:2120
    v_mfma_f32_16x16x32_f16 v[84:87], v[168:171], v[204:207], v[84:87]
    ds_read_b128 v[240:243], v53 offset:2112
    v_mfma_f32_16x16x32_f16 v[84:87], v[172:175], v[200:203], v[84:87]
    ds_read_b64 v[144:145], v52 offset:1600
    s_add_u32 s59, s84, 12288
    s_or_b32 s59, s59, s96
    buffer_load_dwordx4 a[48:51], v1, s[16:19], s59 offen offset:0 sc1
    v_mfma_f32_16x16x32_f16 v[88:91], v[172:175], v[204:207], v[88:91]
    ds_read_b64 v[146:147], v52 offset:1608
    v_mfma_f32_16x16x32_f16 v[80:83], v[160:163], v[208:211], v[80:83]
    ds_read_b128 v[244:247], v53 offset:2624
    v_mfma_f32_16x16x32_f16 v[80:83], v[176:179], v[192:195], v[80:83]
    ds_read_b64 v[148:149], v52 offset:1088
    v_mfma_f32_16x16x32_f16 v[84:87], v[164:167], v[208:211], v[84:87]
    ds_read_b64 v[150:151], v52 offset:1096
    buffer_load_dwordx4 a[52:55], v1, s[16:19], s59 offen offset:1024 sc1
    v_mfma_f32_16x16x32_f16 v[84:87], v[176:179], v[196:199], v[84:87]
    ds_read_b128 v[248:251], v53 offset:3136
    v_mfma_f32_16x16x32_f16 v[88:91], v[168:171], v[208:211], v[88:91]
    ds_read_b64 v[152:153], v52 offset:576
    v_mfma_f32_16x16x32_f16 v[88:91], v[176:179], v[200:203], v[88:91]
    ds_read_b64 v[154:155], v52 offset:584
    v_mfma_f32_16x16x32_f16 v[92:95], v[172:175], v[208:211], v[92:95]
    ds_read_b128 v[252:255], v53 offset:3648
    buffer_load_dwordx4 a[56:59], v1, s[16:19], s59 offen offset:2048 sc1
    v_mfma_f32_16x16x32_f16 v[92:95], v[176:179], v[204:207], v[92:95]
    ds_read_b64 v[156:157], v52 offset:64
    v_mfma_f32_16x16x32_f16 v[84:87], v[160:163], v[212:215], v[84:87]
    ds_read_b64 v[158:159], v52 offset:72
    v_mfma_f32_16x16x32_f16 v[84:87], v[180:183], v[192:195], v[84:87]
    v_mfma_f32_16x16x32_f16 v[88:91], v[164:167], v[212:215], v[88:91]
    buffer_load_dwordx4 a[60:63], v1, s[16:19], s59 offen offset:3072 sc1
    v_mfma_f32_16x16x32_f16 v[88:91], v[180:183], v[196:199], v[88:91]
    v_mfma_f32_16x16x32_f16 v[92:95], v[168:171], v[212:215], v[92:95]
    v_mfma_f32_16x16x32_f16 v[92:95], v[180:183], v[200:203], v[92:95]
    v_mfma_f32_16x16x32_f16 v[88:91], v[160:163], v[216:219], v[88:91]
    s_add_u32 s59, s84, 16384
    s_or_b32 s59, s59, s96
    buffer_load_dwordx4 a[64:67], v1, s[16:19], s59 offen offset:0 sc1
    v_mfma_f32_16x16x32_f16 v[88:91], v[184:187], v[192:195], v[88:91]
    v_mfma_f32_16x16x32_f16 v[92:95], v[164:167], v[216:219], v[92:95]
    v_mfma_f32_16x16x32_f16 v[92:95], v[184:187], v[196:199], v[92:95]
    v_mfma_f32_16x16x32_f16 v[92:95], v[160:163], v[220:223], v[92:95]
    buffer_load_dwordx4 a[68:71], v1, s[16:19], s59 offen offset:1024 sc1
    v_mfma_f32_16x16x32_f16 v[92:95], v[188:191], v[192:195], v[92:95]
    s_waitcnt lgkmcnt(0)
    v_mfma_f32_16x16x32_f16 v[64:67], v[128:131], v[224:227], v[64:67]
    v_mfma_f32_16x16x32_f16 v[68:71], v[128:131], v[228:231], v[68:71]
    ds_read_b128 v[192:195], v53 offset:0
    v_mfma_f32_16x16x32_f16 v[68:71], v[132:135], v[224:227], v[68:71]
    ds_read_b64 v[160:161], v52 offset:3584
    buffer_load_dwordx4 a[72:75], v1, s[16:19], s59 offen offset:2048 sc1
    v_mfma_f32_16x16x32_f16 v[72:75], v[132:135], v[228:231], v[72:75]
    ds_read_b64 v[162:163], v52 offset:3592
    v_mfma_f32_16x16x32_f16 v[72:75], v[128:131], v[232:235], v[72:75]
    ds_read_b128 v[196:199], v53 offset:512
    v_mfma_f32_16x16x32_f16 v[72:75], v[136:139], v[224:227], v[72:75]
    ds_read_b64 v[164:165], v52 offset:3072
    v_mfma_f32_16x16x32_f16 v[76:79], v[132:135], v[232:235], v[76:79]
    ds_read_b64 v[166:167], v52 offset:3080
    buffer_load_dwordx4 a[76:79], v1, s[16:19], s59 offen offset:3072 sc1
    v_mfma_f32_16x16x32_f16 v[76:79], v[136:139], v[228:231], v[76:79]
    ds_read_b128 v[200:203], v53 offset:1024
    v_mfma_f32_16x16x32_f16 v[80:83], v[136:139], v[232:235], v[80:83]
    ds_read_b64 v[168:169], v52 offset:2560
    v_mfma_f32_16x16x32_f16 v[76:79], v[128:131], v[236:239], v[76:79]
    ds_read_b64 v[170:171], v52 offset:2568
    v_mfma_f32_16x16x32_f16 v[76:79], v[140:143], v[224:227], v[76:79]
    ds_read_b128 v[204:207], v53 offset:1536
    s_add_u32 s59, s84, 20480
    s_or_b32 s59, s59, s96
    buffer_load_dwordx4 a[80:83], v1, s[16:19], s59 offen offset:0 sc1
    v_mfma_f32_16x16x32_f16 v[80:83], v[132:135], v[236:239], v[80:83]
    ds_read_b64 v[172:173], v52 offset:2048
    v_mfma_f32_16x16x32_f16 v[80:83], v[140:143], v[228:231], v[80:83]
    ds_read_b64 v[174:175], v52 offset:2056
    v_mfma_f32_16x16x32_f16 v[84:87], v[136:139], v[236:239], v[84:87]
    ds_read_b128 v[208:211], v53 offset:2048
    v_mfma_f32_16x16x32_f16 v[84:87], v[140:143], v[232:235], v[84:87]
    ds_read_b64 v[176:177], v52 offset:1536
    buffer_load_dwordx4 a[84:87], v1, s[16:19], s59 offen offset:1024 sc1
    v_mfma_f32_16x16x32_f16 v[88:91], v[140:143], v[236:239], v[88:91]
    ds_read_b64 v[178:179], v52 offset:1544
    v_mfma_f32_16x16x32_f16 v[80:83], v[128:131], v[240:243], v[80:83]
    ds_read_b128 v[212:215], v53 offset:2560
    v_mfma_f32_16x16x32_f16 v[80:83], v[144:147], v[224:227], v[80:83]
    ds_read_b64 v[180:181], v52 offset:1024
    v_mfma_f32_16x16x32_f16 v[84:87], v[132:135], v[240:243], v[84:87]
    ds_read_b64 v[182:183], v52 offset:1032
    buffer_load_dwordx4 a[88:91], v1, s[16:19], s59 offen offset:2048 sc1
    v_mfma_f32_16x16x32_f16 v[84:87], v[144:147], v[228:231], v[84:87]
    ds_read_b128 v[216:219], v53 offset:3072
    v_mfma_f32_16x16x32_f16 v[88:91], v[136:139], v[240:243], v[88:91]
    ds_read_b64 v[184:185], v52 offset:512
    v_mfma_f32_16x16x32_f16 v[88:91], v[144:147], v[232:235], v[88:91]
    ds_read_b64 v[186:187], v52 offset:520
    v_mfma_f32_16x16x32_f16 v[92:95], v[140:143], v[240:243], v[92:95]
    ds_read_b128 v[220:223], v53 offset:3584
    buffer_load_dwordx4 a[92:95], v1, s[16:19], s59 offen offset:3072 sc1
    v_mfma_f32_16x16x32_f16 v[92:95], v[144:147], v[236:239], v[92:95]
    ds_read_b64 v[188:189], v52 offset:0
    v_mfma_f32_16x16x32_f16 v[84:87], v[128:131], v[244:247], v[84:87]
    ds_read_b64 v[190:191], v52 offset:8
    v_mfma_f32_16x16x32_f16 v[84:87], v[148:151], v[224:227], v[84:87]
    v_mfma_f32_16x16x32_f16 v[88:91], v[132:135], v[244:247], v[88:91]
    s_add_u32 s59, s84, 24576
    s_or_b32 s59, s59, s96
    buffer_load_dwordx4 a[96:99], v1, s[16:19], s59 offen offset:0 sc1
    v_mfma_f32_16x16x32_f16 v[88:91], v[148:151], v[228:231], v[88:91]
    v_mfma_f32_16x16x32_f16 v[92:95], v[136:139], v[244:247], v[92:95]
    v_mfma_f32_16x16x32_f16 v[92:95], v[148:151], v[232:235], v[92:95]
    v_mfma_f32_16x16x32_f16 v[88:91], v[128:131], v[248:251], v[88:91]
    buffer_load_dwordx4 a[100:103], v1, s[16:19], s59 offen offset:1024 sc1
    v_mfma_f32_16x16x32_f16 v[88:91], v[152:155], v[224:227], v[88:91]
    v_mfma_f32_16x16x32_f16 v[92:95], v[132:135], v[248:251], v[92:95]
    v_mfma_f32_16x16x32_f16 v[92:95], v[152:155], v[228:231], v[92:95]
    v_mfma_f32_16x16x32_f16 v[92:95], v[128:131], v[252:255], v[92:95]
    buffer_load_dwordx4 a[104:107], v1, s[16:19], s59 offen offset:2048 sc1
    v_mfma_f32_16x16x32_f16 v[92:95], v[156:159], v[224:227], v[92:95]
    s_waitcnt lgkmcnt(0)
    v_mfma_f32_16x16x32_f16 v[64:67], v[160:163], v[192:195], v[64:67]
    v_mfma_f32_16x16x32_f16 v[68:71], v[160:163], v[196:199], v[68:71]
    ds_read_b64 v[128:129], v6 offset:0
    v_mfma_f32_16x16x32_f16 v[68:71], v[164:167], v[192:195], v[68:71]
    ds_read_b64 v[130:131], v6 offset:512
    buffer_load_dwordx4 a[108:111], v1, s[16:19], s59 offen offset:3072 sc1
    v_mfma_f32_16x16x32_f16 v[72:75], v[164:167], v[196:199], v[72:75]
    ds_read_b64 v[132:133], v6 offset:1024
    v_mfma_f32_16x16x32_f16 v[72:75], v[160:163], v[200:203], v[72:75]
    ds_read_b64 v[134:135], v6 offset:1536
    v_mfma_f32_16x16x32_f16 v[72:75], v[168:171], v[192:195], v[72:75]
    v_mfma_f32_16x16x32_f16 v[76:79], v[164:167], v[200:203], v[76:79]
    s_add_u32 s59, s84, 28672
    s_or_b32 s59, s59, s96
    buffer_load_dwordx4 a[112:115], v1, s[16:19], s59 offen offset:0 sc1
    v_mfma_f32_16x16x32_f16 v[76:79], v[168:171], v[196:199], v[76:79]
    v_mfma_f32_16x16x32_f16 v[80:83], v[168:171], v[200:203], v[80:83]
    v_mfma_f32_16x16x32_f16 v[76:79], v[160:163], v[204:207], v[76:79]
    v_mfma_f32_16x16x32_f16 v[76:79], v[172:175], v[192:195], v[76:79]
    buffer_load_dwordx4 a[116:119], v1, s[16:19], s59 offen offset:1024 sc1
    v_mfma_f32_16x16x32_f16 v[80:83], v[164:167], v[204:207], v[80:83]
    s_waitcnt lgkmcnt(0)
    v_mfma_f32_16x16x32_f16 v[80:83], v[172:175], v[196:199], v[80:83]
    v_fma_mix_f32 v136, v128, v101, 0 op_sel:[0,0,0] op_sel_hi:[1,0,0]
    v_mfma_f32_16x16x32_f16 v[84:87], v[168:171], v[204:207], v[84:87]
    v_fma_mix_f32 v137, v128, v101, 0 op_sel:[1,0,0] op_sel_hi:[1,0,0]
    v_mfma_f32_16x16x32_f16 v[84:87], v[172:175], v[200:203], v[84:87]
    v_fma_mix_f32 v138, v129, v101, 0 op_sel:[0,0,0] op_sel_hi:[1,0,0]
    buffer_load_dwordx4 a[120:123], v1, s[16:19], s59 offen offset:2048 sc1
    v_mfma_f32_16x16x32_f16 v[88:91], v[172:175], v[204:207], v[88:91]
    v_fma_mix_f32 v139, v129, v101, 0 op_sel:[1,0,0] op_sel_hi:[1,0,0]
    v_mfma_f32_16x16x32_f16 v[80:83], v[160:163], v[208:211], v[80:83]
    v_fma_mix_f32 v140, v130, v101, 0 op_sel:[0,0,0] op_sel_hi:[1,0,0]
    v_mfma_f32_16x16x32_f16 v[80:83], v[176:179], v[192:195], v[80:83]
    v_fma_mix_f32 v141, v130, v101, 0 op_sel:[1,0,0] op_sel_hi:[1,0,0]
    v_mfma_f32_16x16x32_f16 v[84:87], v[164:167], v[208:211], v[84:87]
    v_fma_mix_f32 v142, v131, v101, 0 op_sel:[0,0,0] op_sel_hi:[1,0,0]
    buffer_load_dwordx4 a[124:127], v1, s[16:19], s59 offen offset:3072 sc1
    v_mfma_f32_16x16x32_f16 v[84:87], v[176:179], v[196:199], v[84:87]
    v_fma_mix_f32 v143, v131, v101, 0 op_sel:[1,0,0] op_sel_hi:[1,0,0]
    v_mfma_f32_16x16x32_f16 v[88:91], v[168:171], v[208:211], v[88:91]
    v_fma_mix_f32 v144, v132, v101, 0 op_sel:[0,0,0] op_sel_hi:[1,0,0]
    v_mfma_f32_16x16x32_f16 v[88:91], v[176:179], v[200:203], v[88:91]
    v_fma_mix_f32 v145, v132, v101, 0 op_sel:[1,0,0] op_sel_hi:[1,0,0]
    v_mfma_f32_16x16x32_f16 v[92:95], v[172:175], v[208:211], v[92:95]
    v_fma_mix_f32 v146, v133, v101, 0 op_sel:[0,0,0] op_sel_hi:[1,0,0]
    v_mfma_f32_16x16x32_f16 v[92:95], v[176:179], v[204:207], v[92:95]
    v_fma_mix_f32 v147, v133, v101, 0 op_sel:[1,0,0] op_sel_hi:[1,0,0]
    v_mfma_f32_16x16x32_f16 v[84:87], v[160:163], v[212:215], v[84:87]
    v_fma_mix_f32 v148, v134, v101, 0 op_sel:[0,0,0] op_sel_hi:[1,0,0]
    v_mfma_f32_16x16x32_f16 v[84:87], v[180:183], v[192:195], v[84:87]
    v_fma_mix_f32 v149, v134, v101, 0 op_sel:[1,0,0] op_sel_hi:[1,0,0]
    v_mfma_f32_16x16x32_f16 v[88:91], v[164:167], v[212:215], v[88:91]
    v_fma_mix_f32 v150, v135, v101, 0 op_sel:[0,0,0] op_sel_hi:[1,0,0]
    v_mfma_f32_16x16x32_f16 v[88:91], v[180:183], v[196:199], v[88:91]
    v_fma_mix_f32 v151, v135, v101, 0 op_sel:[1,0,0] op_sel_hi:[1,0,0]
    v_mfma_f32_16x16x32_f16 v[92:95], v[168:171], v[212:215], v[92:95]
    v_mfma_f32_16x16x32_f16 v[92:95], v[180:183], v[200:203], v[92:95]
    v_mfma_f32_16x16x32_f16 v[88:91], v[160:163], v[216:219], v[88:91]
    v_mfma_f32_16x16x32_f16 v[88:91], v[184:187], v[192:195], v[88:91]
    v_mfma_f32_16x16x32_f16 v[92:95], v[164:167], v[216:219], v[92:95]
    v_mfma_f32_16x16x32_f16 v[92:95], v[184:187], v[196:199], v[92:95]
    v_mfma_f32_16x16x32_f16 v[92:95], v[160:163], v[220:223], v[92:95]
    v_mfma_f32_16x16x32_f16 v[92:95], v[188:191], v[192:195], v[92:95]
    s_cmp_lg_u32 s62, 0
    s_cbranch_scc1 Lfin1_11
    s_nop 5
    ds_write_b128 v4, v[80:83] offset:0
    ds_write_b128 v4, v[84:87] offset:1024
    ds_write_b128 v4, v[88:91] offset:2048
    ds_write_b128 v4, v[92:95] offset:3072
    .p2align 3
    v_fma_f32 v136, v64, v100, v136
    v_fma_f32 v137, v65, v100, v137
    v_fma_f32 v138, v66, v100, v138
    v_fma_f32 v139, v67, v100, v139
    v_fma_f32 v140, v68, v100, v140
    v_fma_f32 v141, v69, v100, v141
    v_fma_f32 v142, v70, v100, v142
    v_fma_f32 v143, v71, v100, v143
    v_fma_f32 v144, v72, v100, v144
    v_fma_f32 v145, v73, v100, v145
    v_fma_f32 v146, v74, v100, v146
    v_fma_f32 v147, v75, v100, v147
    v_fma_f32 v148, v76, v100, v148
    v_fma_f32 v149, v77, v100, v149
    v_fma_f32 v150, v78, v100, v150
    v_fma_f32 v151, v79, v100, v151
    s_branch Lfind_12
Lfin1_11:
    s_nop 5
    ds_write_b128 v4, v[64:67] offset:0
    ds_write_b128 v4, v[68:71] offset:1024
    ds_write_b128 v4, v[72:75] offset:2048
    ds_write_b128 v4, v[76:79] offset:3072
    .p2align 3
    v_fma_f32 v136, v80, v100, v136
    v_fma_f32 v137, v81, v100, v137
    v_fma_f32 v138, v82, v100, v138
    v_fma_f32 v139, v83, v100, v139
    v_fma_f32 v140, v84, v100, v140
    v_fma_f32 v141, v85, v100, v141
    v_fma_f32 v142, v86, v100, v142
    v_fma_f32 v143, v87, v100, v143
    v_fma_f32 v144, v88, v100, v144
    v_fma_f32 v145, v89, v100, v145
    v_fma_f32 v146, v90, v100, v146
    v_fma_f32 v147, v91, v100, v147
    v_fma_f32 v148, v92, v100, v148
    v_fma_f32 v149, v93, v100, v149
    v_fma_f32 v150, v94, v100, v150
    v_fma_f32 v151, v95, v100, v151
Lfind_12:
    s_waitcnt lgkmcnt(0)
    s_barrier
    ds_read_b128 v[152:155], v5 offset:0
    ds_read_b128 v[156:159], v5 offset:1024
    ds_read_b128 v[160:163], v5 offset:2048
    ds_read_b128 v[164:167], v5 offset:3072
    s_waitcnt lgkmcnt(3)
    v_fmac_f32 v136, v152, v100
    v_fmac_f32 v137, v153, v100
    v_fmac_f32 v138, v154, v100
    v_fmac_f32 v139, v155, v100
    v_cvt_pk_bf16_f32 v128, v136, v137
    v_cvt_pk_bf16_f32 v129, v138, v139
    ds_write_b64 v7, v[128:129] offset:0
    s_waitcnt lgkmcnt(3)
    v_fmac_f32 v140, v156, v100
    v_fmac_f32 v141, v157, v100
    v_fmac_f32 v142, v158, v100
    v_fmac_f32 v143, v159, v100
    v_cvt_pk_bf16_f32 v130, v140, v141
    v_cvt_pk_bf16_f32 v131, v142, v143
    ds_write_b64 v7, v[130:131] offset:512
    s_waitcnt lgkmcnt(3)
    v_fmac_f32 v144, v160, v100
    v_fmac_f32 v145, v161, v100
    v_fmac_f32 v146, v162, v100
    v_fmac_f32 v147, v163, v100
    v_cvt_pk_bf16_f32 v132, v144, v145
    v_cvt_pk_bf16_f32 v133, v146, v147
    ds_write_b64 v7, v[132:133] offset:1024
    s_waitcnt lgkmcnt(3)
    v_fmac_f32 v148, v164, v100
    v_fmac_f32 v149, v165, v100
    v_fmac_f32 v150, v166, v100
    v_fmac_f32 v151, v167, v100
    v_cvt_pk_bf16_f32 v134, v148, v149
    v_cvt_pk_bf16_f32 v135, v150, v151
    ds_write_b64 v7, v[134:135] offset:1536
    s_waitcnt lgkmcnt(0)
    ds_read_b128 v[88:91], v8 offset:0
    ds_read_b128 v[92:95], v8 offset:1024
    s_add_u32 s45, s45, 40
    v_add_u32 v24, 5248, v24
    v_add_u32 v25, 5248, v25
    v_add_u32 v26, 5248, v26
    v_add_u32 v27, 5248, v27
    v_add_u32 v28, 5248, v28
    v_add_u32 v29, 5248, v29
    v_add_u32 v30, 5248, v30
    v_add_u32 v31, 5248, v31
    v_add_u32 v32, 5248, v32
    v_add_u32 v33, 5248, v33
    v_add_u32 v34, 5248, v34
    v_add_u32 v35, 5248, v35
    v_add_u32 v36, 5248, v36
    v_add_u32 v37, 5248, v37
    v_add_u32 v38, 5248, v38
    v_add_u32 v39, 5248, v39
    v_add_u32 v40, 5248, v40
    v_add_u32 v41, 5248, v41
    v_add_u32 v42, 5248, v42
    v_add_u32 v43, 5248, v43
    v_add_u32 v44, 5248, v44
    v_add_u32 v45, 5248, v45
    v_add_u32 v51, 5248, v51
    s_waitcnt lgkmcnt(1)
    buffer_store_dwordx4 v[88:91], v1, s[16:19], s64 offen offset:0 sc1
    s_waitcnt lgkmcnt(0)
    buffer_store_dwordx4 v[92:95], v1, s[16:19], s64 offen offset:1024 sc1
    v_accvgpr_read_b32 v2, a215
    s_mul_i32 s0, s40, 655360
    s_lshl_b32 s1, s45, 5
    s_add_u32 s0, s0, s1
    s_add_u32 s0, s0, 65536
    s_add_u32 s1, s0, 327680
    buffer_load_dwordx4 v[56:59], v2, s[16:19], s0 offen sc1
    buffer_load_dwordx4 v[60:63], v2, s[16:19], s1 offen sc1
    s_mov_b32 s60, s85
    s_sub_u32 s46, s46, 1
    s_cmp_lg_u32 s46, 1
    s_cbranch_scc1 L_conv_early
    s_cmp_eq_u32 s96, 0
    s_cbranch_scc1 L_conv_last
    s_mov_b32 s61, 0x20000
Lpoll_13:
    buffer_load_dwordx4 v[122:125], v119, s[16:19], 0 offen sc1
    s_waitcnt vmcnt(0)
    v_xor_b32 v122, v120, v122
    v_xor_b32 v123, v120, v123
    v_xor_b32 v124, v120, v124
    v_xor_b32 v125, v120, v125
    v_or3_b32 v122, v122, v123, v124
    v_or_b32 v122, v122, v125
    v_cmp_ne_u32 vcc, 0, v122
    s_cbranch_vccz Lpd_14
    s_sleep 24
    s_sub_u32 s61, s61, 1
    s_cbranch_scc0 Lpoll_13
Lpd_14:
    s_add_u32 s59, s84, 0
    buffer_load_dwordx4 a[0:3], v1, s[16:19], s59 offen offset:0 sc1
    buffer_load_dwordx4 a[4:7], v1, s[16:19], s59 offen offset:1024 sc1
    buffer_load_dwordx4 a[8:11], v1, s[16:19], s59 offen offset:2048 sc1
    buffer_load_dwordx4 a[12:15], v1, s[16:19], s59 offen offset:3072 sc1
    s_add_u32 s59, s84, 4096
    buffer_load_dwordx4 a[16:19], v1, s[16:19], s59 offen offset:0 sc1
    buffer_load_dwordx4 a[20:23], v1, s[16:19], s59 offen offset:1024 sc1
    buffer_load_dwordx4 a[24:27], v1, s[16:19], s59 offen offset:2048 sc1
    buffer_load_dwordx4 a[28:31], v1, s[16:19], s59 offen offset:3072 sc1
    s_add_u32 s59, s84, 8192
    buffer_load_dwordx4 a[32:35], v1, s[16:19], s59 offen offset:0 sc1
    buffer_load_dwordx4 a[36:39], v1, s[16:19], s59 offen offset:1024 sc1
    buffer_load_dwordx4 a[40:43], v1, s[16:19], s59 offen offset:2048 sc1
    buffer_load_dwordx4 a[44:47], v1, s[16:19], s59 offen offset:3072 sc1
    s_add_u32 s59, s84, 12288
    buffer_load_dwordx4 a[48:51], v1, s[16:19], s59 offen offset:0 sc1
    buffer_load_dwordx4 a[52:55], v1, s[16:19], s59 offen offset:1024 sc1
    buffer_load_dwordx4 a[56:59], v1, s[16:19], s59 offen offset:2048 sc1
    buffer_load_dwordx4 a[60:63], v1, s[16:19], s59 offen offset:3072 sc1
    s_add_u32 s59, s84, 16384
    buffer_load_dwordx4 a[64:67], v1, s[16:19], s59 offen offset:0 sc1
    buffer_load_dwordx4 a[68:71], v1, s[16:19], s59 offen offset:1024 sc1
    buffer_load_dwordx4 a[72:75], v1, s[16:19], s59 offen offset:2048 sc1
    buffer_load_dwordx4 a[76:79], v1, s[16:19], s59 offen offset:3072 sc1
    s_add_u32 s59, s84, 20480
    buffer_load_dwordx4 a[80:83], v1, s[16:19], s59 offen offset:0 sc1
    buffer_load_dwordx4 a[84:87], v1, s[16:19], s59 offen offset:1024 sc1
    buffer_load_dwordx4 a[88:91], v1, s[16:19], s59 offen offset:2048 sc1
    buffer_load_dwordx4 a[92:95], v1, s[16:19], s59 offen offset:3072 sc1
    s_add_u32 s59, s84, 24576
    buffer_load_dwordx4 a[96:99], v1, s[16:19], s59 offen offset:0 sc1
    buffer_load_dwordx4 a[100:103], v1, s[16:19], s59 offen offset:1024 sc1
    buffer_load_dwordx4 a[104:107], v1, s[16:19], s59 offen offset:2048 sc1
    buffer_load_dwordx4 a[108:111], v1, s[16:19], s59 offen offset:3072 sc1
    s_add_u32 s59, s84, 28672
    buffer_load_dwordx4 a[112:115], v1, s[16:19], s59 offen offset:0 sc1
    buffer_load_dwordx4 a[116:119], v1, s[16:19], s59 offen offset:1024 sc1
    buffer_load_dwordx4 a[120:123], v1, s[16:19], s59 offen offset:2048 sc1
    buffer_load_dwordx4 a[124:127], v1, s[16:19], s59 offen offset:3072 sc1
    s_branch L_conv_last
Lslow_1:
    s_mov_b32 s61, 0x20000
Lpoll_15:
    buffer_load_dwordx4 v[122:125], v118, s[16:19], 0 offen sc1
    s_waitcnt vmcnt(0)
    v_xor_b32 v122, v120, v122
    v_xor_b32 v123, v120, v123
    v_xor_b32 v124, v120, v124
    v_xor_b32 v125, v120, v125
    v_or3_b32 v122, v122, v123, v124
    v_or_b32 v122, v122, v125
    v_cmp_ne_u32 vcc, 0, v122
    s_cbranch_vccz Lpd_16
    s_sleep 20
    s_sub_u32 s61, s61, 1
    s_cbranch_scc0 Lpoll_15
Lpd_16:
    s_mov_b32 s61, 0x20000
Lpoll_17:
    buffer_load_dwordx4 v[122:125], v119, s[16:19], 0 offen sc1
    s_waitcnt vmcnt(0)
    v_xor_b32 v122, v120, v122
    v_xor_b32 v123, v120, v123
    v_xor_b32 v124, v120, v124
    v_xor_b32 v125, v120, v125
    v_or3_b32 v122, v122, v123, v124
    v_or_b32 v122, v122, v125
    v_cmp_ne_u32 vcc, 0, v122
    s_cbranch_vccz Lpd_18
    s_sleep 20
    s_sub_u32 s61, s61, 1
    s_cbranch_scc0 Lpoll_17
Lpd_18:
    s_branch Lback_2
Lslow_7:
    s_mov_b32 s61, 0x20000
Lpoll_19:
    buffer_load_dwordx4 v[122:125], v119, s[16:19], 0 offen sc1
    s_waitcnt vmcnt(0)
    v_xor_b32 v122, v120, v122
    v_xor_b32 v123, v120, v123
    v_xor_b32 v124, v120, v124
    v_xor_b32 v125, v120, v125
    v_or3_b32 v122, v122, v123, v124
    v_or_b32 v122, v122, v125
    v_cmp_ne_u32 vcc, 0, v122
    s_cbranch_vccz Lpd_20
    s_sleep 20
    s_sub_u32 s61, s61, 1
    s_cbranch_scc0 Lpoll_19
Lpd_20:
    s_branch Lback_8
.p2align 7
.type L_tab,@object
L_tab:
.long 0,0,0,69632,0,0,0,69648,0,0,0,69664,0,0,0,69680
.long 0,0,0,69696,0,0,0,69712,0,0,0,69728,0,0,0,69744
.long 0,0,0,69760,0,0,0,69776,0,0,0,69792,0,0,0,69808
.long 0,0,0,69824,0,0,0,69840,0,0,0,69856,0,0,0,69872
.long 0,0,0,82944,0,0,0,82960,0,0,0,87104,0,0,0,87120
.long 0,0,0,82944,0,0,0,82960,0,0,0,87104,0,0,0,87120
.long 0,0,0,82944,0,0,0,82960,0,0,0,87104,0,0,0,87120
.long 0,0,0,82944,0,0,0,82960,0,0,0,87104,0,0,0,87120
.long 0,0,0,82944,0,0,0,82960,0,0,0,87104,0,0,0,87120
.long 0,0,0,82944,0,0,0,82960,0,0,0,87104,0,0,0,87120
.long 0,0,0,82944,0,0,0,82960,0,0,0,87104,0,0,0,87120
.long 0,0,0,82944,0,0,0,82960,0,0,0,87104,0,0,0,87120
.long 0,0,0,82944,0,0,0,82960,0,0,0,87104,0,0,0,87120
.long 0,0,0,82944,0,0,0,82960,0,0,0,87104,0,0,0,87120
.long 0,0,0,82944,0,0,0,82960,0,0,0,87104,0,0,0,87120
.long 0,0,0,82944,0,0,0,82960,0,0,0,87104,0,0,0,87120
.long 78848,70144,157696,91608,78864,74752,157696,87448,78880,70160,157696,83288,78896,74768,157696,79128
.long 78912,70176,157696,91600,78928,74784,157696,87440,78944,70192,157696,83280,78960,74800,157696,79120
.long 78976,70208,157696,91592,78992,74816,157696,87432,79008,70224,157696,83272,79024,74832,157696,79112
.long 79040,70240,157696,91584,79056,74848,157696,87424,79072,70256,157696,83264,79088,74864,157696,79104
.long 79104,70272,157696,91624,79120,74880,157696,87464,79136,70288,157696,83304,79152,74896,157696,79144
.long 79168,70304,157696,91616,79184,74912,157696,87456,79200,70320,157696,83296,79216,74928,157696,79136
.long 79232,70336,157696,91608,79248,74944,157696,87448,79264,70352,157696,83288,79280,74960,157696,79128
.long 79296,70368,157696,91600,79312,74976,157696,87440,79328,70384,157696,83280,79344,74992,157696,79120
.long 79360,70400,157696,91640,79376,75008,157696,87480,79392,70416,157696,83320,79408,75024,157696,79160
.long 79424,70432,157696,91632,79440,75040,157696,87472,79456,70448,157696,83312,79472,75056,157696,79152
.long 79488,70464,157696,91624,79504,75072,157696,87464,79520,70480,157696,83304,79536,75088,157696,79144
.long 79552,70496,157696,91616,79568,75104,157696,87456,79584,70512,157696,83296,79600,75120,157696,79136
.long 79616,70528,157696,91656,79632,75136,157696,87496,79648,70544,157696,83336,79664,75152,157696,79176
.long 79680,70560,157696,91648,79696,75168,157696,87488,79712,70576,157696,83328,79728,75184,157696,79168
.long 79744,70592,157696,91640,79760,75200,157696,87480,79776,70608,157696,83320,79792,75216,157696,79160
.long 79808,70624,157696,91632,79824,75232,157696,87472,79840,70640,157696,83312,79856,75248,157696,79152
.long 69920,0,4096,70144,69952,16,4112,70176,69984,32,4128,70208,70016,48,4144,70240
.long 70048,64,4160,70272,70080,80,4176,70304,70112,96,4192,70336,70144,112,4208,70368
.long 70176,128,4224,70400,70208,144,4240,70432,70240,160,4256,70464,70272,176,4272,70496
.long 70304,192,4288,70528,70336,208,4304,70560,70368,224,4320,70592,70400,240,4336,70624
.long 69936,256,4352,70152,69968,272,4368,70184,70000,288,4384,70216,70032,304,4400,70248
.long 70064,320,4416,70280,70096,336,4432,70312,70128,352,4448,70344,70160,368,4464,70376
.long 70192,384,4480,70408,70224,400,4496,70440,70256,416,4512,70472,70288,432,4528,70504
.long 70320,448,4544,70536,70352,464,4560,70568,70384,480,4576,70600,70416,496,4592,70632
.long 69952,512,4608,70160,69984,528,4624,70192,70016,544,4640,70224,70048,560,4656,70256
.long 70080,576,4672,70288,70112,592,4688,70320,70144,608,4704,70352,70176,624,4720,70384
.long 70208,640,4736,70416,70240,656,4752,70448,70272,672,4768,70480,70304,688,4784,70512
.long 70336,704,4800,70544,70368,720,4816,70576,70400,736,4832,70608,70432,752,4848,70640
.long 69968,768,4864,70168,70000,784,4880,70200,70032,800,4896,70232,70064,816,4912,70264
.long 70096,832,4928,70296,70128,848,4944,70328,70160,864,4960,70360,70192,880,4976,70392
.long 70224,896,4992,70424,70256,912,5008,70456,70288,928,5024,70488,70320,944,5040,70520
.long 70352,960,5056,70552,70384,976,5072,70584,70416,992,5088,70616,70448,1008,5104,70648
.long 16384,16384,39936,60416,16416,16400,39952,60432,16448,16416,39968,60448,16480,16432,39984,60464
.long 16512,16448,40000,60480,16544,16464,40016,60496,16576,16480,40032,60512,16608,16496,40048,60528
.long 16640,16512,40064,60544,16672,16528,40080,60560,16704,16544,40096,60576,16736,16560,40112,60592
.long 16768,16576,40128,60608,16800,16592,40144,60624,16832,16608,40160,60640,16864,16624,40176,60656
.long 16392,16640,40192,60672,16424,16656,40208,60688,16456,16672,40224,60704,16488,16688,40240,60720
.long 16520,16704,40256,60736,16552,16720,40272,60752,16584,16736,40288,60768,16616,16752,40304,60784
.long 16648,16768,40320,60800,16680,16784,40336,60816,16712,16800,40352,60832,16744,16816,40368,60848
.long 16776,16832,40384,60864,16808,16848,40400,60880,16840,16864,40416,60896,16872,16880,40432,60912
.long 16400,16896,40448,60928,16432,16912,40464,60944,16464,16928,40480,60960,16496,16944,40496,60976
.long 16528,16960,40512,60992,16560,16976,40528,61008,16592,16992,40544,61024,16624,17008,40560,61040
.long 16656,17024,40576,61056,16688,17040,40592,61072,16720,17056,40608,61088,16752,17072,40624,61104
.long 16784,17088,40640,61120,16816,17104,40656,61136,16848,17120,40672,61152,16880,17136,40688,61168
.long 16408,17152,40704,61184,16440,17168,40720,61200,16472,17184,40736,61216,16504,17200,40752,61232
.long 16536,17216,40768,61248,16568,17232,40784,61264,16600,17248,40800,61280,16632,17264,40816,61296
.long 16664,17280,40832,61312,16696,17296,40848,61328,16728,17312,40864,61344,16760,17328,40880,61360
.long 16792,17344,40896,61376,16824,17360,40912,61392,16856,17376,40928,61408,16888,17392,40944,61424
.long 80896,0,7744,15488,80912,16,7760,15504,80928,32,7776,16640,80944,48,7792,16656
.long 80960,64,7808,16672,80976,80,7824,16688,80992,96,8960,16704,81008,112,8976,16720
.long 81024,128,8992,16736,81040,144,9008,16752,81056,1280,9024,16768,81072,1296,9040,16784
.long 81088,1312,9056,17920,81104,1328,9072,17936,81120,1344,9088,17952,81136,1360,9104,17968
.long 81152,1376,10240,17984,81168,1392,10256,18000,81184,1408,10272,18016,81200,1424,10288,18032
.long 81216,2560,10304,18048,81232,2576,10320,18064,81248,2592,10336,19200,81264,2608,10352,19216
.long 81280,2624,10368,19232,81296,2640,10384,19248,81312,2656,11520,19264,81328,2672,11536,19280
.long 81344,2688,11552,19296,81360,2704,11568,19312,81376,3840,11584,19328,81392,3856,11600,19344
.long 81408,3872,11616,20480,81424,3888,11632,20496,81440,3904,11648,20512,81456,3920,11664,20528
.long 81472,3936,12800,20544,81488,3952,12816,20560,81504,3968,12832,20576,81520,3984,12848,20592
.long 81536,5120,12864,20608,81552,5136,12880,20624,81568,5152,12896,21760,81584,5168,12912,21776
.long 81600,5184,12928,21792,81616,5200,12944,21808,81632,5216,14080,21824,81648,5232,14096,21840
.long 81664,5248,14112,21856,81680,5264,14128,21872,81696,6400,14144,21888,81712,6416,14160,21904
.long 81728,6432,14176,23040,81744,6448,14192,23056,81760,6464,14208,23072,81776,6480,14224,23088
.long 81792,6496,15360,23104,81808,6512,15376,23120,81824,6528,15392,23136,81840,6544,15408,23152
.long 81856,7680,15424,23168,81872,7696,15440,23184,81888,7712,15456,24320,81904,7728,15472,24336
.long 15488,0,0,0,15504,0,0,16,16640,0,0,10240,16656,0,0,10256
.long 16672,0,0,20480,16688,0,0,20496,16704,0,0,30720,16720,0,0,30736
.long 16736,0,0,40960,16752,0,0,40976,16768,0,0,51200,16784,0,0,51216
.long 17920,0,0,61440,17936,0,0,61456,17952,0,0,71680,17968,0,0,71696
.long 17984,0,0,81920,18000,0,0,81936,18016,0,0,92160,18032,0,0,92176
.long 18048,0,0,102400,18064,0,0,102416,19200,0,0,112640,19216,0,0,112656
.long 19232,0,0,122880,19248,0,0,122896,19264,0,0,133120,19280,0,0,133136
.long 19296,0,0,143360,19312,0,0,143376,19328,0,0,153600,19344,0,0,153616
.long 2147418112,0,0,163840,2147418112,0,0,163856,2147418112,0,0,174080,2147418112,0,0,174096
.long 2147418112,0,0,184320,2147418112,0,0,184336,2147418112,0,0,194560,2147418112,0,0,194576
.long 2147418112,0,0,204800,2147418112,0,0,204816,2147418112,0,0,215040,2147418112,0,0,215056
.long 2147418112,0,0,225280,2147418112,0,0,225296,2147418112,0,0,235520,2147418112,0,0,235536
.long 2147418112,0,0,245760,2147418112,0,0,245776,2147418112,0,0,256000,2147418112,0,0,256016
.long 2147418112,0,0,266240,2147418112,0,0,266256,2147418112,0,0,276480,2147418112,0,0,276496
.long 2147418112,0,0,286720,2147418112,0,0,286736,2147418112,0,0,296960,2147418112,0,0,296976
.long 2147418112,0,0,307200,2147418112,0,0,307216,2147418112,0,0,317440,2147418112,0,0,317456
.long 160260,160260,160260,160260,160256,160256,160256,160252,160252,160252,160252,160252,160248,160248,160248,160244
.long 160244,160244,160244,160244,160240,160240,160240,160236,160236,160236,160236,160236,160232,160232,160232,160228
.long 160228,160228,160228,160228,160224,160224,160224,160220,160220,160220,160220,160220,160216,160216,160216,160212
.long 160212,160212,160212,160212,160208,160208,160208,160204,160204,160204,160204,160204,160200,160200,160200,160196
.long 160196,160196,160196,160196,160192,160192,160192,160188,160188,160188,160188,160188,160184,160184,160184,160180
.long 160180,160180,160180,160180,160176,160176,160176,160172,160172,160172,160172,160172,160168,160168,160168,160164
.long 160164,160164,160164,160164,160160,160160,160160,160156,160156,160156,160156,160156,160152,160152,160152,160148
.long 160148,160148,160148,160148,160144,160144,160144,160140,160140,160140,160140,160140,160136,160136,160136,160132
.long 160132,160132,160132,160132,160128,160128,160128,160124,160124,160124,160124,160124,160120,160120,160120,160116
.long 160116,160116,160116,160116,160112,160112,160112,160108,160108,160108,160108,160108,160104,160104,160104,160100
.long 160100,160100,160100,160100,160096,160096,160096,160092,160092,160092,160092,160092,160088,160088,160088,160084
.long 160084,160084,160084,160084,160080,160080,160080,160076,160076,160076,160076,160076,160072,160072,160072,160068
.long 160068,160068,160068,160068,160064,160064,160064,160060,160060,160060,160060,160060,160056,160056,160056,160052
.long 160052,160052,160052,160052,160048,160048,160048,160044,160044,160044,160044,160044,160040,160040,160040,160036
.long 160036,160036,160036,160036,160032,160032,160032,160028,160028,160028,160028,160028,160024,160024,160024,160020
.long 160020,160020,160020,160020,160016,160016,160016,160012,160012,160012,160012,160012,160008,160008,160008,160004
.long 160256,160256,160256,160256,160252,160252,160252,160252,160248,160248,160248,160248,160244,160244,160244,160244
.long 160240,160240,160240,160240,160236,160236,160236,160236,160232,160232,160232,160232,160228,160228,160228,160228
.long 160224,160224,160224,160224,160220,160220,160220,160220,160216,160216,160216,160216,160212,160212,160212,160212
.long 160208,160208,160208,160208,160204,160204,160204,160204,160200,160200,160200,160200,160196,160196,160196,160196
.long 160192,160192,160192,160192,160188,160188,160188,160188,160184,160184,160184,160184,160180,160180,160180,160180
.long 160176,160176,160176,160176,160172,160172,160172,160172,160168,160168,160168,160168,160164,160164,160164,160164
.long 160160,160160,160160,160160,160156,160156,160156,160156,160152,160152,160152,160152,160148,160148,160148,160148
.long 160144,160144,160144,160144,160140,160140,160140,160140,160136,160136,160136,160136,160132,160132,160132,160132
.long 160128,160128,160128,160128,160124,160124,160124,160124,160120,160120,160120,160120,160116,160116,160116,160116
.long 160112,160112,160112,160112,160108,160108,160108,160108,160104,160104,160104,160104,160100,160100,160100,160100
.long 160096,160096,160096,160096,160092,160092,160092,160092,160088,160088,160088,160088,160084,160084,160084,160084
.long 160080,160080,160080,160080,160076,160076,160076,160076,160072,160072,160072,160072,160068,160068,160068,160068
.long 160064,160064,160064,160064,160060,160060,160060,160060,160056,160056,160056,160056,160052,160052,160052,160052
.long 160048,160048,160048,160048,160044,160044,160044,160044,160040,160040,160040,160040,160036,160036,160036,160036
.long 160032,160032,160032,160032,160028,160028,160028,160028,160024,160024,160024,160024,160020,160020,160020,160020
.long 160016,160016,160016,160016,160012,160012,160012,160012,160008,160008,160008,160008,160004,160004,160004,160004
.long 160256,160256,160256,160004,160252,160252,160252,160000,160248,160248,160248,159996,160244,160244,160244,159992
.long 160240,160240,160240,159988,160236,160236,160236,159984,160232,160232,160232,159980,160228,160228,160228,159976
.long 160224,160224,160224,159972,160220,160220,160220,159968,160216,160216,160216,159964,160212,160212,160212,159960
.long 160208,160208,160208,159956,160204,160204,160204,159952,160200,160200,160200,159948,160196,160196,160196,159944
.long 160192,160192,160192,159940,160188,160188,160188,159936,160184,160184,160184,159932,160180,160180,160180,159928
.long 160176,160176,160176,159924,160172,160172,160172,159920,160168,160168,160168,159916,160164,160164,160164,159912
.long 160160,160160,160160,159908,160156,160156,160156,159904,160152,160152,160152,159900,160148,160148,160148,159896
.long 160144,160144,160144,159892,160140,160140,160140,159888,160136,160136,160136,159884,160132,160132,160132,159880
.long 160128,160128,160128,159876,160124,160124,160124,159872,160120,160120,160120,159868,160116,160116,160116,159864
.long 160112,160112,160112,159860,160108,160108,160108,159856,160104,160104,160104,159852,160100,160100,160100,159848
.long 160096,160096,160096,159844,160092,160092,160092,159840,160088,160088,160088,159836,160084,160084,160084,159832
.long 160080,160080,160080,159828,160076,160076,160076,159824,160072,160072,160072,159820,160068,160068,160068,159816
.long 160064,160064,160064,159812,160060,160060,160060,159808,160056,160056,160056,159804,160052,160052,160052,159800
.long 160048,160048,160048,159796,160044,160044,160044,159792,160040,160040,160040,159788,160036,160036,160036,159784
.long 160032,160032,160032,159780,160028,160028,160028,159776,160024,160024,160024,159772,160020,160020,160020,159768
.long 160016,160016,160016,159764,160012,160012,160012,159760,160008,160008,160008,159756,160004,160004,160004,159752
.long 160004,160004,160004,160000,160000,160000,159996,159996,159996,159996,159996,159992,159992,159992,159988,159988
.long 159988,159988,159988,159984,159984,159984,159980,159980,159980,159980,159980,159976,159976,159976,159972,159972
.long 159972,159972,159972,159968,159968,159968,159964,159964,159964,159964,159964,159960,159960,159960,159956,159956
.long 159956,159956,159956,159952,159952,159952,159948,159948,159948,159948,159948,159944,159944,159944,159940,159940
.long 159940,159940,159940,159936,159936,159936,159932,159932,159932,159932,159932,159928,159928,159928,159924,159924
.long 159924,159924,159924,159920,159920,159920,159916,159916,159916,159916,159916,159912,159912,159912,159908,159908
.long 159908,159908,159908,159904,159904,159904,159900,159900,159900,159900,159900,159896,159896,159896,159892,159892
.long 159892,159892,159892,159888,159888,159888,159884,159884,159884,159884,159884,159880,159880,159880,159876,159876
.long 159876,159876,159876,159872,159872,159872,159868,159868,159868,159868,159868,159864,159864,159864,159860,159860
.long 159860,159860,159860,159856,159856,159856,159852,159852,159852,159852,159852,159848,159848,159848,159844,159844
.long 159844,159844,159844,159840,159840,159840,159836,159836,159836,159836,159836,159832,159832,159832,159828,159828
.long 159828,159828,159828,159824,159824,159824,159820,159820,159820,159820,159820,159816,159816,159816,159812,159812
.long 159812,159812,159812,159808,159808,159808,159804,159804,159804,159804,159804,159800,159800,159800,159796,159796
.long 159796,159796,159796,159792,159792,159792,159788,159788,159788,159788,159788,159784,159784,159784,159780,159780
.long 159780,159780,159780,159776,159776,159776,159772,159772,159772,159772,159772,159768,159768,159768,159764,159764
.long 159764,159764,159764,159760,159760,159760,159756,159756,159756,159756,159756,159752,159752,159752,159748,159748
.long 160000,160000,160000,160000,159996,159996,159996,159996,159992,159992,159992,159992,159988,159988,159988,159988
.long 159984,159984,159984,159984,159980,159980,159980,159980,159976,159976,159976,159976,159972,159972,159972,159972
.long 159968,159968,159968,159968,159964,159964,159964,159964,159960,159960,159960,159960,159956,159956,159956,159956
.long 159952,159952,159952,159952,159948,159948,159948,159948,159944,159944,159944,159944,159940,159940,159940,159940
.long 159936,159936,159936,159936,159932,159932,159932,159932,159928,159928,159928,159928,159924,159924,159924,159924
.long 159920,159920,159920,159920,159916,159916,159916,159916,159912,159912,159912,159912,159908,159908,159908,159908
.long 159904,159904,159904,159904,159900,159900,159900,159900,159896,159896,159896,159896,159892,159892,159892,159892
.long 159888,159888,159888,159888,159884,159884,159884,159884,159880,159880,159880,159880,159876,159876,159876,159876
.long 159872,159872,159872,159872,159868,159868,159868,159868,159864,159864,159864,159864,159860,159860,159860,159860
.long 159856,159856,159856,159856,159852,159852,159852,159852,159848,159848,159848,159848,159844,159844,159844,159844
.long 159840,159840,159840,159840,159836,159836,159836,159836,159832,159832,159832,159832,159828,159828,159828,159828
.long 159824,159824,159824,159824,159820,159820,159820,159820,159816,159816,159816,159816,159812,159812,159812,159812
.long 159808,159808,159808,159808,159804,159804,159804,159804,159800,159800,159800,159800,159796,159796,159796,159796
.long 159792,159792,159792,159792,159788,159788,159788,159788,159784,159784,159784,159784,159780,159780,159780,159780
.long 159776,159776,159776,159776,159772,159772,159772,159772,159768,159768,159768,159768,159764,159764,159764,159764
.long 159760,159760,159760,159760,159756,159756,159756,159756,159752,159752,159752,159752,159748,159748,159748,159748
.long 160000,160000,0,0,159996,159996,0,0,159992,159992,0,0,159988,159988,0,0
.long 159984,159984,0,0,159980,159980,0,0,159976,159976,0,0,159972,159972,0,0
.long 159968,159968,0,0,159964,159964,0,0,159960,159960,0,0,159956,159956,0,0
.long 159952,159952,0,0,159948,159948,0,0,159944,159944,0,0,159940,159940,0,0
.long 159936,159936,0,0,159932,159932,0,0,159928,159928,0,0,159924,159924,0,0
.long 159920,159920,0,0,159916,159916,0,0,159912,159912,0,0,159908,159908,0,0
.long 159904,159904,0,0,159900,159900,0,0,159896,159896,0,0,159892,159892,0,0
.long 159888,159888,0,0,159884,159884,0,0,159880,159880,0,0,159876,159876,0,0
.long 159872,159872,0,0,159868,159868,0,0,159864,159864,0,0,159860,159860,0,0
.long 159856,159856,0,0,159852,159852,0,0,159848,159848,0,0,159844,159844,0,0
.long 159840,159840,0,0,159836,159836,0,0,159832,159832,0,0,159828,159828,0,0
.long 159824,159824,0,0,159820,159820,0,0,159816,159816,0,0,159812,159812,0,0
.long 159808,159808,0,0,159804,159804,0,0,159800,159800,0,0,159796,159796,0,0
.long 159792,159792,0,0,159788,159788,0,0,159784,159784,0,0,159780,159780,0,0
.long 159776,159776,0,0,159772,159772,0,0,159768,159768,0,0,159764,159764,0,0
.long 159760,159760,0,0,159756,159756,0,0,159752,159752,0,0,159748,159744,0,0
.long 0,0,0,69888,0,0,0,69904,0,0,0,69920,0,0,0,69936
.long 0,0,0,69952,0,0,0,69968,0,0,0,69984,0,0,0,70000
.long 0,0,0,70016,0,0,0,70032,0,0,0,70048,0,0,0,70064
.long 0,0,0,70080,0,0,0,70096,0,0,0,70112,0,0,0,70128
.long 0,0,0,91264,0,0,0,91280,0,0,0,95424,0,0,0,95440
.long 0,0,0,91264,0,0,0,91280,0,0,0,95424,0,0,0,95440
.long 0,0,0,91264,0,0,0,91280,0,0,0,95424,0,0,0,95440
.long 0,0,0,91264,0,0,0,91280,0,0,0,95424,0,0,0,95440
.long 0,0,0,91264,0,0,0,91280,0,0,0,95424,0,0,0,95440
.long 0,0,0,91264,0,0,0,91280,0,0,0,95424,0,0,0,95440
.long 0,0,0,91264,0,0,0,91280,0,0,0,95424,0,0,0,95440
.long 0,0,0,91264,0,0,0,91280,0,0,0,95424,0,0,0,95440
.long 0,0,0,91264,0,0,0,91280,0,0,0,95424,0,0,0,95440
.long 0,0,0,91264,0,0,0,91280,0,0,0,95424,0,0,0,95440
.long 0,0,0,91264,0,0,0,91280,0,0,0,95424,0,0,0,95440
.long 0,0,0,91264,0,0,0,91280,0,0,0,95424,0,0,0,95440
.long 80896,71168,157696,91352,80912,75776,157696,87192,80928,71184,157696,83032,80944,75792,157696,78872
.long 80960,71200,157696,91344,80976,75808,157696,87184,80992,71216,157696,83024,81008,75824,157696,78864
.long 81024,71232,157696,91336,81040,75840,157696,87176,81056,71248,157696,83016,81072,75856,157696,78856
.long 81088,71264,157696,91328,81104,75872,157696,87168,81120,71280,157696,83008,81136,75888,157696,78848
.long 81152,71296,157696,91368,81168,75904,157696,87208,81184,71312,157696,83048,81200,75920,157696,78888
.long 81216,71328,157696,91360,81232,75936,157696,87200,81248,71344,157696,83040,81264,75952,157696,78880
.long 81280,71360,157696,91352,81296,75968,157696,87192,81312,71376,157696,83032,81328,75984,157696,78872
.long 81344,71392,157696,91344,81360,76000,157696,87184,81376,71408,157696,83024,81392,76016,157696,78864
.long 81408,71424,157696,91384,81424,76032,157696,87224,81440,71440,157696,83064,81456,76048,157696,78904
.long 81472,71456,157696,91376,81488,76064,157696,87216,81504,71472,157696,83056,81520,76080,157696,78896
.long 81536,71488,157696,91368,81552,76096,157696,87208,81568,71504,157696,83048,81584,76112,157696,78888
.long 81600,71520,157696,91360,81616,76128,157696,87200,81632,71536,157696,83040,81648,76144,157696,78880
.long 81664,71552,157696,91400,81680,76160,157696,87240,81696,71568,157696,83080,81712,76176,157696,78920
.long 81728,71584,157696,91392,81744,76192,157696,87232,81760,71600,157696,83072,81776,76208,157696,78912
.long 81792,71616,157696,91384,81808,76224,157696,87224,81824,71632,157696,83064,81840,76240,157696,78904
.long 81856,71648,157696,91376,81872,76256,157696,87216,81888,71664,157696,83056,81904,76272,157696,78896
.long 69664,4096,0,72192,69696,4112,16,72224,69728,4128,32,72256,69760,4144,48,72288
.long 69792,4160,64,72320,69824,4176,80,72352,69856,4192,96,72384,69888,4208,112,72416
.long 69920,4224,128,72448,69952,4240,144,72480,69984,4256,160,72512,70016,4272,176,72544
.long 70048,4288,192,72576,70080,4304,208,72608,70112,4320,224,72640,70144,4336,240,72672
.long 69680,4352,256,72200,69712,4368,272,72232,69744,4384,288,72264,69776,4400,304,72296
.long 69808,4416,320,72328,69840,4432,336,72360,69872,4448,352,72392,69904,4464,368,72424
.long 69936,4480,384,72456,69968,4496,400,72488,70000,4512,416,72520,70032,4528,432,72552
.long 70064,4544,448,72584,70096,4560,464,72616,70128,4576,480,72648,70160,4592,496,72680
.long 69696,4608,512,72208,69728,4624,528,72240,69760,4640,544,72272,69792,4656,560,72304
.long 69824,4672,576,72336,69856,4688,592,72368,69888,4704,608,72400,69920,4720,624,72432
.long 69952,4736,640,72464,69984,4752,656,72496,70016,4768,672,72528,70048,4784,688,72560
.long 70080,4800,704,72592,70112,4816,720,72624,70144,4832,736,72656,70176,4848,752,72688
.long 69712,4864,768,72216,69744,4880,784,72248,69776,4896,800,72280,69808,4912,816,72312
.long 69840,4928,832,72344,69872,4944,848,72376,69904,4960,864,72408,69936,4976,880,72440
.long 69968,4992,896,72472,70000,5008,912,72504,70032,5024,928,72536,70064,5040,944,72568
.long 70096,5056,960,72600,70128,5072,976,72632,70160,5088,992,72664,70192,5104,1008,72696
.long 18432,18432,55296,75776,18464,18448,55312,75792,18496,18464,55328,75808,18528,18480,55344,75824
.long 18560,18496,55360,75840,18592,18512,55376,75856,18624,18528,55392,75872,18656,18544,55408,75888
.long 18688,18560,55424,75904,18720,18576,55440,75920,18752,18592,55456,75936,18784,18608,55472,75952
.long 18816,18624,55488,75968,18848,18640,55504,75984,18880,18656,55520,76000,18912,18672,55536,76016
.long 18440,18688,55552,76032,18472,18704,55568,76048,18504,18720,55584,76064,18536,18736,55600,76080
.long 18568,18752,55616,76096,18600,18768,55632,76112,18632,18784,55648,76128,18664,18800,55664,76144
.long 18696,18816,55680,76160,18728,18832,55696,76176,18760,18848,55712,76192,18792,18864,55728,76208
.long 18824,18880,55744,76224,18856,18896,55760,76240,18888,18912,55776,76256,18920,18928,55792,76272
.long 18448,18944,55808,76288,18480,18960,55824,76304,18512,18976,55840,76320,18544,18992,55856,76336
.long 18576,19008,55872,76352,18608,19024,55888,76368,18640,19040,55904,76384,18672,19056,55920,76400
.long 18704,19072,55936,76416,18736,19088,55952,76432,18768,19104,55968,76448,18800,19120,55984,76464
.long 18832,19136,56000,76480,18864,19152,56016,76496,18896,19168,56032,76512,18928,19184,56048,76528
.long 18456,19200,56064,76544,18488,19216,56080,76560,18520,19232,56096,76576,18552,19248,56112,76592
.long 18584,19264,56128,76608,18616,19280,56144,76624,18648,19296,56160,76640,18680,19312,56176,76656
.long 18712,19328,56192,76672,18744,19344,56208,76688,18776,19360,56224,76704,18808,19376,56240,76720
.long 18840,19392,56256,76736,18872,19408,56272,76752,18904,19424,56288,76768,18936,19440,56304,76784
.long 34816,0,7744,15488,34832,16,7760,15504,34848,32,7776,16640,34864,48,7792,16656
.long 34880,64,7808,16672,34896,80,7824,16688,34912,96,8960,16704,34928,112,8976,16720
.long 34944,128,8992,16736,34960,144,9008,16752,34976,1280,9024,16768,34992,1296,9040,16784
.long 35008,1312,9056,17920,35024,1328,9072,17936,35040,1344,9088,17952,35056,1360,9104,17968
.long 35072,1376,10240,17984,35088,1392,10256,18000,35104,1408,10272,18016,35120,1424,10288,18032
.long 35136,2560,10304,18048,35152,2576,10320,18064,35168,2592,10336,19200,35184,2608,10352,19216
.long 35200,2624,10368,19232,35216,2640,10384,19248,35232,2656,11520,19264,35248,2672,11536,19280
.long 35264,2688,11552,19296,35280,2704,11568,19312,35296,3840,11584,19328,35312,3856,11600,19344
.long 35328,3872,11616,20480,35344,3888,11632,20496,35360,3904,11648,20512,35376,3920,11664,20528
.long 35392,3936,12800,20544,35408,3952,12816,20560,35424,3968,12832,20576,35440,3984,12848,20592
.long 35456,5120,12864,20608,35472,5136,12880,20624,35488,5152,12896,21760,35504,5168,12912,21776
.long 35520,5184,12928,21792,35536,5200,12944,21808,35552,5216,14080,21824,35568,5232,14096,21840
.long 35584,5248,14112,21856,35600,5264,14128,21872,35616,6400,14144,21888,35632,6416,14160,21904
.long 35648,6432,14176,23040,35664,6448,14192,23056,35680,6464,14208,23072,35696,6480,14224,23088
.long 35712,6496,15360,23104,35728,6512,15376,23120,35744,6528,15392,23136,35760,6544,15408,23152
.long 35776,7680,15424,23168,35792,7696,15440,23184,35808,7712,15456,24320,35824,7728,15472,24336
.long 15488,0,0,0,15504,0,0,16,16640,0,0,10240,16656,0,0,10256
.long 16672,0,0,20480,16688,0,0,20496,16704,0,0,30720,16720,0,0,30736
.long 16736,0,0,40960,16752,0,0,40976,16768,0,0,51200,16784,0,0,51216
.long 17920,0,0,61440,17936,0,0,61456,17952,0,0,71680,17968,0,0,71696
.long 17984,0,0,81920,18000,0,0,81936,18016,0,0,92160,18032,0,0,92176
.long 18048,0,0,102400,18064,0,0,102416,19200,0,0,112640,19216,0,0,112656
.long 19232,0,0,122880,19248,0,0,122896,19264,0,0,133120,19280,0,0,133136
.long 19296,0,0,143360,19312,0,0,143376,19328,0,0,153600,19344,0,0,153616
.long 2147418112,0,0,163840,2147418112,0,0,163856,2147418112,0,0,174080,2147418112,0,0,174096
.long 2147418112,0,0,184320,2147418112,0,0,184336,2147418112,0,0,194560,2147418112,0,0,194576
.long 2147418112,0,0,204800,2147418112,0,0,204816,2147418112,0,0,215040,2147418112,0,0,215056
.long 2147418112,0,0,225280,2147418112,0,0,225296,2147418112,0,0,235520,2147418112,0,0,235536
.long 2147418112,0,0,245760,2147418112,0,0,245776,2147418112,0,0,256000,2147418112,0,0,256016
.long 2147418112,0,0,266240,2147418112,0,0,266256,2147418112,0,0,276480,2147418112,0,0,276496
.long 2147418112,0,0,286720,2147418112,0,0,286736,2147418112,0,0,296960,2147418112,0,0,296976
.long 2147418112,0,0,307200,2147418112,0,0,307216,2147418112,0,0,317440,2147418112,0,0,317456
.long 159748,159748,159744,159744,159740,159740,159736,159736,159732,159732,159728,159728,159724,159724,159720,159720
.long 159716,159716,159712,159712,159708,159708,159704,159704,159700,159700,159696,159696,159692,159692,159688,159688
.long 159684,159684,159680,159680,159676,159676,159672,159672,159668,159668,159664,159664,159660,159660,159656,159656
.long 159652,159652,159648,159648,159644,159644,159640,159640,159636,159636,159632,159632,159628,159628,159624,159624
.long 159620,159620,159616,159616,159612,159612,159608,159608,159604,159604,159600,159600,159596,159596,159592,159592
.long 159588,159588,159584,159584,159580,159580,159576,159576,159572,159572,159568,159568,159564,159564,159560,159560
.long 159556,159556,159552,159552,159548,159548,159544,159544,159540,159540,159536,159536,159532,159532,159528,159528
.long 159524,159524,159520,159520,159516,159516,159512,159512,159508,159508,159504,159504,159500,159500,159496,159496
.long 159492,159492,159488,159488,159484,159484,159480,159480,159476,159476,159472,159472,159468,159468,159464,159464
.long 159460,159460,159456,159456,159452,159452,159448,159448,159444,159444,159440,159440,159436,159436,159432,159432
.long 159428,159428,159424,159424,159420,159420,159416,159416,159412,159412,159408,159408,159404,159404,159400,159400
.long 159396,159396,159392,159392,159388,159388,159384,159384,159380,159380,159376,159376,159372,159372,159368,159368
.long 159364,159364,159360,159360,159356,159356,159352,159352,159348,159348,159344,159344,159340,159340,159336,159336
.long 159332,159332,159328,159328,159324,159324,159320,159320,159316,159316,159312,159312,159308,159308,159304,159304
.long 159300,159300,159296,159296,159292,159292,159288,159288,159284,159284,159280,159280,159276,159276,159272,159272
.long 159268,159268,159264,159264,159260,159260,159256,159256,159252,159252,159248,159248,159244,159244,159240,159240
.long 159744,159740,159740,159740,159736,159732,159732,159732,159728,159724,159724,159724,159720,159716,159716,159716
.long 159712,159708,159708,159708,159704,159700,159700,159700,159696,159692,159692,159692,159688,159684,159684,159684
.long 159680,159676,159676,159676,159672,159668,159668,159668,159664,159660,159660,159660,159656,159652,159652,159652
.long 159648,159644,159644,159644,159640,159636,159636,159636,159632,159628,159628,159628,159624,159620,159620,159620
.long 159616,159612,159612,159612,159608,159604,159604,159604,159600,159596,159596,159596,159592,159588,159588,159588
.long 159584,159580,159580,159580,159576,159572,159572,159572,159568,159564,159564,159564,159560,159556,159556,159556
.long 159552,159548,159548,159548,159544,159540,159540,159540,159536,159532,159532,159532,159528,159524,159524,159524
.long 159520,159516,159516,159516,159512,159508,159508,159508,159504,159500,159500,159500,159496,159492,159492,159492
.long 159488,159484,159484,159484,159480,159476,159476,159476,159472,159468,159468,159468,159464,159460,159460,159460
.long 159456,159452,159452,159452,159448,159444,159444,159444,159440,159436,159436,159436,159432,159428,159428,159428
.long 159424,159420,159420,159420,159416,159412,159412,159412,159408,159404,159404,159404,159400,159396,159396,159396
.long 159392,159388,159388,159388,159384,159380,159380,159380,159376,159372,159372,159372,159368,159364,159364,159364
.long 159360,159356,159356,159356,159352,159348,159348,159348,159344,159340,159340,159340,159336,159332,159332,159332
.long 159328,159324,159324,159324,159320,159316,159316,159316,159312,159308,159308,159308,159304,159300,159300,159300
.long 159296,159292,159292,159292,159288,159284,159284,159284,159280,159276,159276,159276,159272,159268,159268,159268
.long 159264,159260,159260,159260,159256,159252,159252,159252,159248,159244,159244,159244,159240,159236,159236,159236
.long 159740,159740,159736,159236,159732,159732,159728,159220,159724,159724,159720,159204,159716,159716,159712,159188
.long 159708,159708,159704,159172,159700,159700,159696,159156,159692,159692,159688,159140,159684,159684,159680,159124
.long 159676,159676,159672,159108,159668,159668,159664,159092,159660,159660,159656,159076,159652,159652,159648,159060
.long 159644,159644,159640,159044,159636,159636,159632,159028,159628,159628,159624,159012,159620,159620,159616,158996
.long 159612,159612,159608,158980,159604,159604,159600,158964,159596,159596,159592,158948,159588,159588,159584,158932
.long 159580,159580,159576,158916,159572,159572,159568,158900,159564,159564,159560,158884,159556,159556,159552,158868
.long 159548,159548,159544,158852,159540,159540,159536,158836,159532,159532,159528,158820,159524,159524,159520,158804
.long 159516,159516,159512,158788,159508,159508,159504,158772,159500,159500,159496,158756,159492,159492,159488,158740
.long 159484,159484,159480,158720,159476,159476,159472,158688,159468,159468,159464,158656,159460,159460,159456,158624
.long 159452,159452,159448,158592,159444,159444,159440,158560,159436,159436,159432,158528,159428,159428,159424,158496
.long 159420,159420,159416,158464,159412,159412,159408,158432,159404,159404,159400,158400,159396,159396,159392,158368
.long 159388,159388,159384,158336,159380,159380,159376,158304,159372,159372,159368,158272,159364,159364,159360,158240
.long 159356,159356,159352,158208,159348,159348,159344,158176,159340,159340,159336,158144,159332,159332,159328,158112
.long 159324,159324,159320,158080,159316,159316,159312,158048,159308,159308,159304,158016,159300,159300,159296,157984
.long 159292,159292,159288,157952,159284,159284,159280,157920,159276,159276,159272,157888,159268,159268,159264,157856
.long 159260,159260,159256,157824,159252,159252,159248,157792,159244,159244,159240,157760,159236,159232,159228,157728
.long 159232,159228,159228,159228,159216,159212,159212,159212,159200,159196,159196,159196,159184,159180,159180,159180
.long 159168,159164,159164,159164,159152,159148,159148,159148,159136,159132,159132,159132,159120,159116,159116,159116
.long 159104,159100,159100,159100,159088,159084,159084,159084,159072,159068,159068,159068,159056,159052,159052,159052
.long 159040,159036,159036,159036,159024,159020,159020,159020,159008,159004,159004,159004,158992,158988,158988,158988
.long 158976,158972,158972,158972,158960,158956,158956,158956,158944,158940,158940,158940,158928,158924,158924,158924
.long 158912,158908,158908,158908,158896,158892,158892,158892,158880,158876,158876,158876,158864,158860,158860,158860
.long 158848,158844,158844,158844,158832,158828,158828,158828,158816,158812,158812,158812,158800,158796,158796,158796
.long 158784,158780,158780,158780,158768,158764,158764,158764,158752,158748,158748,158748,158736,158732,158732,158732
.long 158716,158712,158708,158704,158684,158680,158676,158672,158652,158648,158644,158640,158620,158616,158612,158608
.long 158588,158584,158580,158576,158556,158552,158548,158544,158524,158520,158516,158512,158492,158488,158484,158480
.long 158460,158456,158452,158448,158428,158424,158420,158416,158396,158392,158388,158384,158364,158360,158356,158352
.long 158332,158328,158324,158320,158300,158296,158292,158288,158268,158264,158260,158256,158236,158232,158228,158224
.long 158204,158200,158196,158192,158172,158168,158164,158160,158140,158136,158132,158128,158108,158104,158100,158096
.long 158076,158072,158068,158064,158044,158040,158036,158032,158012,158008,158004,158000,157980,157976,157972,157968
.long 157948,157944,157940,157936,157916,157912,157908,157904,157884,157880,157876,157872,157852,157848,157844,157840
.long 157820,157816,157812,157808,157788,157784,157780,157776,157756,157752,157748,157744,157724,157720,157716,157712
.long 159224,159220,159220,159220,159208,159204,159204,159204,159192,159188,159188,159188,159176,159172,159172,159172
.long 159160,159156,159156,159156,159144,159140,159140,159140,159128,159124,159124,159124,159112,159108,159108,159108
.long 159096,159092,159092,159092,159080,159076,159076,159076,159064,159060,159060,159060,159048,159044,159044,159044
.long 159032,159028,159028,159028,159016,159012,159012,159012,159000,158996,158996,158996,158984,158980,158980,158980
.long 158968,158964,158964,158964,158952,158948,158948,158948,158936,158932,158932,158932,158920,158916,158916,158916
.long 158904,158900,158900,158900,158888,158884,158884,158884,158872,158868,158868,158868,158856,158852,158852,158852
.long 158840,158836,158836,158836,158824,158820,158820,158820,158808,158804,158804,158804,158792,158788,158788,158788
.long 158776,158772,158772,158772,158760,158756,158756,158756,158744,158740,158740,158740,158728,158724,158724,158720
.long 158700,158696,158692,158688,158668,158664,158660,158656,158636,158632,158628,158624,158604,158600,158596,158592
.long 158572,158568,158564,158560,158540,158536,158532,158528,158508,158504,158500,158496,158476,158472,158468,158464
.long 158444,158440,158436,158432,158412,158408,158404,158400,158380,158376,158372,158368,158348,158344,158340,158336
.long 158316,158312,158308,158304,158284,158280,158276,158272,158252,158248,158244,158240,158220,158216,158212,158208
.long 158188,158184,158180,158176,158156,158152,158148,158144,158124,158120,158116,158112,158092,158088,158084,158080
.long 158060,158056,158052,158048,158028,158024,158020,158016,157996,157992,157988,157984,157964,157960,157956,157952
.long 157932,157928,157924,157920,157900,157896,157892,157888,157868,157864,157860,157856,157836,157832,157828,157824
.long 157804,157800,157796,157792,157772,157768,157764,157760,157740,157736,157732,157728,157708,157704,157700,157696
.long 159216,159212,0,0,159200,159196,0,0,159184,159180,0,0,159168,159164,0,0
.long 159152,159148,0,0,159136,159132,0,0,159120,159116,0,0,159104,159100,0,0
.long 159088,159084,0,0,159072,159068,0,0,159056,159052,0,0,159040,159036,0,0
.long 159024,159020,0,0,159008,159004,0,0,158992,158988,0,0,158976,158972,0,0
.long 158960,158956,0,0,158944,158940,0,0,158928,158924,0,0,158912,158908,0,0
.long 158896,158892,0,0,158880,158876,0,0,158864,158860,0,0,158848,158844,0,0
.long 158832,158828,0,0,158816,158812,0,0,158800,158796,0,0,158784,158780,0,0
.long 158768,158764,0,0,158752,158748,0,0,158736,158732,0,0,158716,158712,0,0
.long 158684,158680,0,0,158652,158648,0,0,158620,158616,0,0,158588,158584,0,0
.long 158556,158552,0,0,158524,158520,0,0,158492,158488,0,0,158460,158456,0,0
.long 158428,158424,0,0,158396,158392,0,0,158364,158360,0,0,158332,158328,0,0
.long 158300,158296,0,0,158268,158264,0,0,158236,158232,0,0,158204,158200,0,0
.long 158172,158168,0,0,158140,158136,0,0,158108,158104,0,0,158076,158072,0,0
.long 158044,158040,0,0,158012,158008,0,0,157980,157976,0,0,157948,157944,0,0
.long 157916,157912,0,0,157884,157880,0,0,157852,157848,0,0,157820,157816,0,0
.long 157788,157784,0,0,157756,157752,0,0,157724,157720,0,0,157696,157696,0,0
.long 0,0,0,74240,0,0,0,74256,0,0,0,74272,0,0,0,74288
.long 0,0,0,74304,0,0,0,74320,0,0,0,74336,0,0,0,74352
.long 0,0,0,74368,0,0,0,74384,0,0,0,74400,0,0,0,74416
.long 0,0,0,74432,0,0,0,74448,0,0,0,74464,0,0,0,74480
.long 0,0,0,99584,0,0,0,99600,0,0,0,103744,0,0,0,103760
.long 0,0,0,99584,0,0,0,99600,0,0,0,103744,0,0,0,103760
.long 0,0,0,99584,0,0,0,99600,0,0,0,103744,0,0,0,103760
.long 0,0,0,99584,0,0,0,99600,0,0,0,103744,0,0,0,103760
.long 0,0,0,99584,0,0,0,99600,0,0,0,103744,0,0,0,103760
.long 0,0,0,99584,0,0,0,99600,0,0,0,103744,0,0,0,103760
.long 0,0,0,99584,0,0,0,99600,0,0,0,103744,0,0,0,103760
.long 0,0,0,99584,0,0,0,99600,0,0,0,103744,0,0,0,103760
.long 0,0,0,99584,0,0,0,99600,0,0,0,103744,0,0,0,103760
.long 0,0,0,99584,0,0,0,99600,0,0,0,103744,0,0,0,103760
.long 0,0,0,99584,0,0,0,99600,0,0,0,103744,0,0,0,103760
.long 0,0,0,99584,0,0,0,99600,0,0,0,103744,0,0,0,103760
.long 95488,72192,160320,108248,95504,76800,160320,104088,95520,72208,160320,99928,95536,76816,160320,95768
.long 95552,72224,160320,108240,95568,76832,160320,104080,95584,72240,160320,99920,95600,76848,160320,95760
.long 95616,72256,160320,108232,95632,76864,160320,104072,95648,72272,160320,99912,95664,76880,160320,95752
.long 95680,72288,160320,108224,95696,76896,160320,104064,95712,72304,160320,99904,95728,76912,160320,95744
.long 95744,72320,160320,108264,95760,76928,160320,104104,95776,72336,160320,99944,95792,76944,160320,95784
.long 95808,72352,160320,108256,95824,76960,160320,104096,95840,72368,160320,99936,95856,76976,160320,95776
.long 95872,72384,160320,108248,95888,76992,160320,104088,95904,72400,160320,99928,95920,77008,160320,95768
.long 95936,72416,160320,108240,95952,77024,160320,104080,95968,72432,160320,99920,95984,77040,160320,95760
.long 96000,72448,160320,108280,96016,77056,160320,104120,96032,72464,160320,99960,96048,77072,160320,95800
.long 96064,72480,160320,108272,96080,77088,160320,104112,96096,72496,160320,99952,96112,77104,160320,95792
.long 96128,72512,160320,108264,96144,77120,160320,104104,96160,72528,160320,99944,96176,77136,160320,95784
.long 96192,72544,160320,108256,96208,77152,160320,104096,96224,72560,160320,99936,96240,77168,160320,95776
.long 96256,72576,160320,108296,96272,77184,160320,104136,96288,72592,160320,99976,96304,77200,160320,95816
.long 96320,72608,160320,108288,96336,77216,160320,104128,96352,72624,160320,99968,96368,77232,160320,95808
.long 96384,72640,160320,108280,96400,77248,160320,104120,96416,72656,160320,99960,96432,77264,160320,95800
.long 96448,72672,160320,108272,96464,77280,160320,104112,96480,72688,160320,99952,96496,77296,160320,95792
.long 74528,8192,12288,74752,74560,8208,12304,74784,74592,8224,12320,74816,74624,8240,12336,74848
.long 74656,8256,12352,74880,74688,8272,12368,74912,74720,8288,12384,74944,74752,8304,12400,74976
.long 74784,8320,12416,75008,74816,8336,12432,75040,74848,8352,12448,75072,74880,8368,12464,75104
.long 74912,8384,12480,75136,74944,8400,12496,75168,74976,8416,12512,75200,75008,8432,12528,75232
.long 74544,8448,12544,74760,74576,8464,12560,74792,74608,8480,12576,74824,74640,8496,12592,74856
.long 74672,8512,12608,74888,74704,8528,12624,74920,74736,8544,12640,74952,74768,8560,12656,74984
.long 74800,8576,12672,75016,74832,8592,12688,75048,74864,8608,12704,75080,74896,8624,12720,75112
.long 74928,8640,12736,75144,74960,8656,12752,75176,74992,8672,12768,75208,75024,8688,12784,75240
.long 74560,8704,12800,74768,74592,8720,12816,74800,74624,8736,12832,74832,74656,8752,12848,74864
.long 74688,8768,12864,74896,74720,8784,12880,74928,74752,8800,12896,74960,74784,8816,12912,74992
.long 74816,8832,12928,75024,74848,8848,12944,75056,74880,8864,12960,75088,74912,8880,12976,75120
.long 74944,8896,12992,75152,74976,8912,13008,75184,75008,8928,13024,75216,75040,8944,13040,75248
.long 74576,8960,13056,74776,74608,8976,13072,74808,74640,8992,13088,74840,74672,9008,13104,74872
.long 74704,9024,13120,74904,74736,9040,13136,74936,74768,9056,13152,74968,74800,9072,13168,75000
.long 74832,9088,13184,75032,74864,9104,13200,75064,74896,9120,13216,75096,74928,9136,13232,75128
.long 74960,9152,13248,75160,74992,9168,13264,75192,75024,9184,13280,75224,75056,9200,13296,75256
.long 20480,20480,70656,29696,20512,20496,70672,29712,20544,20512,70688,29728,20576,20528,70704,29744
.long 20608,20544,70720,29760,20640,20560,70736,29776,20672,20576,70752,29792,20704,20592,70768,29808
.long 20736,20608,70784,29824,20768,20624,70800,29840,20800,20640,70816,29856,20832,20656,70832,29872
.long 20864,20672,70848,29888,20896,20688,70864,29904,20928,20704,70880,29920,20960,20720,70896,29936
.long 20488,20736,70912,29952,20520,20752,70928,29968,20552,20768,70944,29984,20584,20784,70960,30000
.long 20616,20800,70976,30016,20648,20816,70992,30032,20680,20832,71008,30048,20712,20848,71024,30064
.long 20744,20864,71040,30080,20776,20880,71056,30096,20808,20896,71072,30112,20840,20912,71088,30128
.long 20872,20928,71104,30144,20904,20944,71120,30160,20936,20960,71136,30176,20968,20976,71152,30192
.long 20496,20992,71168,30208,20528,21008,71184,30224,20560,21024,71200,30240,20592,21040,71216,30256
.long 20624,21056,71232,30272,20656,21072,71248,30288,20688,21088,71264,30304,20720,21104,71280,30320
.long 20752,21120,71296,30336,20784,21136,71312,30352,20816,21152,71328,30368,20848,21168,71344,30384
.long 20880,21184,71360,30400,20912,21200,71376,30416,20944,21216,71392,30432,20976,21232,71408,30448
.long 20504,21248,71424,30464,20536,21264,71440,30480,20568,21280,71456,30496,20600,21296,71472,30512
.long 20632,21312,71488,30528,20664,21328,71504,30544,20696,21344,71520,30560,20728,21360,71536,30576
.long 20760,21376,71552,30592,20792,21392,71568,30608,20824,21408,71584,30624,20856,21424,71600,30640
.long 20888,21440,71616,30656,20920,21456,71632,30672,20952,21472,71648,30688,20984,21488,71664,30704
.long 50176,0,7744,15488,50192,16,7760,15504,50208,32,7776,16640,50224,48,7792,16656
.long 50240,64,7808,16672,50256,80,7824,16688,50272,96,8960,16704,50288,112,8976,16720
.long 50304,128,8992,16736,50320,144,9008,16752,50336,1280,9024,16768,50352,1296,9040,16784
.long 50368,1312,9056,17920,50384,1328,9072,17936,50400,1344,9088,17952,50416,1360,9104,17968
.long 50432,1376,10240,17984,50448,1392,10256,18000,50464,1408,10272,18016,50480,1424,10288,18032
.long 50496,2560,10304,18048,50512,2576,10320,18064,50528,2592,10336,19200,50544,2608,10352,19216
.long 50560,2624,10368,19232,50576,2640,10384,19248,50592,2656,11520,19264,50608,2672,11536,19280
.long 50624,2688,11552,19296,50640,2704,11568,19312,50656,3840,11584,19328,50672,3856,11600,19344
.long 50688,3872,11616,20480,50704,3888,11632,20496,50720,3904,11648,20512,50736,3920,11664,20528
.long 50752,3936,12800,20544,50768,3952,12816,20560,50784,3968,12832,20576,50800,3984,12848,20592
.long 50816,5120,12864,20608,50832,5136,12880,20624,50848,5152,12896,21760,50864,5168,12912,21776
.long 50880,5184,12928,21792,50896,5200,12944,21808,50912,5216,14080,21824,50928,5232,14096,21840
.long 50944,5248,14112,21856,50960,5264,14128,21872,50976,6400,14144,21888,50992,6416,14160,21904
.long 51008,6432,14176,23040,51024,6448,14192,23056,51040,6464,14208,23072,51056,6480,14224,23088
.long 51072,6496,15360,23104,51088,6512,15376,23120,51104,6528,15392,23136,51120,6544,15408,23152
.long 51136,7680,15424,23168,51152,7696,15440,23184,51168,7712,15456,24320,51184,7728,15472,24336
.long 15488,0,0,0,15504,0,0,16,16640,0,0,10240,16656,0,0,10256
.long 16672,0,0,20480,16688,0,0,20496,16704,0,0,30720,16720,0,0,30736
.long 16736,0,0,40960,16752,0,0,40976,16768,0,0,51200,16784,0,0,51216
.long 17920,0,0,61440,17936,0,0,61456,17952,0,0,71680,17968,0,0,71696
.long 17984,0,0,81920,18000,0,0,81936,18016,0,0,92160,18032,0,0,92176
.long 18048,0,0,102400,18064,0,0,102416,19200,0,0,112640,19216,0,0,112656
.long 19232,0,0,122880,19248,0,0,122896,19264,0,0,133120,19280,0,0,133136
.long 19296,0,0,143360,19312,0,0,143376,19328,0,0,153600,19344,0,0,153616
.long 2147418112,0,0,163840,2147418112,0,0,163856,2147418112,0,0,174080,2147418112,0,0,174096
.long 2147418112,0,0,184320,2147418112,0,0,184336,2147418112,0,0,194560,2147418112,0,0,194576
.long 2147418112,0,0,204800,2147418112,0,0,204816,2147418112,0,0,215040,2147418112,0,0,215056
.long 2147418112,0,0,225280,2147418112,0,0,225296,2147418112,0,0,235520,2147418112,0,0,235536
.long 2147418112,0,0,245760,2147418112,0,0,245776,2147418112,0,0,256000,2147418112,0,0,256016
.long 2147418112,0,0,266240,2147418112,0,0,266256,2147418112,0,0,276480,2147418112,0,0,276496
.long 2147418112,0,0,286720,2147418112,0,0,286736,2147418112,0,0,296960,2147418112,0,0,296976
.long 2147418112,0,0,307200,2147418112,0,0,307216,2147418112,0,0,317440,2147418112,0,0,317456
.long 162884,162884,162884,162884,162880,162880,162880,162876,162876,162876,162876,162876,162872,162872,162872,162868
.long 162868,162868,162868,162868,162864,162864,162864,162860,162860,162860,162860,162860,162856,162856,162856,162852
.long 162852,162852,162852,162852,162848,162848,162848,162844,162844,162844,162844,162844,162840,162840,162840,162836
.long 162836,162836,162836,162836,162832,162832,162832,162828,162828,162828,162828,162828,162824,162824,162824,162820
.long 162820,162820,162820,162820,162816,162816,162816,162812,162812,162812,162812,162812,162808,162808,162808,162804
.long 162804,162804,162804,162804,162800,162800,162800,162796,162796,162796,162796,162796,162792,162792,162792,162788
.long 162788,162788,162788,162788,162784,162784,162784,162780,162780,162780,162780,162780,162776,162776,162776,162772
.long 162772,162772,162772,162772,162768,162768,162768,162764,162764,162764,162764,162764,162760,162760,162760,162756
.long 162756,162756,162756,162756,162752,162752,162752,162748,162748,162748,162748,162748,162744,162744,162744,162740
.long 162740,162740,162740,162740,162736,162736,162736,162732,162732,162732,162732,162732,162728,162728,162728,162724
.long 162724,162724,162724,162724,162720,162720,162720,162716,162716,162716,162716,162716,162712,162712,162712,162708
.long 162708,162708,162708,162708,162704,162704,162704,162700,162700,162700,162700,162700,162696,162696,162696,162692
.long 162692,162692,162692,162692,162688,162688,162688,162684,162684,162684,162684,162684,162680,162680,162680,162676
.long 162676,162676,162676,162676,162672,162672,162672,162668,162668,162668,162668,162668,162664,162664,162664,162660
.long 162660,162660,162660,162660,162656,162656,162656,162652,162652,162652,162652,162652,162648,162648,162648,162644
.long 162644,162644,162644,162644,162640,162640,162640,162636,162636,162636,162636,162636,162632,162632,162632,162628
.long 162880,162880,162880,162880,162876,162876,162876,162876,162872,162872,162872,162872,162868,162868,162868,162868
.long 162864,162864,162864,162864,162860,162860,162860,162860,162856,162856,162856,162856,162852,162852,162852,162852
.long 162848,162848,162848,162848,162844,162844,162844,162844,162840,162840,162840,162840,162836,162836,162836,162836
.long 162832,162832,162832,162832,162828,162828,162828,162828,162824,162824,162824,162824,162820,162820,162820,162820
.long 162816,162816,162816,162816,162812,162812,162812,162812,162808,162808,162808,162808,162804,162804,162804,162804
.long 162800,162800,162800,162800,162796,162796,162796,162796,162792,162792,162792,162792,162788,162788,162788,162788
.long 162784,162784,162784,162784,162780,162780,162780,162780,162776,162776,162776,162776,162772,162772,162772,162772
.long 162768,162768,162768,162768,162764,162764,162764,162764,162760,162760,162760,162760,162756,162756,162756,162756
.long 162752,162752,162752,162752,162748,162748,162748,162748,162744,162744,162744,162744,162740,162740,162740,162740
.long 162736,162736,162736,162736,162732,162732,162732,162732,162728,162728,162728,162728,162724,162724,162724,162724
.long 162720,162720,162720,162720,162716,162716,162716,162716,162712,162712,162712,162712,162708,162708,162708,162708
.long 162704,162704,162704,162704,162700,162700,162700,162700,162696,162696,162696,162696,162692,162692,162692,162692
.long 162688,162688,162688,162688,162684,162684,162684,162684,162680,162680,162680,162680,162676,162676,162676,162676
.long 162672,162672,162672,162672,162668,162668,162668,162668,162664,162664,162664,162664,162660,162660,162660,162660
.long 162656,162656,162656,162656,162652,162652,162652,162652,162648,162648,162648,162648,162644,162644,162644,162644
.long 162640,162640,162640,162640,162636,162636,162636,162636,162632,162632,162632,162632,162628,162628,162628,162628
.long 162880,162880,162880,162628,162876,162876,162876,162624,162872,162872,162872,162620,162868,162868,162868,162616
.long 162864,162864,162864,162612,162860,162860,162860,162608,162856,162856,162856,162604,162852,162852,162852,162600
.long 162848,162848,162848,162596,162844,162844,162844,162592,162840,162840,162840,162588,162836,162836,162836,162584
.long 162832,162832,162832,162580,162828,162828,162828,162576,162824,162824,162824,162572,162820,162820,162820,162568
.long 162816,162816,162816,162564,162812,162812,162812,162560,162808,162808,162808,162556,162804,162804,162804,162552
.long 162800,162800,162800,162548,162796,162796,162796,162544,162792,162792,162792,162540,162788,162788,162788,162536
.long 162784,162784,162784,162532,162780,162780,162780,162528,162776,162776,162776,162524,162772,162772,162772,162520
.long 162768,162768,162768,162516,162764,162764,162764,162512,162760,162760,162760,162508,162756,162756,162756,162504
.long 162752,162752,162752,162500,162748,162748,162748,162496,162744,162744,162744,162492,162740,162740,162740,162488
.long 162736,162736,162736,162484,162732,162732,162732,162480,162728,162728,162728,162476,162724,162724,162724,162472
.long 162720,162720,162720,162468,162716,162716,162716,162464,162712,162712,162712,162460,162708,162708,162708,162456
.long 162704,162704,162704,162452,162700,162700,162700,162448,162696,162696,162696,162444,162692,162692,162692,162440
.long 162688,162688,162688,162436,162684,162684,162684,162432,162680,162680,162680,162428,162676,162676,162676,162424
.long 162672,162672,162672,162420,162668,162668,162668,162416,162664,162664,162664,162412,162660,162660,162660,162408
.long 162656,162656,162656,162404,162652,162652,162652,162400,162648,162648,162648,162396,162644,162644,162644,162392
.long 162640,162640,162640,162388,162636,162636,162636,162384,162632,162632,162632,162380,162628,162628,162628,162376
.long 162628,162628,162628,162624,162624,162624,162620,162620,162620,162620,162620,162616,162616,162616,162612,162612
.long 162612,162612,162612,162608,162608,162608,162604,162604,162604,162604,162604,162600,162600,162600,162596,162596
.long 162596,162596,162596,162592,162592,162592,162588,162588,162588,162588,162588,162584,162584,162584,162580,162580
.long 162580,162580,162580,162576,162576,162576,162572,162572,162572,162572,162572,162568,162568,162568,162564,162564
.long 162564,162564,162564,162560,162560,162560,162556,162556,162556,162556,162556,162552,162552,162552,162548,162548
.long 162548,162548,162548,162544,162544,162544,162540,162540,162540,162540,162540,162536,162536,162536,162532,162532
.long 162532,162532,162532,162528,162528,162528,162524,162524,162524,162524,162524,162520,162520,162520,162516,162516
.long 162516,162516,162516,162512,162512,162512,162508,162508,162508,162508,162508,162504,162504,162504,162500,162500
.long 162500,162500,162500,162496,162496,162496,162492,162492,162492,162492,162492,162488,162488,162488,162484,162484
.long 162484,162484,162484,162480,162480,162480,162476,162476,162476,162476,162476,162472,162472,162472,162468,162468
.long 162468,162468,162468,162464,162464,162464,162460,162460,162460,162460,162460,162456,162456,162456,162452,162452
.long 162452,162452,162452,162448,162448,162448,162444,162444,162444,162444,162444,162440,162440,162440,162436,162436
.long 162436,162436,162436,162432,162432,162432,162428,162428,162428,162428,162428,162424,162424,162424,162420,162420
.long 162420,162420,162420,162416,162416,162416,162412,162412,162412,162412,162412,162408,162408,162408,162404,162404
.long 162404,162404,162404,162400,162400,162400,162396,162396,162396,162396,162396,162392,162392,162392,162388,162388
.long 162388,162388,162388,162384,162384,162384,162380,162380,162380,162380,162380,162376,162376,162376,162372,162372
.long 162624,162624,162624,162624,162620,162620,162620,162620,162616,162616,162616,162616,162612,162612,162612,162612
.long 162608,162608,162608,162608,162604,162604,162604,162604,162600,162600,162600,162600,162596,162596,162596,162596
.long 162592,162592,162592,162592,162588,162588,162588,162588,162584,162584,162584,162584,162580,162580,162580,162580
.long 162576,162576,162576,162576,162572,162572,162572,162572,162568,162568,162568,162568,162564,162564,162564,162564
.long 162560,162560,162560,162560,162556,162556,162556,162556,162552,162552,162552,162552,162548,162548,162548,162548
.long 162544,162544,162544,162544,162540,162540,162540,162540,162536,162536,162536,162536,162532,162532,162532,162532
.long 162528,162528,162528,162528,162524,162524,162524,162524,162520,162520,162520,162520,162516,162516,162516,162516
.long 162512,162512,162512,162512,162508,162508,162508,162508,162504,162504,162504,162504,162500,162500,162500,162500
.long 162496,162496,162496,162496,162492,162492,162492,162492,162488,162488,162488,162488,162484,162484,162484,162484
.long 162480,162480,162480,162480,162476,162476,162476,162476,162472,162472,162472,162472,162468,162468,162468,162468
.long 162464,162464,162464,162464,162460,162460,162460,162460,162456,162456,162456,162456,162452,162452,162452,162452
.long 162448,162448,162448,162448,162444,162444,162444,162444,162440,162440,162440,162440,162436,162436,162436,162436
.long 162432,162432,162432,162432,162428,162428,162428,162428,162424,162424,162424,162424,162420,162420,162420,162420
.long 162416,162416,162416,162416,162412,162412,162412,162412,162408,162408,162408,162408,162404,162404,162404,162404
.long 162400,162400,162400,162400,162396,162396,162396,162396,162392,162392,162392,162392,162388,162388,162388,162388
.long 162384,162384,162384,162384,162380,162380,162380,162380,162376,162376,162376,162376,162372,162372,162372,162372
.long 162624,162624,0,0,162620,162620,0,0,162616,162616,0,0,162612,162612,0,0
.long 162608,162608,0,0,162604,162604,0,0,162600,162600,0,0,162596,162596,0,0
.long 162592,162592,0,0,162588,162588,0,0,162584,162584,0,0,162580,162580,0,0
.long 162576,162576,0,0,162572,162572,0,0,162568,162568,0,0,162564,162564,0,0
.long 162560,162560,0,0,162556,162556,0,0,162552,162552,0,0,162548,162548,0,0
.long 162544,162544,0,0,162540,162540,0,0,162536,162536,0,0,162532,162532,0,0
.long 162528,162528,0,0,162524,162524,0,0,162520,162520,0,0,162516,162516,0,0
.long 162512,162512,0,0,162508,162508,0,0,162504,162504,0,0,162500,162500,0,0
.long 162496,162496,0,0,162492,162492,0,0,162488,162488,0,0,162484,162484,0,0
.long 162480,162480,0,0,162476,162476,0,0,162472,162472,0,0,162468,162468,0,0
.long 162464,162464,0,0,162460,162460,0,0,162456,162456,0,0,162452,162452,0,0
.long 162448,162448,0,0,162444,162444,0,0,162440,162440,0,0,162436,162436,0,0
.long 162432,162432,0,0,162428,162428,0,0,162424,162424,0,0,162420,162420,0,0
.long 162416,162416,0,0,162412,162412,0,0,162408,162408,0,0,162404,162404,0,0
.long 162400,162400,0,0,162396,162396,0,0,162392,162392,0,0,162388,162388,0,0
.long 162384,162384,0,0,162380,162380,0,0,162376,162376,0,0,162372,162368,0,0
.long 0,0,0,74496,0,0,0,74512,0,0,0,74528,0,0,0,74544
.long 0,0,0,74560,0,0,0,74576,0,0,0,74592,0,0,0,74608
.long 0,0,0,74624,0,0,0,74640,0,0,0,74656,0,0,0,74672
.long 0,0,0,74688,0,0,0,74704,0,0,0,74720,0,0,0,74736
.long 0,0,0,107904,0,0,0,107920,0,0,0,112064,0,0,0,112080
.long 0,0,0,107904,0,0,0,107920,0,0,0,112064,0,0,0,112080
.long 0,0,0,107904,0,0,0,107920,0,0,0,112064,0,0,0,112080
.long 0,0,0,107904,0,0,0,107920,0,0,0,112064,0,0,0,112080
.long 0,0,0,107904,0,0,0,107920,0,0,0,112064,0,0,0,112080
.long 0,0,0,107904,0,0,0,107920,0,0,0,112064,0,0,0,112080
.long 0,0,0,107904,0,0,0,107920,0,0,0,112064,0,0,0,112080
.long 0,0,0,107904,0,0,0,107920,0,0,0,112064,0,0,0,112080
.long 0,0,0,107904,0,0,0,107920,0,0,0,112064,0,0,0,112080
.long 0,0,0,107904,0,0,0,107920,0,0,0,112064,0,0,0,112080
.long 0,0,0,107904,0,0,0,107920,0,0,0,112064,0,0,0,112080
.long 0,0,0,107904,0,0,0,107920,0,0,0,112064,0,0,0,112080
.long 97536,73216,160320,107992,97552,77824,160320,103832,97568,73232,160320,99672,97584,77840,160320,95512
.long 97600,73248,160320,107984,97616,77856,160320,103824,97632,73264,160320,99664,97648,77872,160320,95504
.long 97664,73280,160320,107976,97680,77888,160320,103816,97696,73296,160320,99656,97712,77904,160320,95496
.long 97728,73312,160320,107968,97744,77920,160320,103808,97760,73328,160320,99648,97776,77936,160320,95488
.long 97792,73344,160320,108008,97808,77952,160320,103848,97824,73360,160320,99688,97840,77968,160320,95528
.long 97856,73376,160320,108000,97872,77984,160320,103840,97888,73392,160320,99680,97904,78000,160320,95520
.long 97920,73408,160320,107992,97936,78016,160320,103832,97952,73424,160320,99672,97968,78032,160320,95512
.long 97984,73440,160320,107984,98000,78048,160320,103824,98016,73456,160320,99664,98032,78064,160320,95504
.long 98048,73472,160320,108024,98064,78080,160320,103864,98080,73488,160320,99704,98096,78096,160320,95544
.long 98112,73504,160320,108016,98128,78112,160320,103856,98144,73520,160320,99696,98160,78128,160320,95536
.long 98176,73536,160320,108008,98192,78144,160320,103848,98208,73552,160320,99688,98224,78160,160320,95528
.long 98240,73568,160320,108000,98256,78176,160320,103840,98272,73584,160320,99680,98288,78192,160320,95520
.long 98304,73600,160320,108040,98320,78208,160320,103880,98336,73616,160320,99720,98352,78224,160320,95560
.long 98368,73632,160320,108032,98384,78240,160320,103872,98400,73648,160320,99712,98416,78256,160320,95552
.long 98432,73664,160320,108024,98448,78272,160320,103864,98464,73680,160320,99704,98480,78288,160320,95544
.long 98496,73696,160320,108016,98512,78304,160320,103856,98528,73712,160320,99696,98544,78320,160320,95536
.long 74272,12288,8192,76800,74304,12304,8208,76832,74336,12320,8224,76864,74368,12336,8240,76896
.long 74400,12352,8256,76928,74432,12368,8272,76960,74464,12384,8288,76992,74496,12400,8304,77024
.long 74528,12416,8320,77056,74560,12432,8336,77088,74592,12448,8352,77120,74624,12464,8368,77152
.long 74656,12480,8384,77184,74688,12496,8400,77216,74720,12512,8416,77248,74752,12528,8432,77280
.long 74288,12544,8448,76808,74320,12560,8464,76840,74352,12576,8480,76872,74384,12592,8496,76904
.long 74416,12608,8512,76936,74448,12624,8528,76968,74480,12640,8544,77000,74512,12656,8560,77032
.long 74544,12672,8576,77064,74576,12688,8592,77096,74608,12704,8608,77128,74640,12720,8624,77160
.long 74672,12736,8640,77192,74704,12752,8656,77224,74736,12768,8672,77256,74768,12784,8688,77288
.long 74304,12800,8704,76816,74336,12816,8720,76848,74368,12832,8736,76880,74400,12848,8752,76912
.long 74432,12864,8768,76944,74464,12880,8784,76976,74496,12896,8800,77008,74528,12912,8816,77040
.long 74560,12928,8832,77072,74592,12944,8848,77104,74624,12960,8864,77136,74656,12976,8880,77168
.long 74688,12992,8896,77200,74720,13008,8912,77232,74752,13024,8928,77264,74784,13040,8944,77296
.long 74320,13056,8960,76824,74352,13072,8976,76856,74384,13088,8992,76888,74416,13104,9008,76920
.long 74448,13120,9024,76952,74480,13136,9040,76984,74512,13152,9056,77016,74544,13168,9072,77048
.long 74576,13184,9088,77080,74608,13200,9104,77112,74640,13216,9120,77144,74672,13232,9136,77176
.long 74704,13248,9152,77208,74736,13264,9168,77240,74768,13280,9184,77272,74800,13296,9200,77304
.long 22528,22528,24576,45056,22560,22544,24592,45072,22592,22560,24608,45088,22624,22576,24624,45104
.long 22656,22592,24640,45120,22688,22608,24656,45136,22720,22624,24672,45152,22752,22640,24688,45168
.long 22784,22656,24704,45184,22816,22672,24720,45200,22848,22688,24736,45216,22880,22704,24752,45232
.long 22912,22720,24768,45248,22944,22736,24784,45264,22976,22752,24800,45280,23008,22768,24816,45296
.long 22536,22784,24832,45312,22568,22800,24848,45328,22600,22816,24864,45344,22632,22832,24880,45360
.long 22664,22848,24896,45376,22696,22864,24912,45392,22728,22880,24928,45408,22760,22896,24944,45424
.long 22792,22912,24960,45440,22824,22928,24976,45456,22856,22944,24992,45472,22888,22960,25008,45488
.long 22920,22976,25024,45504,22952,22992,25040,45520,22984,23008,25056,45536,23016,23024,25072,45552
.long 22544,23040,25088,45568,22576,23056,25104,45584,22608,23072,25120,45600,22640,23088,25136,45616
.long 22672,23104,25152,45632,22704,23120,25168,45648,22736,23136,25184,45664,22768,23152,25200,45680
.long 22800,23168,25216,45696,22832,23184,25232,45712,22864,23200,25248,45728,22896,23216,25264,45744
.long 22928,23232,25280,45760,22960,23248,25296,45776,22992,23264,25312,45792,23024,23280,25328,45808
.long 22552,23296,25344,45824,22584,23312,25360,45840,22616,23328,25376,45856,22648,23344,25392,45872
.long 22680,23360,25408,45888,22712,23376,25424,45904,22744,23392,25440,45920,22776,23408,25456,45936
.long 22808,23424,25472,45952,22840,23440,25488,45968,22872,23456,25504,45984,22904,23472,25520,46000
.long 22936,23488,25536,46016,22968,23504,25552,46032,23000,23520,25568,46048,23032,23536,25584,46064
.long 65536,0,7744,15488,65552,16,7760,15504,65568,32,7776,16640,65584,48,7792,16656
.long 65600,64,7808,16672,65616,80,7824,16688,65632,96,8960,16704,65648,112,8976,16720
.long 65664,128,8992,16736,65680,144,9008,16752,65696,1280,9024,16768,65712,1296,9040,16784
.long 65728,1312,9056,17920,65744,1328,9072,17936,65760,1344,9088,17952,65776,1360,9104,17968
.long 65792,1376,10240,17984,65808,1392,10256,18000,65824,1408,10272,18016,65840,1424,10288,18032
.long 65856,2560,10304,18048,65872,2576,10320,18064,65888,2592,10336,19200,65904,2608,10352,19216
.long 65920,2624,10368,19232,65936,2640,10384,19248,65952,2656,11520,19264,65968,2672,11536,19280
.long 65984,2688,11552,19296,66000,2704,11568,19312,66016,3840,11584,19328,66032,3856,11600,19344
.long 66048,3872,11616,20480,66064,3888,11632,20496,66080,3904,11648,20512,66096,3920,11664,20528
.long 66112,3936,12800,20544,66128,3952,12816,20560,66144,3968,12832,20576,66160,3984,12848,20592
.long 66176,5120,12864,20608,66192,5136,12880,20624,66208,5152,12896,21760,66224,5168,12912,21776
.long 66240,5184,12928,21792,66256,5200,12944,21808,66272,5216,14080,21824,66288,5232,14096,21840
.long 66304,5248,14112,21856,66320,5264,14128,21872,66336,6400,14144,21888,66352,6416,14160,21904
.long 66368,6432,14176,23040,66384,6448,14192,23056,66400,6464,14208,23072,66416,6480,14224,23088
.long 66432,6496,15360,23104,66448,6512,15376,23120,66464,6528,15392,23136,66480,6544,15408,23152
.long 66496,7680,15424,23168,66512,7696,15440,23184,66528,7712,15456,24320,66544,7728,15472,24336
.long 15488,0,0,0,15504,0,0,16,16640,0,0,10240,16656,0,0,10256
.long 16672,0,0,20480,16688,0,0,20496,16704,0,0,30720,16720,0,0,30736
.long 16736,0,0,40960,16752,0,0,40976,16768,0,0,51200,16784,0,0,51216
.long 17920,0,0,61440,17936,0,0,61456,17952,0,0,71680,17968,0,0,71696
.long 17984,0,0,81920,18000,0,0,81936,18016,0,0,92160,18032,0,0,92176
.long 18048,0,0,102400,18064,0,0,102416,19200,0,0,112640,19216,0,0,112656
.long 19232,0,0,122880,19248,0,0,122896,19264,0,0,133120,19280,0,0,133136
.long 19296,0,0,143360,19312,0,0,143376,19328,0,0,153600,19344,0,0,153616
.long 2147418112,0,0,163840,2147418112,0,0,163856,2147418112,0,0,174080,2147418112,0,0,174096
.long 2147418112,0,0,184320,2147418112,0,0,184336,2147418112,0,0,194560,2147418112,0,0,194576
.long 2147418112,0,0,204800,2147418112,0,0,204816,2147418112,0,0,215040,2147418112,0,0,215056
.long 2147418112,0,0,225280,2147418112,0,0,225296,2147418112,0,0,235520,2147418112,0,0,235536
.long 2147418112,0,0,245760,2147418112,0,0,245776,2147418112,0,0,256000,2147418112,0,0,256016
.long 2147418112,0,0,266240,2147418112,0,0,266256,2147418112,0,0,276480,2147418112,0,0,276496
.long 2147418112,0,0,286720,2147418112,0,0,286736,2147418112,0,0,296960,2147418112,0,0,296976
.long 2147418112,0,0,307200,2147418112,0,0,307216,2147418112,0,0,317440,2147418112,0,0,317456
.long 162372,162372,162368,162368,162364,162364,162360,162360,162356,162356,162352,162352,162348,162348,162344,162344
.long 162340,162340,162336,162336,162332,162332,162328,162328,162324,162324,162320,162320,162316,162316,162312,162312
.long 162308,162308,162304,162304,162300,162300,162296,162296,162292,162292,162288,162288,162284,162284,162280,162280
.long 162276,162276,162272,162272,162268,162268,162264,162264,162260,162260,162256,162256,162252,162252,162248,162248
.long 162244,162244,162240,162240,162236,162236,162232,162232,162228,162228,162224,162224,162220,162220,162216,162216
.long 162212,162212,162208,162208,162204,162204,162200,162200,162196,162196,162192,162192,162188,162188,162184,162184
.long 162180,162180,162176,162176,162172,162172,162168,162168,162164,162164,162160,162160,162156,162156,162152,162152
.long 162148,162148,162144,162144,162140,162140,162136,162136,162132,162132,162128,162128,162124,162124,162120,162120
.long 162116,162116,162112,162112,162108,162108,162104,162104,162100,162100,162096,162096,162092,162092,162088,162088
.long 162084,162084,162080,162080,162076,162076,162072,162072,162068,162068,162064,162064,162060,162060,162056,162056
.long 162052,162052,162048,162048,162044,162044,162040,162040,162036,162036,162032,162032,162028,162028,162024,162024
.long 162020,162020,162016,162016,162012,162012,162008,162008,162004,162004,162000,162000,161996,161996,161992,161992
.long 161988,161988,161984,161984,161980,161980,161976,161976,161972,161972,161968,161968,161964,161964,161960,161960
.long 161956,161956,161952,161952,161948,161948,161944,161944,161940,161940,161936,161936,161932,161932,161928,161928
.long 161924,161924,161920,161920,161916,161916,161912,161912,161908,161908,161904,161904,161900,161900,161896,161896
.long 161892,161892,161888,161888,161884,161884,161880,161880,161876,161876,161872,161872,161868,161868,161864,161864
.long 162368,162364,162364,162364,162360,162356,162356,162356,162352,162348,162348,162348,162344,162340,162340,162340
.long 162336,162332,162332,162332,162328,162324,162324,162324,162320,162316,162316,162316,162312,162308,162308,162308
.long 162304,162300,162300,162300,162296,162292,162292,162292,162288,162284,162284,162284,162280,162276,162276,162276
.long 162272,162268,162268,162268,162264,162260,162260,162260,162256,162252,162252,162252,162248,162244,162244,162244
.long 162240,162236,162236,162236,162232,162228,162228,162228,162224,162220,162220,162220,162216,162212,162212,162212
.long 162208,162204,162204,162204,162200,162196,162196,162196,162192,162188,162188,162188,162184,162180,162180,162180
.long 162176,162172,162172,162172,162168,162164,162164,162164,162160,162156,162156,162156,162152,162148,162148,162148
.long 162144,162140,162140,162140,162136,162132,162132,162132,162128,162124,162124,162124,162120,162116,162116,162116
.long 162112,162108,162108,162108,162104,162100,162100,162100,162096,162092,162092,162092,162088,162084,162084,162084
.long 162080,162076,162076,162076,162072,162068,162068,162068,162064,162060,162060,162060,162056,162052,162052,162052
.long 162048,162044,162044,162044,162040,162036,162036,162036,162032,162028,162028,162028,162024,162020,162020,162020
.long 162016,162012,162012,162012,162008,162004,162004,162004,162000,161996,161996,161996,161992,161988,161988,161988
.long 161984,161980,161980,161980,161976,161972,161972,161972,161968,161964,161964,161964,161960,161956,161956,161956
.long 161952,161948,161948,161948,161944,161940,161940,161940,161936,161932,161932,161932,161928,161924,161924,161924
.long 161920,161916,161916,161916,161912,161908,161908,161908,161904,161900,161900,161900,161896,161892,161892,161892
.long 161888,161884,161884,161884,161880,161876,161876,161876,161872,161868,161868,161868,161864,161860,161860,161860
.long 162364,162364,162360,161860,162356,162356,162352,161844,162348,162348,162344,161828,162340,162340,162336,161812
.long 162332,162332,162328,161796,162324,162324,162320,161780,162316,162316,162312,161764,162308,162308,162304,161748
.long 162300,162300,162296,161732,162292,162292,162288,161716,162284,162284,162280,161700,162276,162276,162272,161684
.long 162268,162268,162264,161668,162260,162260,162256,161652,162252,162252,162248,161636,162244,162244,162240,161620
.long 162236,162236,162232,161604,162228,162228,162224,161588,162220,162220,162216,161572,162212,162212,162208,161556
.long 162204,162204,162200,161540,162196,162196,162192,161524,162188,162188,162184,161508,162180,162180,162176,161492
.long 162172,162172,162168,161476,162164,162164,162160,161460,162156,162156,162152,161444,162148,162148,162144,161428
.long 162140,162140,162136,161412,162132,162132,162128,161396,162124,162124,162120,161380,162116,162116,162112,161364
.long 162108,162108,162104,161344,162100,162100,162096,161312,162092,162092,162088,161280,162084,162084,162080,161248
.long 162076,162076,162072,161216,162068,162068,162064,161184,162060,162060,162056,161152,162052,162052,162048,161120
.long 162044,162044,162040,161088,162036,162036,162032,161056,162028,162028,162024,161024,162020,162020,162016,160992
.long 162012,162012,162008,160960,162004,162004,162000,160928,161996,161996,161992,160896,161988,161988,161984,160864
.long 161980,161980,161976,160832,161972,161972,161968,160800,161964,161964,161960,160768,161956,161956,161952,160736
.long 161948,161948,161944,160704,161940,161940,161936,160672,161932,161932,161928,160640,161924,161924,161920,160608
.long 161916,161916,161912,160576,161908,161908,161904,160544,161900,161900,161896,160512,161892,161892,161888,160480
.long 161884,161884,161880,160448,161876,161876,161872,160416,161868,161868,161864,160384,161860,161856,161852,160352
.long 161856,161852,161852,161852,161840,161836,161836,161836,161824,161820,161820,161820,161808,161804,161804,161804
.long 161792,161788,161788,161788,161776,161772,161772,161772,161760,161756,161756,161756,161744,161740,161740,161740
.long 161728,161724,161724,161724,161712,161708,161708,161708,161696,161692,161692,161692,161680,161676,161676,161676
.long 161664,161660,161660,161660,161648,161644,161644,161644,161632,161628,161628,161628,161616,161612,161612,161612
.long 161600,161596,161596,161596,161584,161580,161580,161580,161568,161564,161564,161564,161552,161548,161548,161548
.long 161536,161532,161532,161532,161520,161516,161516,161516,161504,161500,161500,161500,161488,161484,161484,161484
.long 161472,161468,161468,161468,161456,161452,161452,161452,161440,161436,161436,161436,161424,161420,161420,161420
.long 161408,161404,161404,161404,161392,161388,161388,161388,161376,161372,161372,161372,161360,161356,161356,161356
.long 161340,161336,161332,161328,161308,161304,161300,161296,161276,161272,161268,161264,161244,161240,161236,161232
.long 161212,161208,161204,161200,161180,161176,161172,161168,161148,161144,161140,161136,161116,161112,161108,161104
.long 161084,161080,161076,161072,161052,161048,161044,161040,161020,161016,161012,161008,160988,160984,160980,160976
.long 160956,160952,160948,160944,160924,160920,160916,160912,160892,160888,160884,160880,160860,160856,160852,160848
.long 160828,160824,160820,160816,160796,160792,160788,160784,160764,160760,160756,160752,160732,160728,160724,160720
.long 160700,160696,160692,160688,160668,160664,160660,160656,160636,160632,160628,160624,160604,160600,160596,160592
.long 160572,160568,160564,160560,160540,160536,160532,160528,160508,160504,160500,160496,160476,160472,160468,160464
.long 160444,160440,160436,160432,160412,160408,160404,160400,160380,160376,160372,160368,160348,160344,160340,160336
.long 161848,161844,161844,161844,161832,161828,161828,161828,161816,161812,161812,161812,161800,161796,161796,161796
.long 161784,161780,161780,161780,161768,161764,161764,161764,161752,161748,161748,161748,161736,161732,161732,161732
.long 161720,161716,161716,161716,161704,161700,161700,161700,161688,161684,161684,161684,161672,161668,161668,161668
.long 161656,161652,161652,161652,161640,161636,161636,161636,161624,161620,161620,161620,161608,161604,161604,161604
.long 161592,161588,161588,161588,161576,161572,161572,161572,161560,161556,161556,161556,161544,161540,161540,161540
.long 161528,161524,161524,161524,161512,161508,161508,161508,161496,161492,161492,161492,161480,161476,161476,161476
.long 161464,161460,161460,161460,161448,161444,161444,161444,161432,161428,161428,161428,161416,161412,161412,161412
.long 161400,161396,161396,161396,161384,161380,161380,161380,161368,161364,161364,161364,161352,161348,161348,161344
.long 161324,161320,161316,161312,161292,161288,161284,161280,161260,161256,161252,161248,161228,161224,161220,161216
.long 161196,161192,161188,161184,161164,161160,161156,161152,161132,161128,161124,161120,161100,161096,161092,161088
.long 161068,161064,161060,161056,161036,161032,161028,161024,161004,161000,160996,160992,160972,160968,160964,160960
.long 160940,160936,160932,160928,160908,160904,160900,160896,160876,160872,160868,160864,160844,160840,160836,160832
.long 160812,160808,160804,160800,160780,160776,160772,160768,160748,160744,160740,160736,160716,160712,160708,160704
.long 160684,160680,160676,160672,160652,160648,160644,160640,160620,160616,160612,160608,160588,160584,160580,160576
.long 160556,160552,160548,160544,160524,160520,160516,160512,160492,160488,160484,160480,160460,160456,160452,160448
.long 160428,160424,160420,160416,160396,160392,160388,160384,160364,160360,160356,160352,160332,160328,160324,160320
.long 161840,161836,0,0,161824,161820,0,0,161808,161804,0,0,161792,161788,0,0
.long 161776,161772,0,0,161760,161756,0,0,161744,161740,0,0,161728,161724,0,0
.long 161712,161708,0,0,161696,161692,0,0,161680,161676,0,0,161664,161660,0,0
.long 161648,161644,0,0,161632,161628,0,0,161616,161612,0,0,161600,161596,0,0
.long 161584,161580,0,0,161568,161564,0,0,161552,161548,0,0,161536,161532,0,0
.long 161520,161516,0,0,161504,161500,0,0,161488,161484,0,0,161472,161468,0,0
.long 161456,161452,0,0,161440,161436,0,0,161424,161420,0,0,161408,161404,0,0
.long 161392,161388,0,0,161376,161372,0,0,161360,161356,0,0,161340,161336,0,0
.long 161308,161304,0,0,161276,161272,0,0,161244,161240,0,0,161212,161208,0,0
.long 161180,161176,0,0,161148,161144,0,0,161116,161112,0,0,161084,161080,0,0
.long 161052,161048,0,0,161020,161016,0,0,160988,160984,0,0,160956,160952,0,0
.long 160924,160920,0,0,160892,160888,0,0,160860,160856,0,0,160828,160824,0,0
.long 160796,160792,0,0,160764,160760,0,0,160732,160728,0,0,160700,160696,0,0
.long 160668,160664,0,0,160636,160632,0,0,160604,160600,0,0,160572,160568,0,0
.long 160540,160536,0,0,160508,160504,0,0,160476,160472,0,0,160444,160440,0,0
.long 160412,160408,0,0,160380,160376,0,0,160348,160344,0,0,160320,160320,0,0
.size L_tab, 49152
L_codeend:
.section .rodata,"a"
.p2align 6
.amdhsa_kernel recurrent_scan__ssm_conv_s4d__geglu_ffn__prompt_kernel
  .amdhsa_next_free_vgpr 512
  .amdhsa_next_free_sgpr 102
  .amdhsa_accum_offset 256
  .amdhsa_group_segment_fixed_size 0
  .amdhsa_kernarg_size 112
  .amdhsa_user_sgpr_count 2
  .amdhsa_user_sgpr_kernarg_segment_ptr 1
  .amdhsa_system_sgpr_workgroup_id_x 1
  .amdhsa_float_denorm_mode_32 3
.end_amdhsa_kernel
```
